```python
import torch

def _softmax(x, axis=-1):
    return torch.softmax(x, dim=axis)
def _gelu(x):
    return torch.nn.functional.gelu(x, approximate="tanh")
def _silu(x):
    return torch.nn.functional.silu(x)
def _sigmoid(x):
    return torch.sigmoid(x)
def _layernorm(x, axis=-1, eps=1e-5):
    m = x.mean(dim=axis, keepdim=True)
    v = x.var(dim=axis, keepdim=True, unbiased=False)
    return (x - m) / torch.sqrt(v + eps)
def _scatter_add(tgt, idx, src, axis=0):
    return tgt.clone().index_add_(axis, idx, src)
def _segment_sum(src, seg, n):
    out = torch.zeros((n,) + src.shape[1:], dtype=src.dtype)
    return out.index_add_(0, seg, src)
def _pad(x, pw):
    flat = tuple(v for pair in reversed(pw) for v in pair)
    return torch.nn.functional.pad(x, flat)

kernel_name = 'sequential_preLN__linear_kernel_hedgehog__geglu_ffn__prompt'

def setup_inputs():

    _w = (lambda a: (lambda t: t.to(torch.bfloat16) if t.is_floating_point() else t)(torch.as_tensor(a)))
    def _A_setup():
        B, S, D, H = 1, 2048, 640, 32
        Dh = D // H
        return {
            "x": _w((lambda *s: torch.randn(*s, dtype=torch.bfloat16) * 0.05)(B, S, D)),
            "wqkv": _w((lambda *s: torch.randn(*s, dtype=torch.bfloat16) * 0.2)(D, 3 * D)),
            "w_phi": _w((lambda *s: torch.randn(*s, dtype=torch.bfloat16) * 0.2)(H, Dh, Dh) * (Dh ** -0.5)),
            "wo": _w((lambda *s: torch.randn(*s, dtype=torch.bfloat16) * 0.05)(D, D)),
        }
    _A_in = _A_setup()

    def _B_setup():
        B, S, D, F = 1, 2048, 640, 1536
        return {
            "x": _w((lambda *s: torch.randn(*s, dtype=torch.bfloat16) * 0.05)(B, S, D)),
            "w_gate": _w((lambda *s: torch.randn(*s, dtype=torch.bfloat16) * 0.05)(D, F)),
            "w_up": _w((lambda *s: torch.randn(*s, dtype=torch.bfloat16) * 0.05)(D, F)),
            "w_down": _w((lambda *s: torch.randn(*s, dtype=torch.bfloat16) * 0.05)(F, D)),
        }
    _B_in = _B_setup()

    return {
        "A_x": _A_in["x"],
        "A_wqkv": _A_in["wqkv"],
        "A_w_phi": _A_in["w_phi"],
        "A_wo": _A_in["wo"],
        "B_x": _B_in["x"],
        "B_w_gate": _B_in["w_gate"],
        "B_w_up": _B_in["w_up"],
        "B_w_down": _B_in["w_down"],
    }

def reference(A_x, A_wqkv, A_w_phi, A_wo, B_x, B_w_gate, B_w_up, B_w_down):
    def _A_ref(x, wqkv, w_phi, wo):
        B, S, D = x.shape
        H = 32; Dh = D // H
        qkv = (lambda x, *d: x.permute(*d))((x @ wqkv).reshape(B, S, 3, H, Dh), 2, 0, 3, 1, 4)
        q, k, v = qkv[0], qkv[1], qkv[2]
        pq = torch.einsum("bhsd,hdf->bhsf", q, w_phi)
        pk = torch.einsum("bhsd,hdf->bhsf", k, w_phi)
        phi_q = torch.concatenate([_softmax(pq, axis=-1), _softmax(-pq, axis=-1)], axis=-1)
        phi_k = torch.concatenate([_softmax(pk, axis=-1), _softmax(-pk, axis=-1)], axis=-1)
        kv = torch.einsum("bhsf,bhsd->bhfd", phi_k, v)
        z  = torch.einsum("bhsf->bhf", phi_k)
        num = torch.einsum("bhqf,bhfd->bhqd", phi_q, kv)
        den = torch.einsum("bhqf,bhf->bhq", phi_q, z)[..., None] + 1e-6
        o = num / den
        return (lambda x, *d: x.permute(*d))(o, 0, 2, 1, 3).reshape(B, S, D) @ wo

    def _B_ref(x, w_gate, w_up, w_down):
        return (_gelu(x @ w_gate) * (x @ w_up)) @ w_down

    x = A_x
    h = x + _A_ref(_layernorm(x, axis=-1), A_wqkv, A_w_phi, A_wo)
    h2 = h + _B_ref(_layernorm(h, axis=-1), B_w_gate, B_w_up, B_w_down)
    return h2
```

```asm
; @launch grid=(256,1,1) block=(256,1,1) lds=163840
.amdgcn_target "amdgcn-amd-amdhsa--gfx950"
.text
.globl sequential_preLN__linear_kernel_hedgehog__geglu_ffn__prompt_kernel
.p2align 8
.type sequential_preLN__linear_kernel_hedgehog__geglu_ffn__prompt_kernel,@function
sequential_preLN__linear_kernel_hedgehog__geglu_ffn__prompt_kernel:
    s_cmp_lt_u32 s2, 256
    s_cbranch_scc1 L_go
    s_endpgm
L_go:
    s_load_dwordx4 s[72:75], s[0:1], 0
    s_load_dwordx4 s[76:79], s[0:1], 16
    s_load_dwordx4 s[80:83], s[0:1], 40
    s_load_dwordx4 s[84:87], s[0:1], 56
    s_load_dwordx4 s[88:91], s[0:1], 72
    v_lshrrev_b32 v2, 6, v0
    v_and_b32 v1, 63, v0
    s_and_b32 s43, s2, 7
    s_lshr_b32 s44, s2, 3
    v_readfirstlane_b32 s42, v2
    s_and_b32 s47, s44, 1
    s_lshr_b32 s57, s44, 1
    s_and_b32 s45, s43, 1
    s_lshl_b32 s45, s45, 3
    s_and_b32 s58, s57, 7
    s_add_u32 s45, s45, s58
    s_lshr_b32 s46, s43, 1
    s_lshl_b32 s46, s46, 1
    s_lshr_b32 s58, s57, 3
    s_add_u32 s46, s46, s58
    s_lshl_b32 s52, s57, 3
    s_add_u32 s52, s52, s43
    s_and_b32 s53, s45, 7
    s_mul_i32 s53, s53, 10
    s_lshr_b32 s56, s45, 3
    s_mul_i32 s56, s56, 5
    s_add_u32 s53, s53, s56
    s_lshr_b32 s56, s46, 1
    s_mul_i32 s56, s56, 20
    s_add_u32 s53, s53, s56
    s_lshr_b32 s53, s53, 3
    s_cmp_ge_u32 s53, 10
    s_cselect_b32 s56, 10, 0
    s_sub_u32 s53, s53, s56
    v_lshrrev_b32 v2, 3, v1
    v_and_b32 v3, 7, v1
    s_lshl_b32 s57, s45, 7
    s_lshl_b32 s58, s42, 5
    s_add_u32 s57, s57, s58
    s_mul_i32 s57, s57, 1280
    v_lshrrev_b32 v4, 1, v2
    v_mul_u32_u24 v5, 1280, v2
    v_add_u32 v5, s57, v5
    v_xor_b32 v6, v4, v3
    v_lshl_add_u32 v10, v6, 4, v5
    v_add_u32 v5, 10240, v5
    v_xor_b32 v6, 4, v6
    v_lshl_add_u32 v11, v6, 4, v5
    v_add_u32 v5, 10240, v5
    v_xor_b32 v6, v4, v3
    v_lshl_add_u32 v12, v6, 4, v5
    v_add_u32 v5, 10240, v5
    v_xor_b32 v6, 4, v6
    v_lshl_add_u32 v13, v6, 4, v5
    s_lshl_b32 s56, s42, 12
    s_waitcnt lgkmcnt(0)
    s_mov_b32 s4, s72
    s_and_b32 s5, s73, 0xffff
    s_mov_b32 s6, 2621440
    s_mov_b32 s7, 0x00020000
    s_mov_b32 s8, s74
    s_and_b32 s9, s75, 0xffff
    s_mov_b32 s10, 2457600
    s_mov_b32 s11, 0x00020000
    s_lshl_b32 s54, s53, 7
    s_add_u32 m0, s56, 0
    s_nop 0
    buffer_load_dwordx4 v10, s[4:7], s54 offen lds
    s_add_u32 m0, s56, 1024
    s_nop 0
    buffer_load_dwordx4 v11, s[4:7], s54 offen lds
    s_add_u32 m0, s56, 2048
    s_nop 0
    buffer_load_dwordx4 v12, s[4:7], s54 offen lds
    s_add_u32 m0, s56, 3072
    s_nop 0
    buffer_load_dwordx4 v13, s[4:7], s54 offen lds
    s_cmp_eq_u32 s47, 1
    s_cbranch_scc0 L_hk
    s_mul_i32 s55, s53, 245760
    s_mul_i32 s96, s42, 3072
    s_add_u32 s96, s96, 16384
    s_mul_i32 s59, s46, 160
    s_mul_i32 s57, s42, 192
    v_add_u32 v2, s57, v1
    s_add_u32 s57, s57, 64
    v_mul_u32_u24 v3, 0xAAAB, v2
    v_lshrrev_b32 v3, 19, v3
    v_mul_u32_u24 v4, 12, v3
    v_sub_u32 v4, v2, v4
    v_cmp_le_u32 vcc, 5, v4
    s_nop 1
    v_cndmask_b32 v5, 0, 1, vcc
    v_sub_u32 v4, v4, v5
    v_min_u32 v4, 9, v4
    v_lshlrev_b32 v4, 4, v4
    v_mul_u32_u24 v3, 3840, v3
    s_add_u32 m0, s96, 0
    v_add3_u32 v14, v3, v4, s59
    buffer_load_dwordx4 v14, s[8:11], s55 offen lds
    v_add_u32 v2, s57, v1
    s_add_u32 s57, s57, 64
    v_mul_u32_u24 v3, 0xAAAB, v2
    v_lshrrev_b32 v3, 19, v3
    v_mul_u32_u24 v4, 12, v3
    v_sub_u32 v4, v2, v4
    v_cmp_le_u32 vcc, 5, v4
    s_nop 1
    v_cndmask_b32 v5, 0, 1, vcc
    v_sub_u32 v4, v4, v5
    v_min_u32 v4, 9, v4
    v_lshlrev_b32 v4, 4, v4
    v_mul_u32_u24 v3, 3840, v3
    s_add_u32 m0, s96, 1024
    v_add3_u32 v15, v3, v4, s59
    buffer_load_dwordx4 v15, s[8:11], s55 offen lds
    v_add_u32 v2, s57, v1
    v_mul_u32_u24 v3, 0xAAAB, v2
    v_lshrrev_b32 v3, 19, v3
    v_mul_u32_u24 v4, 12, v3
    v_sub_u32 v4, v2, v4
    v_cmp_le_u32 vcc, 5, v4
    s_nop 1
    v_cndmask_b32 v5, 0, 1, vcc
    v_sub_u32 v4, v4, v5
    v_min_u32 v4, 9, v4
    v_lshlrev_b32 v4, 4, v4
    v_mul_u32_u24 v3, 3840, v3
    s_add_u32 m0, s96, 2048
    v_add3_u32 v16, v3, v4, s59
    buffer_load_dwordx4 v16, s[8:11], s55 offen lds
    s_mul_i32 s96, s42, 3072
    s_add_u32 s96, s96, 16384
    s_lshl_b32 s54, s53, 7
    s_mul_i32 s55, s53, 245760
    s_add_u32 s53, s53, 1
    s_cmp_eq_u32 s53, 10
    s_cselect_b32 s53, 0, s53
    s_add_u32 s56, s56, 28672
    s_add_u32 s96, s96, 28672
    s_branch L_q
L_hk:
    s_mul_i32 s55, s53, 245760
    s_mul_i32 s96, s42, 5120
    s_add_u32 s96, s96, 16384
    s_mul_i32 s59, s46, 160
    s_mul_i32 s57, s42, 320
    v_add_u32 v2, s57, v1
    s_add_u32 s57, s57, 64
    v_mul_u32_u24 v3, 0xCCCD, v2
    v_lshrrev_b32 v3, 20, v3
    v_mul_u32_u24 v4, 20, v3
    v_sub_u32 v4, v2, v4
    v_mul_u32_u24 v5, 52, v4
    v_lshrrev_b32 v5, 8, v5
    v_lshlrev_b32 v4, 4, v4
    v_and_b32 v6, 1, v5
    v_mul_u32_u24 v6, 1200, v6
    v_lshrrev_b32 v5, 1, v5
    v_mul_u32_u24 v5, 80, v5
    v_sub_u32 v6, v6, v5
    v_add_u32 v4, v4, v6
    v_add_u32 v4, 1280, v4
    v_mul_u32_u24 v3, 3840, v3
    s_add_u32 m0, s96, 0
    v_add3_u32 v14, v3, v4, s59
    buffer_load_dwordx4 v14, s[8:11], s55 offen lds
    v_add_u32 v2, s57, v1
    s_add_u32 s57, s57, 64
    v_mul_u32_u24 v3, 0xCCCD, v2
    v_lshrrev_b32 v3, 20, v3
    v_mul_u32_u24 v4, 20, v3
    v_sub_u32 v4, v2, v4
    v_mul_u32_u24 v5, 52, v4
    v_lshrrev_b32 v5, 8, v5
    v_lshlrev_b32 v4, 4, v4
    v_and_b32 v6, 1, v5
    v_mul_u32_u24 v6, 1200, v6
    v_lshrrev_b32 v5, 1, v5
    v_mul_u32_u24 v5, 80, v5
    v_sub_u32 v6, v6, v5
    v_add_u32 v4, v4, v6
    v_add_u32 v4, 1280, v4
    v_mul_u32_u24 v3, 3840, v3
    s_add_u32 m0, s96, 1024
    v_add3_u32 v15, v3, v4, s59
    buffer_load_dwordx4 v15, s[8:11], s55 offen lds
    v_add_u32 v2, s57, v1
    s_add_u32 s57, s57, 64
    v_mul_u32_u24 v3, 0xCCCD, v2
    v_lshrrev_b32 v3, 20, v3
    v_mul_u32_u24 v4, 20, v3
    v_sub_u32 v4, v2, v4
    v_mul_u32_u24 v5, 52, v4
    v_lshrrev_b32 v5, 8, v5
    v_lshlrev_b32 v4, 4, v4
    v_and_b32 v6, 1, v5
    v_mul_u32_u24 v6, 1200, v6
    v_lshrrev_b32 v5, 1, v5
    v_mul_u32_u24 v5, 80, v5
    v_sub_u32 v6, v6, v5
    v_add_u32 v4, v4, v6
    v_add_u32 v4, 1280, v4
    v_mul_u32_u24 v3, 3840, v3
    s_add_u32 m0, s96, 2048
    v_add3_u32 v16, v3, v4, s59
    buffer_load_dwordx4 v16, s[8:11], s55 offen lds
    v_add_u32 v2, s57, v1
    s_add_u32 s57, s57, 64
    v_mul_u32_u24 v3, 0xCCCD, v2
    v_lshrrev_b32 v3, 20, v3
    v_mul_u32_u24 v4, 20, v3
    v_sub_u32 v4, v2, v4
    v_mul_u32_u24 v5, 52, v4
    v_lshrrev_b32 v5, 8, v5
    v_lshlrev_b32 v4, 4, v4
    v_and_b32 v6, 1, v5
    v_mul_u32_u24 v6, 1200, v6
    v_lshrrev_b32 v5, 1, v5
    v_mul_u32_u24 v5, 80, v5
    v_sub_u32 v6, v6, v5
    v_add_u32 v4, v4, v6
    v_add_u32 v4, 1280, v4
    v_mul_u32_u24 v3, 3840, v3
    s_add_u32 m0, s96, 3072
    v_add3_u32 v17, v3, v4, s59
    buffer_load_dwordx4 v17, s[8:11], s55 offen lds
    v_add_u32 v2, s57, v1
    v_mul_u32_u24 v3, 0xCCCD, v2
    v_lshrrev_b32 v3, 20, v3
    v_mul_u32_u24 v4, 20, v3
    v_sub_u32 v4, v2, v4
    v_mul_u32_u24 v5, 52, v4
    v_lshrrev_b32 v5, 8, v5
    v_lshlrev_b32 v4, 4, v4
    v_and_b32 v6, 1, v5
    v_mul_u32_u24 v6, 1200, v6
    v_lshrrev_b32 v5, 1, v5
    v_mul_u32_u24 v5, 80, v5
    v_sub_u32 v6, v6, v5
    v_add_u32 v4, v4, v6
    v_add_u32 v4, 1280, v4
    v_mul_u32_u24 v3, 3840, v3
    s_add_u32 m0, s96, 4096
    v_add3_u32 v18, v3, v4, s59
    buffer_load_dwordx4 v18, s[8:11], s55 offen lds
    s_mul_i32 s96, s42, 5120
    s_add_u32 s96, s96, 16384
    s_lshl_b32 s54, s53, 7
    s_mul_i32 s55, s53, 245760
    s_add_u32 s53, s53, 1
    s_cmp_eq_u32 s53, 10
    s_cselect_b32 s53, 0, s53
    s_add_u32 s56, s56, 36864
    s_add_u32 s96, s96, 36864
    s_mov_b32 s12, s90
    s_and_b32 s13, s91, 0xffff
    s_mov_b32 s14, 33554432
    s_mov_b32 s15, 0x00020000
    s_mov_b32 s16, s88
    s_and_b32 s17, s89, 0xffff
    s_mov_b32 s18, 256
    s_mov_b32 s19, 0x00020000
    s_mov_b32 s20, s86
    s_and_b32 s21, s87, 0xffff
    s_mov_b32 s22, 2621440
    s_mov_b32 s23, 0x00020000
    s_mov_b32 s24, s76
    s_and_b32 s25, s77, 0xffff
    s_mov_b32 s26, 25600
    s_mov_b32 s27, 0x00020000
    s_mov_b64 s[32:33], s[78:79]
    s_mov_b64 s[34:35], s[80:81]
    s_mov_b64 s[36:37], s[82:83]
    s_mov_b64 s[38:39], s[84:85]
    s_lshr_b32 s58, s44, 3
    s_lshr_b32 s48, s43, 1
    s_lshl_b32 s48, s48, 2
    s_add_u32 s48, s48, s58
    s_bfe_u32 s49, s44, 0x10002
    s_and_b32 s58, s43, 1
    s_lshl_b32 s50, s58, 2
    s_and_b32 s59, s44, 3
    s_add_u32 s50, s50, s59
    s_and_b32 s58, s43, 1
    s_lshl_b32 s51, s58, 3
    s_and_b32 s59, s44, 7
    s_add_u32 s51, s51, s59
    s_mov_b32 s63, 0x3f803f80
    s_mov_b32 s66, 0x3fb8aa3b
    s_mov_b32 s67, 0x3fb8aa3b
    s_mul_i32 s57, s46, 3200
    v_lshlrev_b32 v2, 4, v0
    v_cmp_gt_u32 vcc, 200, v0
    s_lshl_b32 s58, s42, 10
    s_add_u32 m0, s58, 147456
    s_and_saveexec_b64 s[68:69], vcc
    buffer_load_dwordx4 v2, s[24:27], s57 offen lds
    s_mov_b64 exec, s[68:69]
    s_getpc_b64 s[28:29]
L_pc:
    s_sub_u32 s28, s28, L_pc-sequential_preLN__linear_kernel_hedgehog__geglu_ffn__prompt_kernel
    s_subb_u32 s29, s29, 0
    s_and_b32 s29, s29, 0xffff
    s_mov_b32 s30, L_end-sequential_preLN__linear_kernel_hedgehog__geglu_ffn__prompt_kernel
    s_mov_b32 s31, 0x00020000
    s_lshl_b32 s57, s44, 12
    buffer_load_dwordx4 v[4:7], v2, s[28:31], s57 offen
    s_or_b32 s57, s2, s42
    s_cmp_eq_u32 s57, 0
    s_cbranch_scc0 noz_1
    v_lshlrev_b32 v8, 8, v0
    v_mov_b32 v9, 0
    s_movk_i32 s58, 0x4000
    buffer_store_dword v9, v8, s[12:15], 0 offen sc1
    buffer_store_dword v9, v8, s[12:15], s58 offen sc1
    s_mov_b32 s58, 0x8000
    buffer_store_dword v9, v8, s[12:15], s58 offen sc1
noz_1:
    v_mov_b32 v25, 0
    v_mov_b32 v26, 0
    v_mov_b32 v27, 0
    v_mov_b32 v28, 0
    v_mov_b32 v29, 0
    v_mov_b32 v30, 0
    v_mov_b32 v31, 0
    v_mov_b32 v60, 0
    v_mov_b32 v61, 0
    v_mov_b32 v62, 0
    v_mov_b32 v63, 0
    v_mov_b32 v64, 0
    v_mov_b32 v65, 0
    v_mov_b32 v66, 0
    v_mov_b32 v67, 0
    v_mov_b32 v68, 0
    v_mov_b32 v69, 0
    v_mov_b32 v70, 0
    v_mov_b32 v71, 0
    v_mov_b32 v72, 0
    v_mov_b32 v73, 0
    v_mov_b32 v74, 0
    v_mov_b32 v75, 0
    v_mov_b32 v76, 0
    v_mov_b32 v77, 0
    v_mov_b32 v78, 0
    v_mov_b32 v79, 0
    v_mov_b32 v80, 0
    v_mov_b32 v81, 0
    v_mov_b32 v82, 0
    v_mov_b32 v83, 0
    v_mov_b32 v84, 0
    v_mov_b32 v85, 0
    v_mov_b32 v86, 0
    v_mov_b32 v87, 0
    v_mov_b32 v88, 0
    v_mov_b32 v89, 0
    v_mov_b32 v90, 0
    v_mov_b32 v91, 0
    v_mov_b32 v92, 0
    v_mov_b32 v93, 0
    v_mov_b32 v94, 0
    v_mov_b32 v95, 0
    v_mov_b32 v96, 0
    v_mov_b32 v97, 0
    v_mov_b32 v98, 0
    v_mov_b32 v99, 0
    v_mov_b32 v100, 0
    v_mov_b32 v101, 0
    v_mov_b32 v102, 0
    v_mov_b32 v103, 0
    v_mov_b32 v104, 0
    v_mov_b32 v105, 0
    v_mov_b32 v106, 0
    v_mov_b32 v107, 0
    v_mov_b32 v108, 0
    v_mov_b32 v109, 0
    v_mov_b32 v110, 0
    v_mov_b32 v111, 0
    v_mov_b32 v112, 0
    v_mov_b32 v113, 0
    v_mov_b32 v114, 0
    v_mov_b32 v115, 0
    v_mov_b32 v116, 0
    v_mov_b32 v117, 0
    v_mov_b32 v118, 0
    v_mov_b32 v119, 0
    v_mov_b32 v120, 0
    v_mov_b32 v121, 0
    v_mov_b32 v122, 0
    v_mov_b32 v123, 0
    v_mov_b32 v124, 0
    v_mov_b32 v125, 0
    v_mov_b32 v126, 0
    v_mov_b32 v127, 0
    v_mov_b32 v128, 0
    v_mov_b32 v129, 0
    v_mov_b32 v130, 0
    v_mov_b32 v131, 0
    v_mov_b32 v132, 0
    v_mov_b32 v133, 0
    v_mov_b32 v134, 0
    v_mov_b32 v135, 0
    v_mov_b32 v136, 0
    v_mov_b32 v137, 0
    v_mov_b32 v138, 0
    v_mov_b32 v139, 0
    v_mov_b32 v140, 0
    v_mov_b32 v141, 0
    v_mov_b32 v142, 0
    v_mov_b32 v143, 0
    v_mov_b32 v144, 0
    v_mov_b32 v145, 0
    v_mov_b32 v146, 0
    v_mov_b32 v147, 0
    v_mov_b32 v148, 0
    v_mov_b32 v149, 0
    v_mov_b32 v150, 0
    v_mov_b32 v151, 0
    v_mov_b32 v152, 0
    v_mov_b32 v153, 0
    v_mov_b32 v154, 0
    v_mov_b32 v155, 0
    v_mov_b32 v156, 0
    v_mov_b32 v157, 0
    v_mov_b32 v158, 0
    v_mov_b32 v159, 0
    v_mov_b32 v164, 0
    v_mov_b32 v165, 0
    v_mov_b32 v166, 0
    v_mov_b32 v167, 0
    v_lshlrev_b32 v2, 4, v0
    v_add_u32 v2, 150784, v2
    v_cmp_gt_u32 vcc, 128, v0
    s_nop 1
    s_and_saveexec_b64 s[68:69], vcc
    ds_write_b128 v2, v[60:63]
    s_mov_b64 exec, s[68:69]
    v_and_b32 v2, 31, v1
    v_lshrrev_b32 v3, 5, v1
    v_bfe_u32 v8, v2, 1, 3
    v_xor_b32 v3, v3, v8
    s_lshl_b32 s57, s42, 12
    v_lshlrev_b32 v2, 7, v2
    v_lshl_add_u32 v2, v3, 4, v2
    v_add_u32 v19, s57, v2
    v_lshrrev_b32 v2, 5, v1
    v_bfe_u32 v3, v1, 2, 2
    v_bfe_u32 v8, v1, 4, 1
    v_lshlrev_b32 v8, 1, v8
    v_bfe_u32 v9, v1, 1, 1
    v_add_u32 v8, v8, v9
    v_and_b32 v9, 1, v1
    v_lshl_add_u32 v24, v2, 3, v3
    v_mul_u32_u24 v24, 320, v24
    v_mul_u32_u24 v177, 160, v9
    v_lshl_add_u32 v177, v8, 3, v177
    v_add_u32 v24, v24, v177
    s_add_u32 s57, s42, 0
    s_and_b32 s57, s57, 3
    s_lshl_b32 s58, s57, 5
    s_mul_i32 s57, s57, 5120
    s_add_u32 s57, s57, 16384
    v_xor_b32 v20, s58, v19
    v_add_u32 v168, s57, v24
    s_add_u32 s57, s42, 1
    s_and_b32 s57, s57, 3
    s_lshl_b32 s58, s57, 5
    s_mul_i32 s57, s57, 5120
    s_add_u32 s57, s57, 16384
    v_xor_b32 v21, s58, v19
    v_add_u32 v169, s57, v24
    s_add_u32 s57, s42, 2
    s_and_b32 s57, s57, 3
    s_lshl_b32 s58, s57, 5
    s_mul_i32 s57, s57, 5120
    s_add_u32 s57, s57, 16384
    v_xor_b32 v22, s58, v19
    v_add_u32 v170, s57, v24
    s_add_u32 s57, s42, 3
    s_and_b32 s57, s57, 3
    s_lshl_b32 s58, s57, 5
    s_mul_i32 s57, s57, 5120
    s_add_u32 s57, s57, 16384
    v_xor_b32 v23, s58, v19
    v_add_u32 v171, s57, v24
    v_mul_u32_u24 v178, 40, v3
    v_mul_u32_u24 v177, 1600, v2
    v_add_u32 v177, v177, v178
    v_add_u32 v177, 147456, v177
    v_lshl_add_u32 v178, v8, 3, v177
    v_mov_b32 v24, 150784
    v_cmp_eq_u32 s[68:69], v2, v9
    s_nop 1
    v_cndmask_b32 v200, v24, v178, s[68:69]
    v_cmp_eq_u32 vcc, 0, v8
    s_nop 1
    s_and_b64 vcc, vcc, s[68:69]
    v_add_u32 v19, 32, v177
    v_cndmask_b32 v201, v24, v19, vcc
    v_cmp_lt_u32 vcc, 0, v8
    s_nop 1
    s_and_b64 vcc, vcc, s[68:69]
    v_add_u32 v19, 792, v178
    v_cndmask_b32 v202, v24, v19, vcc
    v_cmp_gt_u32 vcc, 2, v8
    s_nop 1
    s_and_b64 vcc, vcc, s[68:69]
    v_add_u32 v19, 824, v178
    v_cndmask_b32 v203, v24, v19, vcc
    v_lshl_add_u32 v177, v2, 3, v3
    v_lshlrev_b32 v177, 9, v177
    v_bfe_u32 v178, v3, 1, 1
    v_mul_u32_u24 v178, 10, v178
    v_and_b32 v19, 1, v3
    v_lshl_add_u32 v178, v19, 2, v178
    s_lshl_b32 s57, s42, 3
    v_xor_b32 v178, s57, v178
    v_and_b32 v19, 1, v8
    v_lshl_add_u32 v24, v19, 3, v177
    v_lshrrev_b32 v19, 1, v8
    v_lshl_add_u32 v19, v9, 1, v19
    v_xor_b32 v19, v19, v178
    v_lshl_add_u32 v252, v19, 4, v24
    v_xor_b32 v19, 4, v178
    v_lshl_add_u32 v253, v19, 4, v24
    v_lshl_add_u32 v24, v9, 3, v177
    v_min_u32 v19, 2, v8
    v_add_u32 v19, 5, v19
    v_xor_b32 v19, v19, v178
    v_lshl_add_u32 v255, v19, 4, v24
    v_and_b32 v2, 31, v1
    s_lshl_b32 s57, s42, 14
    v_lshlrev_b32 v3, 9, v2
    v_lshrrev_b32 v8, 5, v1
    v_lshl_add_u32 v3, v8, 8, v3
    v_add_u32 v3, s57, v3
    v_bfe_u32 v8, v2, 1, 1
    v_mul_u32_u24 v8, 10, v8
    v_and_b32 v9, 1, v2
    v_lshl_add_u32 v8, v9, 2, v8
    v_bfe_u32 v9, v2, 2, 1
    v_add_u32 v8, v8, v9
    v_lshl_add_u32 v254, v8, 4, v3
    s_mov_b32 s41, s52
    s_mov_b32 s28, s38
    s_and_b32 s29, s39, 0xffff
    s_mov_b32 s30, 1966080
    s_mov_b32 s31, 0x00020000
    s_lshr_b32 s57, s41, 1
    s_lshl_b32 s57, s57, 2
    s_add_u32 s57, s57, s42
    s_mul_i32 s58, s57, 0x5556
    s_lshr_b32 s58, s58, 16
    s_mul_i32 s59, s58, 3
    s_sub_u32 s59, s57, s59
    s_mul_i32 s58, s58, 24
    s_lshl_b32 s61, s59, 2
    s_cmp_eq_u32 s59, 2
    s_cselect_b32 s61, 16, s61
    s_cselect_b32 s62, 0, 4
    s_add_u32 s58, s58, s61
    s_mov_b32 s61, s62
    s_mul_i32 s58, s58, 1280
    s_mul_i32 s61, s61, 1280
    s_and_b32 s59, s41, 1
    s_mul_i32 s59, s59, 640
    s_add_u32 s59, s59, s58
    s_mul_i32 s62, s42, 5120
    v_add_u32 v2, 0, v1
    v_mul_u32_u24 v3, 0xCCCD, v2
    v_lshrrev_b32 v3, 21, v3
    v_lshrrev_b32 v8, 2, v3
    v_mul_lo_u32 v8, v8, s61
    v_mul_u32_u24 v3, 640, v3
    v_lshl_add_u32 v3, v2, 4, v3
    v_add_u32 v172, v3, v8
    v_add_u32 v2, 64, v1
    v_mul_u32_u24 v3, 0xCCCD, v2
    v_lshrrev_b32 v3, 21, v3
    v_lshrrev_b32 v8, 2, v3
    v_mul_lo_u32 v8, v8, s61
    v_mul_u32_u24 v3, 640, v3
    v_lshl_add_u32 v3, v2, 4, v3
    v_add_u32 v173, v3, v8
    v_add_u32 v2, 128, v1
    v_mul_u32_u24 v3, 0xCCCD, v2
    v_lshrrev_b32 v3, 21, v3
    v_lshrrev_b32 v8, 2, v3
    v_mul_lo_u32 v8, v8, s61
    v_mul_u32_u24 v3, 640, v3
    v_lshl_add_u32 v3, v2, 4, v3
    v_add_u32 v174, v3, v8
    v_add_u32 v2, 192, v1
    v_mul_u32_u24 v3, 0xCCCD, v2
    v_lshrrev_b32 v3, 21, v3
    v_lshrrev_b32 v8, 2, v3
    v_mul_lo_u32 v8, v8, s61
    v_mul_u32_u24 v3, 640, v3
    v_lshl_add_u32 v3, v2, 4, v3
    v_add_u32 v175, v3, v8
    v_add_u32 v2, 256, v1
    v_mul_u32_u24 v3, 0xCCCD, v2
    v_lshrrev_b32 v3, 21, v3
    v_lshrrev_b32 v8, 2, v3
    v_mul_lo_u32 v8, v8, s61
    v_mul_u32_u24 v3, 640, v3
    v_lshl_add_u32 v3, v2, 4, v3
    v_add_u32 v176, v3, v8
    s_mov_b32 s40, s59
    s_mov_b32 s99, s62
    s_cmp_lt_u32 s52, 96
    s_cbranch_scc1 wdu_2
    s_add_u32 s41, s52, 32
    s_lshr_b32 s57, s41, 3
    s_mul_i32 s58, s57, 52
    s_lshr_b32 s58, s58, 8
    s_mul_i32 s59, s58, 5
    s_sub_u32 s59, s57, s59
    s_mul_i32 s58, s58, 160
    s_lshl_b32 s61, s59, 5
    s_cmp_ge_u32 s59, 2
    s_cselect_b32 s62, 16, 0
    s_add_u32 s61, s61, s62
    s_cmp_eq_u32 s59, 4
    s_cselect_b32 s61, 64, s61
    s_cselect_b32 s62, 64, 0
    s_add_u32 s58, s58, s61
    s_add_u32 s62, s62, 16
    s_and_b32 s57, s42, 1
    s_mul_i32 s62, s62, s57
    s_add_u32 s58, s58, s62
    s_mul_i32 s58, s58, 3072
    s_and_b32 s59, s41, 7
    s_mul_i32 s59, s59, 384
    s_add_u32 s59, s59, s58
    s_cmp_lt_u32 s42, 2
    s_cselect_b32 s28, s34, s36
    s_cselect_b32 s29, s35, s37
    s_and_b32 s29, s29, 0xffff
    s_mov_b32 s30, 1966080
    s_mov_b32 s31, 0x00020000
    s_mul_i32 s61, s42, 6144
    v_add_u32 v2, 0, v1
    v_mul_u32_u24 v3, 0xAAAB, v2
    v_lshrrev_b32 v3, 20, v3
    v_mul_u32_u24 v8, 2688, v3
    v_lshl_add_u32 v172, v2, 4, v8
    v_add_u32 v2, 64, v1
    v_mul_u32_u24 v3, 0xAAAB, v2
    v_lshrrev_b32 v3, 20, v3
    v_mul_u32_u24 v8, 2688, v3
    v_lshl_add_u32 v173, v2, 4, v8
    v_add_u32 v2, 128, v1
    v_mul_u32_u24 v3, 0xAAAB, v2
    v_lshrrev_b32 v3, 20, v3
    v_mul_u32_u24 v8, 2688, v3
    v_lshl_add_u32 v174, v2, 4, v8
    v_add_u32 v2, 192, v1
    v_mul_u32_u24 v3, 0xAAAB, v2
    v_lshrrev_b32 v3, 20, v3
    v_mul_u32_u24 v8, 2688, v3
    v_lshl_add_u32 v175, v2, 4, v8
    v_add_u32 v2, 256, v1
    v_mul_u32_u24 v3, 0xAAAB, v2
    v_lshrrev_b32 v3, 20, v3
    v_mul_u32_u24 v8, 2688, v3
    v_lshl_add_u32 v176, v2, 4, v8
    v_add_u32 v2, 320, v1
    v_mul_u32_u24 v3, 0xAAAB, v2
    v_lshrrev_b32 v3, 20, v3
    v_mul_u32_u24 v8, 2688, v3
    v_lshl_add_u32 v177, v2, 4, v8
    s_mov_b32 s40, s59
    s_mov_b32 s99, s61
wdu_2:
    s_lshl_b32 s54, s53, 7
    s_mul_i32 s55, s53, 245760
    s_add_u32 s53, s53, 1
    s_cmp_eq_u32 s53, 10
    s_cselect_b32 s53, 0, s53
    s_add_u32 m0, s56, 0
    s_nop 0
    buffer_load_dwordx4 v10, s[4:7], s54 offen lds
    s_add_u32 m0, s56, 1024
    s_nop 0
    buffer_load_dwordx4 v11, s[4:7], s54 offen lds
    s_add_u32 m0, s56, 2048
    s_nop 0
    buffer_load_dwordx4 v12, s[4:7], s54 offen lds
    s_add_u32 m0, s56, 3072
    s_nop 0
    buffer_load_dwordx4 v13, s[4:7], s54 offen lds
    s_add_u32 m0, s96, 0
    s_nop 0
    buffer_load_dwordx4 v14, s[8:11], s55 offen lds
    s_add_u32 m0, s96, 1024
    s_nop 0
    buffer_load_dwordx4 v15, s[8:11], s55 offen lds
    s_add_u32 m0, s96, 2048
    s_nop 0
    buffer_load_dwordx4 v16, s[8:11], s55 offen lds
    s_add_u32 m0, s96, 3072
    s_nop 0
    buffer_load_dwordx4 v17, s[8:11], s55 offen lds
    s_add_u32 m0, s96, 4096
    s_nop 0
    buffer_load_dwordx4 v18, s[8:11], s55 offen lds
    s_add_u32 s56, s56, 36864
    s_add_u32 s96, s96, 36864
    s_mov_b32 s97, 0
    s_mov_b32 s98, 36864
    s_mov_b32 s65, 0
    s_waitcnt vmcnt(9) lgkmcnt(0)
    s_or_b32 s57, s2, s42
    s_cmp_eq_u32 s57, 0
    s_cbranch_scc0 nof_4
    v_mov_b32 v2, 0
    v_mov_b32 v3, 1
    s_mov_b64 exec, 1
    buffer_store_dword v3, v2, s[16:19], 0 offen sc1
    s_mov_b64 exec, -1
nof_4:
    .p2align 6
p1loop_5:
    s_waitcnt vmcnt(9)
    s_barrier
    v_mfma_f32_32x32x16_bf16 v[80:95], v[60:63], v[164:167], v[80:95]
    ds_read_b128 v[32:35], v20
    ds_read_b64_tr_b16 v[40:41], v168 offset:0
    ds_read_b64_tr_b16 v[42:43], v168 offset:1280
    v_mfma_f32_32x32x16_bf16 v[96:111], v[64:67], v[164:167], v[96:111]
    ds_read_b64_tr_b16 v[44:45], v168 offset:32
    ds_read_b64_tr_b16 v[46:47], v168 offset:1312
    v_mfma_f32_32x32x16_bf16 v[112:127], v[68:71], v[164:167], v[112:127]
    ds_read_b64_tr_b16 v[48:49], v168 offset:64
    ds_read_b64_tr_b16 v[50:51], v168 offset:1344
    s_lshl_b32 s54, s53, 7
    s_mul_i32 s55, s53, 245760
    s_add_u32 s53, s53, 1
    s_cmp_eq_u32 s53, 10
    s_cselect_b32 s53, 0, s53
    v_mfma_f32_32x32x16_bf16 v[128:143], v[72:75], v[164:167], v[128:143]
    s_add_u32 m0, s56, 0
    ds_read_b64_tr_b16 v[52:53], v168 offset:96
    ds_read_b64_tr_b16 v[54:55], v168 offset:1376
    buffer_load_dwordx4 v10, s[4:7], s54 offen lds
    v_mfma_f32_32x32x16_bf16 v[144:159], v[76:79], v[164:167], v[144:159]
    s_add_u32 m0, s56, 1024
    ds_read_b64_tr_b16 v[56:57], v168 offset:128
    ds_read_b64_tr_b16 v[58:59], v168 offset:1408
    buffer_load_dwordx4 v11, s[4:7], s54 offen lds
    s_waitcnt lgkmcnt(8)
    v_mfma_f32_32x32x16_bf16 v[80:95], v[40:43], v[32:35], v[80:95]
    ds_read_b128 v[36:39], v21
    ds_read_b64_tr_b16 v[60:61], v169 offset:0
    ds_read_b64_tr_b16 v[62:63], v169 offset:1280
    s_waitcnt lgkmcnt(9)
    v_mfma_f32_32x32x16_bf16 v[96:111], v[44:47], v[32:35], v[96:111]
    ds_read_b64_tr_b16 v[64:65], v169 offset:32
    ds_read_b64_tr_b16 v[66:67], v169 offset:1312
    s_waitcnt lgkmcnt(9)
    v_mfma_f32_32x32x16_bf16 v[112:127], v[48:51], v[32:35], v[112:127]
    s_add_u32 m0, s56, 2048
    ds_read_b64_tr_b16 v[68:69], v169 offset:64
    ds_read_b64_tr_b16 v[70:71], v169 offset:1344
    buffer_load_dwordx4 v12, s[4:7], s54 offen lds
    s_waitcnt lgkmcnt(9)
    v_mfma_f32_32x32x16_bf16 v[128:143], v[52:55], v[32:35], v[128:143]
    s_add_u32 m0, s56, 3072
    ds_read_b64_tr_b16 v[72:73], v169 offset:96
    ds_read_b64_tr_b16 v[74:75], v169 offset:1376
    buffer_load_dwordx4 v13, s[4:7], s54 offen lds
    s_waitcnt lgkmcnt(9)
    v_mfma_f32_32x32x16_bf16 v[144:159], v[56:59], v[32:35], v[144:159]
    s_add_u32 m0, s96, 0
    ds_read_b64_tr_b16 v[76:77], v169 offset:128
    ds_read_b64_tr_b16 v[78:79], v169 offset:1408
    buffer_load_dwordx4 v14, s[8:11], s55 offen lds
    s_waitcnt lgkmcnt(8)
    v_mfma_f32_32x32x16_bf16 v[80:95], v[60:63], v[36:39], v[80:95]
    ds_read_b128 v[160:163], v22
    ds_read_b64_tr_b16 v[40:41], v170 offset:0
    ds_read_b64_tr_b16 v[42:43], v170 offset:1280
    s_waitcnt lgkmcnt(9)
    v_mfma_f32_32x32x16_bf16 v[96:111], v[64:67], v[36:39], v[96:111]
    ds_read_b64_tr_b16 v[44:45], v170 offset:32
    ds_read_b64_tr_b16 v[46:47], v170 offset:1312
    s_waitcnt lgkmcnt(9)
    v_mfma_f32_32x32x16_bf16 v[112:127], v[68:71], v[36:39], v[112:127]
    s_add_u32 m0, s96, 1024
    ds_read_b64_tr_b16 v[48:49], v170 offset:64
    ds_read_b64_tr_b16 v[50:51], v170 offset:1344
    buffer_load_dwordx4 v15, s[8:11], s55 offen lds
    s_waitcnt lgkmcnt(9)
    v_mfma_f32_32x32x16_bf16 v[128:143], v[72:75], v[36:39], v[128:143]
    s_add_u32 m0, s96, 2048
    ds_read_b64_tr_b16 v[52:53], v170 offset:96
    ds_read_b64_tr_b16 v[54:55], v170 offset:1376
    buffer_load_dwordx4 v16, s[8:11], s55 offen lds
    s_waitcnt lgkmcnt(9)
    v_mfma_f32_32x32x16_bf16 v[144:159], v[76:79], v[36:39], v[144:159]
    s_add_u32 m0, s96, 3072
    ds_read_b64_tr_b16 v[56:57], v170 offset:128
    ds_read_b64_tr_b16 v[58:59], v170 offset:1408
    buffer_load_dwordx4 v17, s[8:11], s55 offen lds
    s_waitcnt lgkmcnt(8)
    v_mfma_f32_32x32x16_bf16 v[80:95], v[40:43], v[160:163], v[80:95]
    ds_read_b128 v[164:167], v23
    ds_read_b64_tr_b16 v[60:61], v171 offset:0
    ds_read_b64_tr_b16 v[62:63], v171 offset:1280
    s_waitcnt lgkmcnt(9)
    v_mfma_f32_32x32x16_bf16 v[96:111], v[44:47], v[160:163], v[96:111]
    ds_read_b64_tr_b16 v[64:65], v171 offset:32
    ds_read_b64_tr_b16 v[66:67], v171 offset:1312
    s_waitcnt lgkmcnt(9)
    v_mfma_f32_32x32x16_bf16 v[112:127], v[48:51], v[160:163], v[112:127]
    s_add_u32 m0, s96, 4096
    ds_read_b64_tr_b16 v[68:69], v171 offset:64
    ds_read_b64_tr_b16 v[70:71], v171 offset:1344
    buffer_load_dwordx4 v18, s[8:11], s55 offen lds
    s_waitcnt lgkmcnt(9)
    v_mfma_f32_32x32x16_bf16 v[128:143], v[52:55], v[160:163], v[128:143]
    ds_read_b64_tr_b16 v[72:73], v171 offset:96
    ds_read_b64_tr_b16 v[74:75], v171 offset:1376
    s_cmp_eq_u32 s97, 0
    s_cselect_b32 s58, 4294893568, s98
    s_add_u32 s56, s56, s58
    s_add_u32 s96, s96, s58
    s_waitcnt lgkmcnt(9)
    v_mfma_f32_32x32x16_bf16 v[144:159], v[56:59], v[160:163], v[144:159]
    ds_read_b64_tr_b16 v[76:77], v171 offset:128
    ds_read_b64_tr_b16 v[78:79], v171 offset:1408
    s_add_u32 s97, s97, 1
    s_cmp_eq_u32 s97, 3
    s_cselect_b32 s57, 4294893568, s98
    s_cselect_b32 s97, 0, s97
    v_add_u32 v20, s57, v20
    v_add_u32 v21, s57, v21
    v_add_u32 v22, s57, v22
    v_add_u32 v23, s57, v23
    v_add_u32 v168, s57, v168
    v_add_u32 v169, s57, v169
    v_add_u32 v170, s57, v170
    v_add_u32 v171, s57, v171
    v_dot2c_f32_bf16 v25, s63, v32
    v_dot2c_f32_bf16 v26, v32, v32
    v_dot2c_f32_bf16 v25, s63, v33
    v_dot2c_f32_bf16 v26, v33, v33
    v_dot2c_f32_bf16 v25, s63, v34
    v_dot2c_f32_bf16 v26, v34, v34
    v_dot2c_f32_bf16 v25, s63, v35
    v_dot2c_f32_bf16 v26, v35, v35
    v_dot2c_f32_bf16 v25, s63, v36
    v_dot2c_f32_bf16 v26, v36, v36
    v_dot2c_f32_bf16 v25, s63, v37
    v_dot2c_f32_bf16 v26, v37, v37
    v_dot2c_f32_bf16 v25, s63, v38
    v_dot2c_f32_bf16 v26, v38, v38
    v_dot2c_f32_bf16 v25, s63, v39
    v_dot2c_f32_bf16 v26, v39, v39
    v_dot2c_f32_bf16 v25, s63, v160
    v_dot2c_f32_bf16 v26, v160, v160
    v_dot2c_f32_bf16 v25, s63, v161
    v_dot2c_f32_bf16 v26, v161, v161
    v_dot2c_f32_bf16 v25, s63, v162
    v_dot2c_f32_bf16 v26, v162, v162
    v_dot2c_f32_bf16 v25, s63, v163
    v_dot2c_f32_bf16 v26, v163, v163
    s_waitcnt lgkmcnt(0)
    v_dot2c_f32_bf16 v25, s63, v164
    v_dot2c_f32_bf16 v26, v164, v164
    v_dot2c_f32_bf16 v25, s63, v165
    v_dot2c_f32_bf16 v26, v165, v165
    v_dot2c_f32_bf16 v25, s63, v166
    v_dot2c_f32_bf16 v26, v166, v166
    v_dot2c_f32_bf16 v25, s63, v167
    v_dot2c_f32_bf16 v26, v167, v167
    v_dot2c_f32_bf16 v27, s63, v60
    v_dot2c_f32_bf16 v28, s63, v64
    v_dot2c_f32_bf16 v29, s63, v68
    v_dot2c_f32_bf16 v30, s63, v72
    v_dot2c_f32_bf16 v31, s63, v76
    v_dot2c_f32_bf16 v27, s63, v61
    v_dot2c_f32_bf16 v28, s63, v65
    v_dot2c_f32_bf16 v29, s63, v69
    v_dot2c_f32_bf16 v30, s63, v73
    v_dot2c_f32_bf16 v31, s63, v77
    v_dot2c_f32_bf16 v27, s63, v62
    v_dot2c_f32_bf16 v28, s63, v66
    v_dot2c_f32_bf16 v29, s63, v70
    v_dot2c_f32_bf16 v30, s63, v74
    v_dot2c_f32_bf16 v31, s63, v78
    v_dot2c_f32_bf16 v27, s63, v63
    v_dot2c_f32_bf16 v28, s63, v67
    v_dot2c_f32_bf16 v29, s63, v71
    v_dot2c_f32_bf16 v30, s63, v75
    v_dot2c_f32_bf16 v31, s63, v79
    s_add_u32 s65, s65, 1
    s_cmp_lt_u32 s65, 8
    s_cbranch_scc1 p1loop_5
    s_waitcnt vmcnt(9)
    s_barrier
    v_mfma_f32_32x32x16_bf16 v[80:95], v[60:63], v[164:167], v[80:95]
    ds_read_b128 v[32:35], v20
    ds_read_b64_tr_b16 v[40:41], v168 offset:0
    ds_read_b64_tr_b16 v[42:43], v168 offset:1280
    v_mfma_f32_32x32x16_bf16 v[96:111], v[64:67], v[164:167], v[96:111]
    v_mov_b32 v198, 0
    ds_read_b64_tr_b16 v[44:45], v168 offset:32
    ds_read_b64_tr_b16 v[46:47], v168 offset:1312
    v_mov_b32 v24, 2147483648
    v_mfma_f32_32x32x16_bf16 v[112:127], v[68:71], v[164:167], v[112:127]
    ds_read_b64_tr_b16 v[48:49], v168 offset:64
    ds_read_b64_tr_b16 v[50:51], v168 offset:1344
    buffer_load_dword v196, v198, s[16:19], 0 offen sc1
    v_mfma_f32_32x32x16_bf16 v[128:143], v[72:75], v[164:167], v[128:143]
    v_lshlrev_b32 v199, 8, v1
    ds_read_b64_tr_b16 v[52:53], v168 offset:96
    ds_read_b64_tr_b16 v[54:55], v168 offset:1376
    v_cmp_gt_u32 vcc, 8, v1
    v_mfma_f32_32x32x16_bf16 v[144:159], v[76:79], v[164:167], v[144:159]
    ds_read_b64_tr_b16 v[56:57], v168 offset:128
    ds_read_b64_tr_b16 v[58:59], v168 offset:1408
    s_nop 0
    s_waitcnt lgkmcnt(8)
    v_mfma_f32_32x32x16_bf16 v[80:95], v[40:43], v[32:35], v[80:95]
    ds_read_b128 v[36:39], v21
    ds_read_b64_tr_b16 v[60:61], v169 offset:0
    ds_read_b64_tr_b16 v[62:63], v169 offset:1280
    s_waitcnt lgkmcnt(9)
    v_mfma_f32_32x32x16_bf16 v[96:111], v[44:47], v[32:35], v[96:111]
    ds_read_b64_tr_b16 v[64:65], v169 offset:32
    ds_read_b64_tr_b16 v[66:67], v169 offset:1312
    v_cndmask_b32 v199, v24, v199, vcc
    s_waitcnt lgkmcnt(9)
    v_mfma_f32_32x32x16_bf16 v[112:127], v[48:51], v[32:35], v[112:127]
    s_add_u32 m0, s99, 110592
    ds_read_b64_tr_b16 v[68:69], v169 offset:64
    ds_read_b64_tr_b16 v[70:71], v169 offset:1344
    buffer_load_dwordx4 v172, s[28:31], s40 offen lds
    s_waitcnt lgkmcnt(9)
    v_mfma_f32_32x32x16_bf16 v[128:143], v[52:55], v[32:35], v[128:143]
    s_add_u32 m0, s99, 111616
    ds_read_b64_tr_b16 v[72:73], v169 offset:96
    ds_read_b64_tr_b16 v[74:75], v169 offset:1376
    buffer_load_dwordx4 v173, s[28:31], s40 offen lds
    s_waitcnt lgkmcnt(9)
    v_mfma_f32_32x32x16_bf16 v[144:159], v[56:59], v[32:35], v[144:159]
    s_add_u32 m0, s99, 112640
    ds_read_b64_tr_b16 v[76:77], v169 offset:128
    ds_read_b64_tr_b16 v[78:79], v169 offset:1408
    buffer_load_dwordx4 v174, s[28:31], s40 offen lds
    s_waitcnt lgkmcnt(8)
    v_mfma_f32_32x32x16_bf16 v[80:95], v[60:63], v[36:39], v[80:95]
    ds_read_b128 v[160:163], v22
    ds_read_b64_tr_b16 v[40:41], v170 offset:0
    ds_read_b64_tr_b16 v[42:43], v170 offset:1280
    s_waitcnt lgkmcnt(9)
    v_mfma_f32_32x32x16_bf16 v[96:111], v[64:67], v[36:39], v[96:111]
    s_add_u32 m0, s99, 113664
    ds_read_b64_tr_b16 v[44:45], v170 offset:32
    ds_read_b64_tr_b16 v[46:47], v170 offset:1312
    buffer_load_dwordx4 v175, s[28:31], s40 offen lds
    s_waitcnt lgkmcnt(9)
    v_mfma_f32_32x32x16_bf16 v[112:127], v[68:71], v[36:39], v[112:127]
    s_add_u32 m0, s99, 114688
    ds_read_b64_tr_b16 v[48:49], v170 offset:64
    ds_read_b64_tr_b16 v[50:51], v170 offset:1344
    buffer_load_dwordx4 v176, s[28:31], s40 offen lds
    s_waitcnt lgkmcnt(9)
    v_mfma_f32_32x32x16_bf16 v[128:143], v[72:75], v[36:39], v[128:143]
    ds_read_b64_tr_b16 v[52:53], v170 offset:96
    ds_read_b64_tr_b16 v[54:55], v170 offset:1376
    s_cmp_lt_u32 s52, 96
    s_cbranch_scc1 no6_3
    s_add_u32 m0, s99, 115712
    s_nop 0
    buffer_load_dwordx4 v177, s[28:31], s40 offen lds
no6_3:
    s_waitcnt lgkmcnt(9)
    v_mfma_f32_32x32x16_bf16 v[144:159], v[76:79], v[36:39], v[144:159]
    ds_read_b64_tr_b16 v[56:57], v170 offset:128
    ds_read_b64_tr_b16 v[58:59], v170 offset:1408
    v_mov_b32 v218, 0
    s_waitcnt lgkmcnt(8)
    v_mfma_f32_32x32x16_bf16 v[80:95], v[40:43], v[160:163], v[80:95]
    ds_read_b128 v[164:167], v23
    ds_read_b64_tr_b16 v[60:61], v171 offset:0
    ds_read_b64_tr_b16 v[62:63], v171 offset:1280
    s_waitcnt lgkmcnt(9)
    v_mfma_f32_32x32x16_bf16 v[96:111], v[44:47], v[160:163], v[96:111]
    ds_read_b64_tr_b16 v[64:65], v171 offset:32
    ds_read_b64_tr_b16 v[66:67], v171 offset:1312
    v_mov_b32 v219, 0
    s_waitcnt lgkmcnt(9)
    v_mfma_f32_32x32x16_bf16 v[112:127], v[48:51], v[160:163], v[112:127]
    ds_read_b64_tr_b16 v[68:69], v171 offset:64
    ds_read_b64_tr_b16 v[70:71], v171 offset:1344
    v_mov_b32 v240, 0
    s_waitcnt lgkmcnt(9)
    v_mfma_f32_32x32x16_bf16 v[128:143], v[52:55], v[160:163], v[128:143]
    ds_read_b64_tr_b16 v[72:73], v171 offset:96
    ds_read_b64_tr_b16 v[74:75], v171 offset:1376
    v_mov_b32 v241, 0
    s_waitcnt lgkmcnt(9)
    v_mfma_f32_32x32x16_bf16 v[144:159], v[56:59], v[160:163], v[144:159]
    ds_read_b64_tr_b16 v[76:77], v171 offset:128
    ds_read_b64_tr_b16 v[78:79], v171 offset:1408
    s_add_u32 s97, s97, 1
    s_cmp_eq_u32 s97, 3
    s_cselect_b32 s57, 4294893568, s98
    s_cselect_b32 s97, 0, s97
    v_add_u32 v20, s57, v20
    v_add_u32 v21, s57, v21
    v_add_u32 v22, s57, v22
    v_add_u32 v23, s57, v23
    v_add_u32 v168, s57, v168
    v_add_u32 v169, s57, v169
    v_add_u32 v170, s57, v170
    v_add_u32 v171, s57, v171
    v_dot2c_f32_bf16 v25, s63, v32
    v_dot2c_f32_bf16 v26, v32, v32
    v_dot2c_f32_bf16 v25, s63, v33
    v_dot2c_f32_bf16 v26, v33, v33
    v_dot2c_f32_bf16 v25, s63, v34
    v_dot2c_f32_bf16 v26, v34, v34
    v_dot2c_f32_bf16 v25, s63, v35
    v_dot2c_f32_bf16 v26, v35, v35
    v_dot2c_f32_bf16 v25, s63, v36
    v_dot2c_f32_bf16 v26, v36, v36
    v_dot2c_f32_bf16 v25, s63, v37
    v_dot2c_f32_bf16 v26, v37, v37
    v_dot2c_f32_bf16 v25, s63, v38
    v_dot2c_f32_bf16 v26, v38, v38
    v_dot2c_f32_bf16 v25, s63, v39
    v_dot2c_f32_bf16 v26, v39, v39
    v_dot2c_f32_bf16 v25, s63, v160
    v_dot2c_f32_bf16 v26, v160, v160
    v_dot2c_f32_bf16 v25, s63, v161
    v_dot2c_f32_bf16 v26, v161, v161
    v_dot2c_f32_bf16 v25, s63, v162
    v_dot2c_f32_bf16 v26, v162, v162
    v_dot2c_f32_bf16 v25, s63, v163
    v_dot2c_f32_bf16 v26, v163, v163
    s_waitcnt lgkmcnt(0)
    v_dot2c_f32_bf16 v25, s63, v164
    v_dot2c_f32_bf16 v26, v164, v164
    v_dot2c_f32_bf16 v25, s63, v165
    v_dot2c_f32_bf16 v26, v165, v165
    v_dot2c_f32_bf16 v25, s63, v166
    v_dot2c_f32_bf16 v26, v166, v166
    v_dot2c_f32_bf16 v25, s63, v167
    v_dot2c_f32_bf16 v26, v167, v167
    v_dot2c_f32_bf16 v27, s63, v60
    v_dot2c_f32_bf16 v28, s63, v64
    v_dot2c_f32_bf16 v29, s63, v68
    v_dot2c_f32_bf16 v30, s63, v72
    v_dot2c_f32_bf16 v31, s63, v76
    v_dot2c_f32_bf16 v27, s63, v61
    v_dot2c_f32_bf16 v28, s63, v65
    v_dot2c_f32_bf16 v29, s63, v69
    v_dot2c_f32_bf16 v30, s63, v73
    v_dot2c_f32_bf16 v31, s63, v77
    v_dot2c_f32_bf16 v27, s63, v62
    v_dot2c_f32_bf16 v28, s63, v66
    v_dot2c_f32_bf16 v29, s63, v70
    v_dot2c_f32_bf16 v30, s63, v74
    v_dot2c_f32_bf16 v31, s63, v78
    v_dot2c_f32_bf16 v27, s63, v63
    v_dot2c_f32_bf16 v28, s63, v67
    v_dot2c_f32_bf16 v29, s63, v71
    v_dot2c_f32_bf16 v30, s63, v75
    v_dot2c_f32_bf16 v31, s63, v79
    s_waitcnt vmcnt(5)
    s_barrier
    v_mfma_f32_32x32x16_bf16 v[80:95], v[60:63], v[164:167], v[80:95]
    ds_read_b128 v[32:35], v20
    ds_read_b64_tr_b16 v[40:41], v168 offset:0
    ds_read_b64_tr_b16 v[42:43], v168 offset:1280
    v_mfma_f32_32x32x16_bf16 v[96:111], v[64:67], v[164:167], v[96:111]
    ds_read_b64_tr_b16 v[44:45], v168 offset:32
    ds_read_b64_tr_b16 v[46:47], v168 offset:1312
    v_mfma_f32_32x32x16_bf16 v[112:127], v[68:71], v[164:167], v[112:127]
    ds_read_b64_tr_b16 v[48:49], v168 offset:64
    ds_read_b64_tr_b16 v[50:51], v168 offset:1344
    v_mfma_f32_32x32x16_bf16 v[128:143], v[72:75], v[164:167], v[128:143]
    ds_read_b64_tr_b16 v[52:53], v168 offset:96
    ds_read_b64_tr_b16 v[54:55], v168 offset:1376
    v_mfma_f32_32x32x16_bf16 v[144:159], v[76:79], v[164:167], v[144:159]
    ds_read_b64_tr_b16 v[56:57], v168 offset:128
    ds_read_b64_tr_b16 v[58:59], v168 offset:1408
    buffer_load_dword v197, v199, s[12:15], 0 offen sc1
    s_waitcnt lgkmcnt(8)
    v_mfma_f32_32x32x16_bf16 v[80:95], v[40:43], v[32:35], v[80:95]
    ds_read_b128 v[36:39], v21
    ds_read_b64_tr_b16 v[60:61], v169 offset:0
    ds_read_b64_tr_b16 v[62:63], v169 offset:1280
    s_waitcnt lgkmcnt(9)
    v_mfma_f32_32x32x16_bf16 v[96:111], v[44:47], v[32:35], v[96:111]
    ds_read_b64_tr_b16 v[64:65], v169 offset:32
    ds_read_b64_tr_b16 v[66:67], v169 offset:1312
    s_waitcnt lgkmcnt(9)
    v_mfma_f32_32x32x16_bf16 v[112:127], v[48:51], v[32:35], v[112:127]
    ds_read_b64_tr_b16 v[68:69], v169 offset:64
    ds_read_b64_tr_b16 v[70:71], v169 offset:1344
    s_waitcnt lgkmcnt(9)
    v_mfma_f32_32x32x16_bf16 v[128:143], v[52:55], v[32:35], v[128:143]
    ds_read_b64_tr_b16 v[72:73], v169 offset:96
    ds_read_b64_tr_b16 v[74:75], v169 offset:1376
    s_waitcnt lgkmcnt(9)
    v_mfma_f32_32x32x16_bf16 v[144:159], v[56:59], v[32:35], v[144:159]
    ds_read_b64_tr_b16 v[76:77], v169 offset:128
    ds_read_b64_tr_b16 v[78:79], v169 offset:1408
    s_waitcnt lgkmcnt(8)
    v_mfma_f32_32x32x16_bf16 v[80:95], v[60:63], v[36:39], v[80:95]
    ds_read_b128 v[160:163], v22
    ds_read_b64_tr_b16 v[40:41], v170 offset:0
    ds_read_b64_tr_b16 v[42:43], v170 offset:1280
    s_waitcnt lgkmcnt(9)
    v_mfma_f32_32x32x16_bf16 v[96:111], v[64:67], v[36:39], v[96:111]
    ds_read_b64_tr_b16 v[44:45], v170 offset:32
    ds_read_b64_tr_b16 v[46:47], v170 offset:1312
    s_waitcnt lgkmcnt(9)
    v_mfma_f32_32x32x16_bf16 v[112:127], v[68:71], v[36:39], v[112:127]
    ds_read_b64_tr_b16 v[48:49], v170 offset:64
    ds_read_b64_tr_b16 v[50:51], v170 offset:1344
    s_waitcnt lgkmcnt(9)
    v_mfma_f32_32x32x16_bf16 v[128:143], v[72:75], v[36:39], v[128:143]
    ds_read_b64_tr_b16 v[52:53], v170 offset:96
    ds_read_b64_tr_b16 v[54:55], v170 offset:1376
    s_waitcnt lgkmcnt(9)
    v_mfma_f32_32x32x16_bf16 v[144:159], v[76:79], v[36:39], v[144:159]
    ds_read_b64_tr_b16 v[56:57], v170 offset:128
    ds_read_b64_tr_b16 v[58:59], v170 offset:1408
    s_waitcnt lgkmcnt(8)
    v_mfma_f32_32x32x16_bf16 v[80:95], v[40:43], v[160:163], v[80:95]
    ds_read_b128 v[164:167], v23
    ds_read_b64_tr_b16 v[60:61], v171 offset:0
    ds_read_b64_tr_b16 v[62:63], v171 offset:1280
    s_waitcnt lgkmcnt(9)
    v_mfma_f32_32x32x16_bf16 v[96:111], v[44:47], v[160:163], v[96:111]
    ds_read_b64_tr_b16 v[64:65], v171 offset:32
    ds_read_b64_tr_b16 v[66:67], v171 offset:1312
    s_waitcnt lgkmcnt(9)
    v_mfma_f32_32x32x16_bf16 v[112:127], v[48:51], v[160:163], v[112:127]
    ds_read_b64_tr_b16 v[68:69], v171 offset:64
    ds_read_b64_tr_b16 v[70:71], v171 offset:1344
    s_waitcnt lgkmcnt(9)
    v_mfma_f32_32x32x16_bf16 v[128:143], v[52:55], v[160:163], v[128:143]
    ds_read_b64_tr_b16 v[72:73], v171 offset:96
    ds_read_b64_tr_b16 v[74:75], v171 offset:1376
    s_waitcnt lgkmcnt(9)
    v_mfma_f32_32x32x16_bf16 v[144:159], v[56:59], v[160:163], v[144:159]
    ds_read_b64_tr_b16 v[76:77], v171 offset:128
    ds_read_b64_tr_b16 v[78:79], v171 offset:1408
    s_add_u32 s97, s97, 1
    s_cmp_eq_u32 s97, 3
    s_cselect_b32 s57, 4294893568, s98
    s_cselect_b32 s97, 0, s97
    v_add_u32 v20, s57, v20
    v_add_u32 v21, s57, v21
    v_add_u32 v22, s57, v22
    v_add_u32 v23, s57, v23
    v_add_u32 v168, s57, v168
    v_add_u32 v169, s57, v169
    v_add_u32 v170, s57, v170
    v_add_u32 v171, s57, v171
    v_dot2c_f32_bf16 v25, s63, v32
    v_dot2c_f32_bf16 v26, v32, v32
    v_dot2c_f32_bf16 v25, s63, v33
    v_dot2c_f32_bf16 v26, v33, v33
    v_dot2c_f32_bf16 v25, s63, v34
    v_dot2c_f32_bf16 v26, v34, v34
    v_dot2c_f32_bf16 v25, s63, v35
    v_dot2c_f32_bf16 v26, v35, v35
    v_dot2c_f32_bf16 v25, s63, v36
    v_dot2c_f32_bf16 v26, v36, v36
    v_dot2c_f32_bf16 v25, s63, v37
    v_dot2c_f32_bf16 v26, v37, v37
    v_dot2c_f32_bf16 v25, s63, v38
    v_dot2c_f32_bf16 v26, v38, v38
    v_dot2c_f32_bf16 v25, s63, v39
    v_dot2c_f32_bf16 v26, v39, v39
    v_dot2c_f32_bf16 v25, s63, v160
    v_dot2c_f32_bf16 v26, v160, v160
    v_dot2c_f32_bf16 v25, s63, v161
    v_dot2c_f32_bf16 v26, v161, v161
    v_dot2c_f32_bf16 v25, s63, v162
    v_dot2c_f32_bf16 v26, v162, v162
    v_dot2c_f32_bf16 v25, s63, v163
    v_dot2c_f32_bf16 v26, v163, v163
    s_waitcnt lgkmcnt(0)
    v_dot2c_f32_bf16 v25, s63, v164
    v_dot2c_f32_bf16 v26, v164, v164
    v_dot2c_f32_bf16 v25, s63, v165
    v_dot2c_f32_bf16 v26, v165, v165
    v_dot2c_f32_bf16 v25, s63, v166
    v_dot2c_f32_bf16 v26, v166, v166
    v_dot2c_f32_bf16 v25, s63, v167
    v_dot2c_f32_bf16 v26, v167, v167
    v_dot2c_f32_bf16 v27, s63, v60
    v_dot2c_f32_bf16 v28, s63, v64
    v_dot2c_f32_bf16 v29, s63, v68
    v_dot2c_f32_bf16 v30, s63, v72
    v_dot2c_f32_bf16 v31, s63, v76
    v_dot2c_f32_bf16 v27, s63, v61
    v_dot2c_f32_bf16 v28, s63, v65
    v_dot2c_f32_bf16 v29, s63, v69
    v_dot2c_f32_bf16 v30, s63, v73
    v_dot2c_f32_bf16 v31, s63, v77
    v_dot2c_f32_bf16 v27, s63, v62
    v_dot2c_f32_bf16 v28, s63, v66
    v_dot2c_f32_bf16 v29, s63, v70
    v_dot2c_f32_bf16 v30, s63, v74
    v_dot2c_f32_bf16 v31, s63, v78
    v_dot2c_f32_bf16 v27, s63, v63
    v_dot2c_f32_bf16 v28, s63, v67
    v_dot2c_f32_bf16 v29, s63, v71
    v_dot2c_f32_bf16 v30, s63, v75
    v_dot2c_f32_bf16 v31, s63, v79
    v_mfma_f32_32x32x16_bf16 v[80:95], v[60:63], v[164:167], v[80:95]
    ds_read_b64_tr_b16 v[208:209], v200 offset:0
    ds_read_b64_tr_b16 v[210:211], v200 offset:160
    ds_read_b64_tr_b16 v[212:213], v200 offset:320
    ds_read_b64_tr_b16 v[214:215], v200 offset:480
    v_mfma_f32_32x32x16_bf16 v[96:111], v[64:67], v[164:167], v[96:111]
    ds_read_b64_tr_b16 v[216:217], v200 offset:640
    ds_read_b64_tr_b16 v[220:221], v201 offset:0
    ds_read_b64_tr_b16 v[222:223], v201 offset:160
    ds_read_b64_tr_b16 v[224:225], v201 offset:320
    v_mfma_f32_32x32x16_bf16 v[112:127], v[68:71], v[164:167], v[112:127]
    ds_read_b64_tr_b16 v[226:227], v201 offset:480
    ds_read_b64_tr_b16 v[228:229], v201 offset:640
    ds_read_b64_tr_b16 v[230:231], v202 offset:0
    ds_read_b64_tr_b16 v[232:233], v202 offset:160
    v_mfma_f32_32x32x16_bf16 v[128:143], v[72:75], v[164:167], v[128:143]
    v_mfma_f32_32x32x16_bf16 v[144:159], v[76:79], v[164:167], v[144:159]
    s_mov_b32 s24, s12
    s_mov_b32 s25, s13
    s_mov_b32 s26, s14
    s_mov_b32 s27, 0x00020000
    s_waitcnt vmcnt(0)
    v_readfirstlane_b32 s57, v196
    v_cmp_gt_u32 vcc, 16, v197
    s_nop 0
    s_xor_b32 s57, s57, 1
    s_and_b32 s58, vcc_lo, 0xff
    s_or_b32 s57, s57, s58
    s_cbranch_scc1 slow_6
fast_7:
    v_mov_b32 v180, v25
    v_mov_b32 v181, v26
    v_and_b32 v4, 31, v1
    v_lshlrev_b32 v4, 2, v4
    v_lshrrev_b32 v6, 5, v1
    s_lshl_b32 s57, s42, 9
    s_add_u32 s57, s57, 152832
    v_lshl_add_u32 v5, v6, 8, v4
    v_add_u32 v5, s57, v5
    v_cvt_pk_bf16_f32 v40, v27, v27
    v_and_b32 v40, 0xffff0000, v40
    v_sub_f32 v40, v27, v40
    v_cvt_pk_bf16_f32 v40, v27, v40
    s_waitcnt lgkmcnt(6)
    ds_write_b32 v5, v40 offset:0
    v_cvt_pk_bf16_f32 v41, v28, v28
    v_and_b32 v41, 0xffff0000, v41
    v_sub_f32 v41, v28, v41
    v_cvt_pk_bf16_f32 v41, v28, v41
    ds_write_b32 v5, v41 offset:2048
    v_cvt_pk_bf16_f32 v42, v29, v29
    v_and_b32 v42, 0xffff0000, v42
    v_sub_f32 v42, v29, v42
    v_cvt_pk_bf16_f32 v42, v29, v42
    ds_write_b32 v5, v42 offset:4096
    v_cvt_pk_bf16_f32 v43, v30, v30
    v_and_b32 v43, 0xffff0000, v43
    v_sub_f32 v43, v30, v43
    v_cvt_pk_bf16_f32 v43, v30, v43
    ds_write_b32 v5, v43 offset:6144
    v_cvt_pk_bf16_f32 v44, v31, v31
    v_and_b32 v44, 0xffff0000, v44
    v_sub_f32 v44, v31, v44
    v_cvt_pk_bf16_f32 v44, v31, v44
    ds_write_b32 v5, v44 offset:8192
    v_permlane32_swap_b32 v180, v25
    v_permlane32_swap_b32 v181, v26
    v_lshl_add_u32 v4, v6, 10, v4
    v_add_u32 v4, 152832, v4
    s_waitcnt lgkmcnt(0)
    s_barrier
    ds_read2st64_b32 v[40:41], v4 offset0:0 offset1:1
    ds_read2st64_b32 v[42:43], v4 offset0:2 offset1:3
    ds_read2st64_b32 v[44:45], v4 offset0:8 offset1:9
    ds_read2st64_b32 v[46:47], v4 offset0:10 offset1:11
    ds_read2st64_b32 v[48:49], v4 offset0:16 offset1:17
    ds_read2st64_b32 v[50:51], v4 offset0:18 offset1:19
    ds_read2st64_b32 v[52:53], v4 offset0:24 offset1:25
    ds_read2st64_b32 v[54:55], v4 offset0:26 offset1:27
    ds_read2st64_b32 v[56:57], v4 offset0:32 offset1:33
    ds_read2st64_b32 v[58:59], v4 offset0:34 offset1:35
    v_add_f32 v25, v25, v180
    v_add_f32 v7, v26, v181
    v_mul_f32 v9, 0xbacccccd, v25
    v_cvt_pk_bf16_f32 v32, v9, v9
    v_mul_f32 v2, 0x3acccccd, v7
    v_mov_b32 v33, v32
    v_mov_b32 v34, v32
    v_mov_b32 v35, v32
    v_fma_f32 v2, -v9, v9, v2
    v_max_f32 v2, 0, v2
    v_add_f32 v2, 0x3727c5ac, v2
    v_rsq_f32 v2, v2
    s_waitcnt lgkmcnt(8)
    v_mfma_f32_32x32x16_bf16 v[80:95], v[40:43], v[32:35], v[80:95]
    ds_read_b64_tr_b16 v[234:235], v202 offset:320
    ds_read_b64_tr_b16 v[236:237], v202 offset:480
    s_waitcnt lgkmcnt(8)
    v_mfma_f32_32x32x16_bf16 v[96:111], v[44:47], v[32:35], v[96:111]
    ds_read_b64_tr_b16 v[238:239], v202 offset:640
    ds_read_b64_tr_b16 v[242:243], v203 offset:0
    s_waitcnt lgkmcnt(8)
    v_mfma_f32_32x32x16_bf16 v[112:127], v[48:51], v[32:35], v[112:127]
    ds_read_b64_tr_b16 v[244:245], v203 offset:160
    ds_read_b64_tr_b16 v[246:247], v203 offset:320
    s_waitcnt lgkmcnt(8)
    v_mfma_f32_32x32x16_bf16 v[128:143], v[52:55], v[32:35], v[128:143]
    ds_read_b64_tr_b16 v[248:249], v203 offset:480
    s_waitcnt lgkmcnt(7)
    v_mfma_f32_32x32x16_bf16 v[144:159], v[56:59], v[32:35], v[144:159]
    ds_read_b64_tr_b16 v[250:251], v203 offset:640
    v_lshlrev_b32 v10, 4, v1
    v_pk_mul_f32 v[80:81], v[80:81], v[2:3] op_sel_hi:[1,0]
    v_pk_mul_f32 v[82:83], v[82:83], v[2:3] op_sel_hi:[1,0]
    v_pk_mul_f32 v[84:85], v[84:85], v[2:3] op_sel_hi:[1,0]
    v_pk_mul_f32 v[86:87], v[86:87], v[2:3] op_sel_hi:[1,0]
    v_pk_mul_f32 v[88:89], v[88:89], v[2:3] op_sel_hi:[1,0]
    v_pk_mul_f32 v[90:91], v[90:91], v[2:3] op_sel_hi:[1,0]
    v_pk_mul_f32 v[92:93], v[92:93], v[2:3] op_sel_hi:[1,0]
    v_pk_mul_f32 v[94:95], v[94:95], v[2:3] op_sel_hi:[1,0]
    v_pk_mul_f32 v[96:97], v[96:97], v[2:3] op_sel_hi:[1,0]
    v_pk_mul_f32 v[98:99], v[98:99], v[2:3] op_sel_hi:[1,0]
    v_pk_mul_f32 v[100:101], v[100:101], v[2:3] op_sel_hi:[1,0]
    v_pk_mul_f32 v[102:103], v[102:103], v[2:3] op_sel_hi:[1,0]
    v_pk_mul_f32 v[104:105], v[104:105], v[2:3] op_sel_hi:[1,0]
    v_pk_mul_f32 v[106:107], v[106:107], v[2:3] op_sel_hi:[1,0]
    v_pk_mul_f32 v[108:109], v[108:109], v[2:3] op_sel_hi:[1,0]
    v_pk_mul_f32 v[110:111], v[110:111], v[2:3] op_sel_hi:[1,0]
    v_pk_mul_f32 v[112:113], v[112:113], v[2:3] op_sel_hi:[1,0]
    v_pk_mul_f32 v[114:115], v[114:115], v[2:3] op_sel_hi:[1,0]
    v_pk_mul_f32 v[116:117], v[116:117], v[2:3] op_sel_hi:[1,0]
    v_pk_mul_f32 v[118:119], v[118:119], v[2:3] op_sel_hi:[1,0]
    v_cvt_pk_bf16_f32 v40, v80, v81
    v_cvt_pk_bf16_f32 v41, v82, v83
    v_cvt_pk_bf16_f32 v42, v84, v85
    v_cvt_pk_bf16_f32 v43, v86, v87
    v_cvt_pk_bf16_f32 v44, v88, v89
    v_cvt_pk_bf16_f32 v45, v90, v91
    v_cvt_pk_bf16_f32 v46, v92, v93
    v_cvt_pk_bf16_f32 v47, v94, v95
    v_cvt_pk_bf16_f32 v48, v96, v97
    v_cvt_pk_bf16_f32 v49, v98, v99
    v_cvt_pk_bf16_f32 v50, v100, v101
    v_cvt_pk_bf16_f32 v51, v102, v103
    v_cvt_pk_bf16_f32 v52, v104, v105
    v_cvt_pk_bf16_f32 v53, v106, v107
    v_cvt_pk_bf16_f32 v54, v108, v109
    v_cvt_pk_bf16_f32 v55, v110, v111
    v_cvt_pk_bf16_f32 v56, v112, v113
    v_cvt_pk_bf16_f32 v57, v114, v115
    v_cvt_pk_bf16_f32 v58, v116, v117
    v_cvt_pk_bf16_f32 v59, v118, v119
    s_waitcnt lgkmcnt(0)
    v_mfma_f32_32x32x16_bf16 v[160:175], v[208:211], v[40:43], 0
    v_mul_f32 v120, v120, v2
    v_mul_f32 v121, v121, v2
    v_mul_f32 v122, v122, v2
    v_mul_f32 v123, v123, v2
    v_mul_f32 v124, v124, v2
    v_mul_f32 v125, v125, v2
    v_mfma_f32_32x32x16_bf16 v[176:191], v[220:223], v[40:43], 0
    v_mul_f32 v126, v126, v2
    v_mul_f32 v127, v127, v2
    v_mul_f32 v128, v128, v2
    v_mul_f32 v129, v129, v2
    v_mul_f32 v130, v130, v2
    v_mul_f32 v131, v131, v2
    v_mfma_f32_32x32x16_bf16 v[160:175], v[212:215], v[44:47], v[160:175]
    v_mul_f32 v132, v132, v2
    v_mul_f32 v133, v133, v2
    v_mul_f32 v134, v134, v2
    v_mul_f32 v135, v135, v2
    v_mul_f32 v136, v136, v2
    v_mul_f32 v137, v137, v2
    v_mfma_f32_32x32x16_bf16 v[176:191], v[224:227], v[44:47], v[176:191]
    v_mul_f32 v138, v138, v2
    v_mul_f32 v139, v139, v2
    v_cvt_pk_bf16_f32 v60, v120, v121
    v_cvt_pk_bf16_f32 v61, v122, v123
    v_cvt_pk_bf16_f32 v62, v124, v125
    v_cvt_pk_bf16_f32 v63, v126, v127
    v_mfma_f32_32x32x16_bf16 v[160:175], v[216:219], v[48:51], v[160:175]
    v_cvt_pk_bf16_f32 v64, v128, v129
    v_cvt_pk_bf16_f32 v65, v130, v131
    v_cvt_pk_bf16_f32 v66, v132, v133
    v_cvt_pk_bf16_f32 v67, v134, v135
    v_cvt_pk_bf16_f32 v68, v136, v137
    v_cvt_pk_bf16_f32 v69, v138, v139
    v_mfma_f32_32x32x16_bf16 v[192:207], v[240:243], v[48:51], 0
    v_mov_b32 v70, 0x3f80
    v_mov_b32 v71, 0
    v_mul_f32 v140, v140, v2
    v_mul_f32 v141, v141, v2
    v_mul_f32 v142, v142, v2
    v_mul_f32 v143, v143, v2
    v_mfma_f32_32x32x16_bf16 v[176:191], v[228:231], v[48:51], v[176:191]
    v_mul_f32 v144, v144, v2
    v_mul_f32 v145, v145, v2
    v_mul_f32 v146, v146, v2
    v_mul_f32 v147, v147, v2
    v_mul_f32 v148, v148, v2
    v_mul_f32 v149, v149, v2
    v_mfma_f32_32x32x16_bf16 v[192:207], v[244:247], v[52:55], v[192:207]
    v_mul_f32 v150, v150, v2
    v_mul_f32 v151, v151, v2
    v_mul_f32 v152, v152, v2
    v_mul_f32 v153, v153, v2
    v_mul_f32 v154, v154, v2
    v_mul_f32 v155, v155, v2
    v_mfma_f32_32x32x16_bf16 v[176:191], v[232:235], v[52:55], v[176:191]
    v_mul_f32 v156, v156, v2
    v_mul_f32 v157, v157, v2
    v_mul_f32 v158, v158, v2
    v_mul_f32 v159, v159, v2
    v_cvt_pk_bf16_f32 v72, v140, v141
    v_cvt_pk_bf16_f32 v73, v142, v143
    v_mfma_f32_32x32x16_bf16 v[192:207], v[248:251], v[56:59], v[192:207]
    v_cvt_pk_bf16_f32 v74, v144, v145
    v_cvt_pk_bf16_f32 v75, v146, v147
    v_cvt_pk_bf16_f32 v76, v148, v149
    v_cvt_pk_bf16_f32 v77, v150, v151
    v_cvt_pk_bf16_f32 v78, v152, v153
    v_cvt_pk_bf16_f32 v79, v154, v155
    v_mfma_f32_32x32x16_bf16 v[176:191], v[236:239], v[56:59], v[176:191]
    v_cvt_pk_bf16_f32 v80, v156, v157
    v_cvt_pk_bf16_f32 v81, v158, v159
    v_mov_b32 v82, 0x3f80
    v_mov_b32 v83, 0
    v_max3_f32 v32, v160, v161, v162
    v_min3_f32 v33, v160, v161, v162
    v_max3_f32 v32, v32, v163, v164
    v_min3_f32 v33, v33, v163, v164
    v_max3_f32 v32, v32, v165, v166
    v_min3_f32 v33, v33, v165, v166
    v_max3_f32 v32, v32, v167, v168
    v_min3_f32 v33, v33, v167, v168
    v_xor_b32 v7, 80, v254
    ds_write_b128 v7, v[60:63]
    v_max3_f32 v32, v32, v169, v170
    v_min3_f32 v33, v33, v169, v170
    v_max3_f32 v32, v32, v171, v172
    v_min3_f32 v33, v33, v171, v172
    v_max3_f32 v32, v32, v173, v174
    v_min3_f32 v33, v33, v173, v174
    v_max3_f32 v32, v32, v175, v176
    v_min3_f32 v33, v33, v175, v176
    s_lshl_b32 s101, s51, 2
    s_add_u32 s101, s101, s42
    s_mul_i32 s101, s101, 61440
    s_add_u32 s101, s101, 1048576
    buffer_load_dwordx4 a[0:3], v10, s[24:27], s101 offen offset:0 sc1
    v_max3_f32 v32, v32, v177, v178
    v_min3_f32 v33, v33, v177, v178
    v_max_f32 v32, v32, v179
    v_min_f32 v33, v33, v179
    v_mul_f32 v32, 0xbfb8aa3b, v32
    v_mul_f32 v33, 0x3fb8aa3b, v33
    v_pk_fma_f32 v[84:85], v[160:161], s[66:67], v[32:33] op_sel_hi:[1,1,0]
    v_pk_fma_f32 v[160:161], v[160:161], s[66:67], v[32:33] op_sel:[0,0,1] op_sel_hi:[1,1,1] neg_lo:[1,0,0] neg_hi:[1,0,0]
    buffer_load_dwordx4 a[4:7], v10, s[24:27], s101 offen offset:1024 sc1
    v_pk_fma_f32 v[86:87], v[162:163], s[66:67], v[32:33] op_sel_hi:[1,1,0]
    v_pk_fma_f32 v[162:163], v[162:163], s[66:67], v[32:33] op_sel:[0,0,1] op_sel_hi:[1,1,1] neg_lo:[1,0,0] neg_hi:[1,0,0]
    v_pk_fma_f32 v[88:89], v[164:165], s[66:67], v[32:33] op_sel_hi:[1,1,0]
    v_pk_fma_f32 v[164:165], v[164:165], s[66:67], v[32:33] op_sel:[0,0,1] op_sel_hi:[1,1,1] neg_lo:[1,0,0] neg_hi:[1,0,0]
    v_pk_fma_f32 v[90:91], v[166:167], s[66:67], v[32:33] op_sel_hi:[1,1,0]
    v_pk_fma_f32 v[166:167], v[166:167], s[66:67], v[32:33] op_sel:[0,0,1] op_sel_hi:[1,1,1] neg_lo:[1,0,0] neg_hi:[1,0,0]
    v_pk_fma_f32 v[92:93], v[168:169], s[66:67], v[32:33] op_sel_hi:[1,1,0]
    v_pk_fma_f32 v[168:169], v[168:169], s[66:67], v[32:33] op_sel:[0,0,1] op_sel_hi:[1,1,1] neg_lo:[1,0,0] neg_hi:[1,0,0]
    v_xor_b32 v6, 96, v254
    ds_write_b128 v6, v[64:67]
    v_pk_fma_f32 v[94:95], v[170:171], s[66:67], v[32:33] op_sel_hi:[1,1,0]
    v_pk_fma_f32 v[170:171], v[170:171], s[66:67], v[32:33] op_sel:[0,0,1] op_sel_hi:[1,1,1] neg_lo:[1,0,0] neg_hi:[1,0,0]
    v_pk_fma_f32 v[96:97], v[172:173], s[66:67], v[32:33] op_sel_hi:[1,1,0]
    v_pk_fma_f32 v[172:173], v[172:173], s[66:67], v[32:33] op_sel:[0,0,1] op_sel_hi:[1,1,1] neg_lo:[1,0,0] neg_hi:[1,0,0]
    v_pk_fma_f32 v[98:99], v[174:175], s[66:67], v[32:33] op_sel_hi:[1,1,0]
    v_pk_fma_f32 v[174:175], v[174:175], s[66:67], v[32:33] op_sel:[0,0,1] op_sel_hi:[1,1,1] neg_lo:[1,0,0] neg_hi:[1,0,0]
    v_pk_fma_f32 v[100:101], v[176:177], s[66:67], v[32:33] op_sel_hi:[1,1,0]
    v_pk_fma_f32 v[176:177], v[176:177], s[66:67], v[32:33] op_sel:[0,0,1] op_sel_hi:[1,1,1] neg_lo:[1,0,0] neg_hi:[1,0,0]
    buffer_load_dwordx4 a[8:11], v10, s[24:27], s101 offen offset:2048 sc1
    v_pk_fma_f32 v[102:103], v[178:179], s[66:67], v[32:33] op_sel_hi:[1,1,0]
    v_pk_fma_f32 v[178:179], v[178:179], s[66:67], v[32:33] op_sel:[0,0,1] op_sel_hi:[1,1,1] neg_lo:[1,0,0] neg_hi:[1,0,0]
    v_exp_f32_e64 v84, v84
    v_exp_f32_e64 v160, v160
    v_exp_f32_e64 v85, v85
    v_exp_f32_e64 v161, v161
    v_exp_f32_e64 v86, v86
    v_exp_f32_e64 v162, v162
    v_xor_b32 v7, 112, v254
    ds_write_b128 v7, v[68:71]
    v_exp_f32_e64 v87, v87
    v_exp_f32_e64 v163, v163
    v_exp_f32_e64 v88, v88
    v_exp_f32_e64 v164, v164
    v_exp_f32_e64 v89, v89
    v_exp_f32_e64 v165, v165
    v_exp_f32_e64 v90, v90
    v_exp_f32_e64 v166, v166
    v_xor_b32 v7, 208, v254
    ds_write_b128 v7, v[72:75]
    v_exp_f32_e64 v91, v91
    v_exp_f32_e64 v167, v167
    v_exp_f32_e64 v92, v92
    v_exp_f32_e64 v168, v168
    v_exp_f32_e64 v93, v93
    v_exp_f32_e64 v169, v169
    v_exp_f32_e64 v94, v94
    v_exp_f32_e64 v170, v170
    v_xor_b32 v6, 224, v254
    ds_write_b128 v6, v[76:79]
    v_exp_f32_e64 v95, v95
    v_exp_f32_e64 v171, v171
    v_exp_f32_e64 v96, v96
    v_exp_f32_e64 v172, v172
    v_exp_f32_e64 v97, v97
    v_exp_f32_e64 v173, v173
    v_exp_f32_e64 v98, v98
    v_exp_f32_e64 v174, v174
    v_xor_b32 v7, 240, v254
    ds_write_b128 v7, v[80:83]
    v_exp_f32_e64 v99, v99
    v_exp_f32_e64 v175, v175
    v_exp_f32_e64 v100, v100
    v_exp_f32_e64 v176, v176
    v_exp_f32_e64 v101, v101
    v_exp_f32_e64 v177, v177
    v_exp_f32_e64 v102, v102
    v_exp_f32_e64 v178, v178
    v_exp_f32_e64 v103, v103
    v_exp_f32_e64 v179, v179
    v_pk_add_f32 v[32:33], v[84:85], v[86:87]
    v_pk_add_f32 v[34:35], v[160:161], v[162:163]
    v_pk_add_f32 v[32:33], v[32:33], v[88:89]
    v_pk_add_f32 v[34:35], v[34:35], v[164:165]
    v_pk_add_f32 v[32:33], v[32:33], v[90:91]
    v_pk_add_f32 v[34:35], v[34:35], v[166:167]
    v_pk_add_f32 v[32:33], v[32:33], v[92:93]
    v_pk_add_f32 v[34:35], v[34:35], v[168:169]
    v_pk_add_f32 v[32:33], v[32:33], v[94:95]
    v_pk_add_f32 v[34:35], v[34:35], v[170:171]
    v_pk_add_f32 v[32:33], v[32:33], v[96:97]
    v_pk_add_f32 v[34:35], v[34:35], v[172:173]
    v_pk_add_f32 v[32:33], v[32:33], v[98:99]
    v_pk_add_f32 v[34:35], v[34:35], v[174:175]
    v_pk_add_f32 v[32:33], v[32:33], v[100:101]
    v_pk_add_f32 v[34:35], v[34:35], v[176:177]
    v_pk_add_f32 v[32:33], v[32:33], v[102:103]
    v_pk_add_f32 v[34:35], v[34:35], v[178:179]
    v_add_f32 v32, v32, v33
    v_add_f32 v34, v34, v35
    v_rcp_f32 v32, v32
    v_rcp_f32 v34, v34
    v_pk_mul_f32 v[84:85], v[84:85], v[32:33] op_sel_hi:[1,0]
    v_pk_mul_f32 v[86:87], v[86:87], v[32:33] op_sel_hi:[1,0]
    v_pk_mul_f32 v[88:89], v[88:89], v[32:33] op_sel_hi:[1,0]
    v_pk_mul_f32 v[90:91], v[90:91], v[32:33] op_sel_hi:[1,0]
    v_pk_mul_f32 v[92:93], v[92:93], v[32:33] op_sel_hi:[1,0]
    v_pk_mul_f32 v[94:95], v[94:95], v[32:33] op_sel_hi:[1,0]
    v_pk_mul_f32 v[96:97], v[96:97], v[32:33] op_sel_hi:[1,0]
    v_pk_mul_f32 v[98:99], v[98:99], v[32:33] op_sel_hi:[1,0]
    v_pk_mul_f32 v[100:101], v[100:101], v[32:33] op_sel_hi:[1,0]
    v_pk_mul_f32 v[102:103], v[102:103], v[32:33] op_sel_hi:[1,0]
    v_cvt_pk_bf16_f32 v208, v84, v85
    v_pk_mul_f32 v[160:161], v[160:161], v[34:35] op_sel_hi:[1,0]
    v_cvt_pk_bf16_f32 v209, v86, v87
    v_pk_mul_f32 v[162:163], v[162:163], v[34:35] op_sel_hi:[1,0]
    v_cvt_pk_bf16_f32 v210, v88, v89
    v_pk_mul_f32 v[164:165], v[164:165], v[34:35] op_sel_hi:[1,0]
    v_cvt_pk_bf16_f32 v211, v90, v91
    v_pk_mul_f32 v[166:167], v[166:167], v[34:35] op_sel_hi:[1,0]
    v_cvt_pk_bf16_f32 v212, v92, v93
    v_pk_mul_f32 v[168:169], v[168:169], v[34:35] op_sel_hi:[1,0]
    v_cvt_pk_bf16_f32 v213, v94, v95
    v_pk_mul_f32 v[170:171], v[170:171], v[34:35] op_sel_hi:[1,0]
    v_cvt_pk_bf16_f32 v214, v96, v97
    v_pk_mul_f32 v[172:173], v[172:173], v[34:35] op_sel_hi:[1,0]
    v_cvt_pk_bf16_f32 v215, v98, v99
    v_pk_mul_f32 v[174:175], v[174:175], v[34:35] op_sel_hi:[1,0]
    v_cvt_pk_bf16_f32 v216, v100, v101
    v_pk_mul_f32 v[176:177], v[176:177], v[34:35] op_sel_hi:[1,0]
    v_cvt_pk_bf16_f32 v217, v102, v103
    v_pk_mul_f32 v[178:179], v[178:179], v[34:35] op_sel_hi:[1,0]
    v_cvt_pk_bf16_f32 v218, v160, v161
    v_cvt_pk_bf16_f32 v219, v162, v163
    v_cvt_pk_bf16_f32 v220, v164, v165
    v_cvt_pk_bf16_f32 v221, v166, v167
    v_cvt_pk_bf16_f32 v222, v168, v169
    v_cvt_pk_bf16_f32 v223, v170, v171
    v_cvt_pk_bf16_f32 v224, v172, v173
    v_cvt_pk_bf16_f32 v225, v174, v175
    v_cvt_pk_bf16_f32 v226, v176, v177
    v_cvt_pk_bf16_f32 v227, v178, v179
    v_max3_f32 v36, v180, v181, v182
    v_min3_f32 v37, v180, v181, v182
    v_max3_f32 v36, v36, v183, v184
    v_min3_f32 v37, v37, v183, v184
    v_max3_f32 v36, v36, v185, v186
    v_min3_f32 v37, v37, v185, v186
    v_max3_f32 v36, v36, v187, v188
    v_min3_f32 v37, v37, v187, v188
    v_xor_b32 v6, 0, v254
    ds_write_b128 v6, v[208:211]
    v_max3_f32 v36, v36, v189, v190
    v_min3_f32 v37, v37, v189, v190
    v_max3_f32 v36, v36, v191, v192
    v_min3_f32 v37, v37, v191, v192
    v_max3_f32 v36, v36, v193, v194
    v_min3_f32 v37, v37, v193, v194
    v_max3_f32 v36, v36, v195, v196
    v_min3_f32 v37, v37, v195, v196
    buffer_load_dwordx4 a[12:15], v10, s[24:27], s101 offen offset:3072 sc1
    v_max3_f32 v36, v36, v197, v198
    v_min3_f32 v37, v37, v197, v198
    v_max_f32 v36, v36, v199
    v_min_f32 v37, v37, v199
    v_mul_f32 v36, 0xbfb8aa3b, v36
    v_mul_f32 v37, 0x3fb8aa3b, v37
    v_pk_fma_f32 v[104:105], v[180:181], s[66:67], v[36:37] op_sel_hi:[1,1,0]
    v_pk_fma_f32 v[180:181], v[180:181], s[66:67], v[36:37] op_sel:[0,0,1] op_sel_hi:[1,1,1] neg_lo:[1,0,0] neg_hi:[1,0,0]
    s_add_u32 s101, s101, 4096
    buffer_load_dwordx4 a[16:19], v10, s[24:27], s101 offen offset:0 sc1
    v_pk_fma_f32 v[106:107], v[182:183], s[66:67], v[36:37] op_sel_hi:[1,1,0]
    v_pk_fma_f32 v[182:183], v[182:183], s[66:67], v[36:37] op_sel:[0,0,1] op_sel_hi:[1,1,1] neg_lo:[1,0,0] neg_hi:[1,0,0]
    v_pk_fma_f32 v[108:109], v[184:185], s[66:67], v[36:37] op_sel_hi:[1,1,0]
    v_pk_fma_f32 v[184:185], v[184:185], s[66:67], v[36:37] op_sel:[0,0,1] op_sel_hi:[1,1,1] neg_lo:[1,0,0] neg_hi:[1,0,0]
    v_pk_fma_f32 v[110:111], v[186:187], s[66:67], v[36:37] op_sel_hi:[1,1,0]
    v_pk_fma_f32 v[186:187], v[186:187], s[66:67], v[36:37] op_sel:[0,0,1] op_sel_hi:[1,1,1] neg_lo:[1,0,0] neg_hi:[1,0,0]
    v_pk_fma_f32 v[112:113], v[188:189], s[66:67], v[36:37] op_sel_hi:[1,1,0]
    v_pk_fma_f32 v[188:189], v[188:189], s[66:67], v[36:37] op_sel:[0,0,1] op_sel_hi:[1,1,1] neg_lo:[1,0,0] neg_hi:[1,0,0]
    v_xor_b32 v7, 16, v254
    ds_write_b128 v7, v[212:215]
    v_pk_fma_f32 v[114:115], v[190:191], s[66:67], v[36:37] op_sel_hi:[1,1,0]
    v_pk_fma_f32 v[190:191], v[190:191], s[66:67], v[36:37] op_sel:[0,0,1] op_sel_hi:[1,1,1] neg_lo:[1,0,0] neg_hi:[1,0,0]
    v_pk_fma_f32 v[116:117], v[192:193], s[66:67], v[36:37] op_sel_hi:[1,1,0]
    v_pk_fma_f32 v[192:193], v[192:193], s[66:67], v[36:37] op_sel:[0,0,1] op_sel_hi:[1,1,1] neg_lo:[1,0,0] neg_hi:[1,0,0]
    v_pk_fma_f32 v[118:119], v[194:195], s[66:67], v[36:37] op_sel_hi:[1,1,0]
    v_pk_fma_f32 v[194:195], v[194:195], s[66:67], v[36:37] op_sel:[0,0,1] op_sel_hi:[1,1,1] neg_lo:[1,0,0] neg_hi:[1,0,0]
    v_pk_fma_f32 v[120:121], v[196:197], s[66:67], v[36:37] op_sel_hi:[1,1,0]
    v_pk_fma_f32 v[196:197], v[196:197], s[66:67], v[36:37] op_sel:[0,0,1] op_sel_hi:[1,1,1] neg_lo:[1,0,0] neg_hi:[1,0,0]
    buffer_load_dwordx4 a[20:23], v10, s[24:27], s101 offen offset:1024 sc1
    v_pk_fma_f32 v[122:123], v[198:199], s[66:67], v[36:37] op_sel_hi:[1,1,0]
    v_pk_fma_f32 v[198:199], v[198:199], s[66:67], v[36:37] op_sel:[0,0,1] op_sel_hi:[1,1,1] neg_lo:[1,0,0] neg_hi:[1,0,0]
    v_exp_f32_e64 v104, v104
    v_exp_f32_e64 v180, v180
    v_exp_f32_e64 v105, v105
    v_exp_f32_e64 v181, v181
    v_exp_f32_e64 v106, v106
    v_exp_f32_e64 v182, v182
    v_xor_b32 v6, 32, v254
    ds_write_b128 v6, v[216:219]
    v_exp_f32_e64 v107, v107
    v_exp_f32_e64 v183, v183
    v_exp_f32_e64 v108, v108
    v_exp_f32_e64 v184, v184
    v_exp_f32_e64 v109, v109
    v_exp_f32_e64 v185, v185
    v_exp_f32_e64 v110, v110
    v_exp_f32_e64 v186, v186
    v_xor_b32 v7, 48, v254
    ds_write_b128 v7, v[220:223]
    v_exp_f32_e64 v111, v111
    v_exp_f32_e64 v187, v187
    v_exp_f32_e64 v112, v112
    v_exp_f32_e64 v188, v188
    v_exp_f32_e64 v113, v113
    v_exp_f32_e64 v189, v189
    v_exp_f32_e64 v114, v114
    v_exp_f32_e64 v190, v190
    v_xor_b32 v6, 64, v254
    ds_write_b128 v6, v[224:227]
    v_exp_f32_e64 v115, v115
    v_exp_f32_e64 v191, v191
    v_exp_f32_e64 v116, v116
    v_exp_f32_e64 v192, v192
    v_exp_f32_e64 v117, v117
    v_exp_f32_e64 v193, v193
    v_exp_f32_e64 v118, v118
    v_exp_f32_e64 v194, v194
    v_exp_f32_e64 v119, v119
    v_exp_f32_e64 v195, v195
    v_exp_f32_e64 v120, v120
    v_exp_f32_e64 v196, v196
    v_exp_f32_e64 v121, v121
    v_exp_f32_e64 v197, v197
    v_exp_f32_e64 v122, v122
    v_exp_f32_e64 v198, v198
    v_exp_f32_e64 v123, v123
    v_exp_f32_e64 v199, v199
    v_pk_add_f32 v[36:37], v[104:105], v[106:107]
    v_pk_add_f32 v[38:39], v[180:181], v[182:183]
    v_pk_add_f32 v[36:37], v[36:37], v[108:109]
    v_pk_add_f32 v[38:39], v[38:39], v[184:185]
    v_pk_add_f32 v[36:37], v[36:37], v[110:111]
    v_pk_add_f32 v[38:39], v[38:39], v[186:187]
    v_pk_add_f32 v[36:37], v[36:37], v[112:113]
    v_pk_add_f32 v[38:39], v[38:39], v[188:189]
    v_pk_add_f32 v[36:37], v[36:37], v[114:115]
    v_pk_add_f32 v[38:39], v[38:39], v[190:191]
    v_pk_add_f32 v[36:37], v[36:37], v[116:117]
    v_pk_add_f32 v[38:39], v[38:39], v[192:193]
    v_pk_add_f32 v[36:37], v[36:37], v[118:119]
    v_pk_add_f32 v[38:39], v[38:39], v[194:195]
    v_pk_add_f32 v[36:37], v[36:37], v[120:121]
    v_pk_add_f32 v[38:39], v[38:39], v[196:197]
    v_pk_add_f32 v[36:37], v[36:37], v[122:123]
    v_pk_add_f32 v[38:39], v[38:39], v[198:199]
    v_add_f32 v36, v36, v37
    v_add_f32 v38, v38, v39
    v_rcp_f32 v36, v36
    v_rcp_f32 v38, v38
    v_pk_mul_f32 v[104:105], v[104:105], v[36:37] op_sel_hi:[1,0]
    v_pk_mul_f32 v[106:107], v[106:107], v[36:37] op_sel_hi:[1,0]
    v_pk_mul_f32 v[108:109], v[108:109], v[36:37] op_sel_hi:[1,0]
    v_pk_mul_f32 v[110:111], v[110:111], v[36:37] op_sel_hi:[1,0]
    v_pk_mul_f32 v[112:113], v[112:113], v[36:37] op_sel_hi:[1,0]
    v_pk_mul_f32 v[114:115], v[114:115], v[36:37] op_sel_hi:[1,0]
    v_pk_mul_f32 v[116:117], v[116:117], v[36:37] op_sel_hi:[1,0]
    v_pk_mul_f32 v[118:119], v[118:119], v[36:37] op_sel_hi:[1,0]
    v_pk_mul_f32 v[120:121], v[120:121], v[36:37] op_sel_hi:[1,0]
    v_pk_mul_f32 v[122:123], v[122:123], v[36:37] op_sel_hi:[1,0]
    v_cvt_pk_bf16_f32 v228, v104, v105
    v_pk_mul_f32 v[180:181], v[180:181], v[38:39] op_sel_hi:[1,0]
    v_cvt_pk_bf16_f32 v229, v106, v107
    v_pk_mul_f32 v[182:183], v[182:183], v[38:39] op_sel_hi:[1,0]
    v_cvt_pk_bf16_f32 v230, v108, v109
    v_pk_mul_f32 v[184:185], v[184:185], v[38:39] op_sel_hi:[1,0]
    v_cvt_pk_bf16_f32 v231, v110, v111
    v_pk_mul_f32 v[186:187], v[186:187], v[38:39] op_sel_hi:[1,0]
    v_cvt_pk_bf16_f32 v232, v112, v113
    v_pk_mul_f32 v[188:189], v[188:189], v[38:39] op_sel_hi:[1,0]
    v_cvt_pk_bf16_f32 v233, v114, v115
    v_pk_mul_f32 v[190:191], v[190:191], v[38:39] op_sel_hi:[1,0]
    v_cvt_pk_bf16_f32 v234, v116, v117
    v_pk_mul_f32 v[192:193], v[192:193], v[38:39] op_sel_hi:[1,0]
    v_cvt_pk_bf16_f32 v235, v118, v119
    v_pk_mul_f32 v[194:195], v[194:195], v[38:39] op_sel_hi:[1,0]
    v_cvt_pk_bf16_f32 v236, v120, v121
    v_pk_mul_f32 v[196:197], v[196:197], v[38:39] op_sel_hi:[1,0]
    v_cvt_pk_bf16_f32 v237, v122, v123
    v_pk_mul_f32 v[198:199], v[198:199], v[38:39] op_sel_hi:[1,0]
    v_cvt_pk_bf16_f32 v238, v180, v181
    v_cvt_pk_bf16_f32 v239, v182, v183
    v_cvt_pk_bf16_f32 v240, v184, v185
    v_cvt_pk_bf16_f32 v241, v186, v187
    v_cvt_pk_bf16_f32 v242, v188, v189
    v_cvt_pk_bf16_f32 v243, v190, v191
    v_cvt_pk_bf16_f32 v244, v192, v193
    v_cvt_pk_bf16_f32 v245, v194, v195
    v_cvt_pk_bf16_f32 v246, v196, v197
    v_cvt_pk_bf16_f32 v247, v198, v199
    s_waitcnt lgkmcnt(6)
    v_xor_b32 v6, 128, v254
    ds_write_b128 v6, v[228:231]
    v_xor_b32 v7, 144, v254
    ds_write_b128 v7, v[232:235]
    v_xor_b32 v6, 160, v254
    ds_write_b128 v6, v[236:239]
    v_xor_b32 v7, 176, v254
    ds_write_b128 v7, v[240:243]
    v_xor_b32 v6, 192, v254
    ds_write_b128 v6, v[244:247]
    v_xor_b32 v13, 16, v252
    v_add_u32 v13, 2048, v13
    v_xor_b32 v14, 16, v253
    v_add_u32 v14, 2048, v14
    v_xor_b32 v15, 16, v255
    v_add_u32 v15, 2048, v15
    s_lshl_b32 s57, s46, 2
    s_add_u32 s57, s57, s42
    s_lshl_b32 s57, s57, 4
    s_add_u32 s57, s57, s45
    s_lshl_b32 s57, s57, 11
    s_add_u32 s57, s57, 6946816
    v_and_b32 v4, 31, v1
    v_lshrrev_b32 v5, 5, v1
    v_lshlrev_b32 v12, 4, v4
    v_mul_u32_u24 v11, 768, v5
    v_add_u32 v11, v11, v12
    v_mov_b32 v8, 2147483648
    v_cmp_gt_u32 vcc, 24, v4
    s_nop 1
    v_cndmask_b32 v11, v8, v11, vcc
    v_cmp_gt_u32 vcc, 24, v1
    s_nop 1
    v_cndmask_b32 v12, v8, v12, vcc
    s_waitcnt lgkmcnt(0)
    s_barrier
    ds_read_b64_tr_b16 v[48:49], v255 offset:0
    ds_read_b64_tr_b16 v[50:51], v15 offset:0
    ds_read_b64_tr_b16 v[40:41], v252 offset:0
    ds_read_b64_tr_b16 v[42:43], v13 offset:0
    ds_read_b64_tr_b16 v[44:45], v253 offset:0
    ds_read_b64_tr_b16 v[46:47], v14 offset:0
    ds_read_b64_tr_b16 v[60:61], v255 offset:8192
    ds_read_b64_tr_b16 v[62:63], v15 offset:8192
    ds_read_b64_tr_b16 v[52:53], v252 offset:8192
    ds_read_b64_tr_b16 v[54:55], v13 offset:8192
    ds_read_b64_tr_b16 v[56:57], v253 offset:8192
    ds_read_b64_tr_b16 v[58:59], v14 offset:8192
    s_waitcnt lgkmcnt(6)
    ds_read_b64_tr_b16 v[72:73], v255 offset:16384
    ds_read_b64_tr_b16 v[74:75], v15 offset:16384
    ds_read_b64_tr_b16 v[64:65], v252 offset:16384
    ds_read_b64_tr_b16 v[66:67], v13 offset:16384
    ds_read_b64_tr_b16 v[68:69], v253 offset:16384
    ds_read_b64_tr_b16 v[70:71], v14 offset:16384
    v_mfma_f32_32x32x16_bf16 v[160:175], v[40:43], v[48:51], 0
    v_mfma_f32_32x32x16_bf16 v[176:191], v[44:47], v[48:51], 0
    s_waitcnt lgkmcnt(6)
    ds_read_b64_tr_b16 v[84:85], v255 offset:24576
    ds_read_b64_tr_b16 v[86:87], v15 offset:24576
    ds_read_b64_tr_b16 v[76:77], v252 offset:24576
    ds_read_b64_tr_b16 v[78:79], v13 offset:24576
    ds_read_b64_tr_b16 v[80:81], v253 offset:24576
    ds_read_b64_tr_b16 v[82:83], v14 offset:24576
    v_mfma_f32_32x32x16_bf16 v[160:175], v[52:55], v[60:63], v[160:175]
    v_mfma_f32_32x32x16_bf16 v[176:191], v[56:59], v[60:63], v[176:191]
    s_waitcnt lgkmcnt(6)
    ds_read_b64_tr_b16 v[96:97], v255 offset:32768
    ds_read_b64_tr_b16 v[98:99], v15 offset:32768
    ds_read_b64_tr_b16 v[88:89], v252 offset:32768
    ds_read_b64_tr_b16 v[90:91], v13 offset:32768
    ds_read_b64_tr_b16 v[92:93], v253 offset:32768
    ds_read_b64_tr_b16 v[94:95], v14 offset:32768
    v_mfma_f32_32x32x16_bf16 v[160:175], v[64:67], v[72:75], v[160:175]
    v_mfma_f32_32x32x16_bf16 v[176:191], v[68:71], v[72:75], v[176:191]
    s_waitcnt lgkmcnt(6)
    ds_read_b64_tr_b16 v[108:109], v255 offset:40960
    ds_read_b64_tr_b16 v[110:111], v15 offset:40960
    ds_read_b64_tr_b16 v[100:101], v252 offset:40960
    ds_read_b64_tr_b16 v[102:103], v13 offset:40960
    ds_read_b64_tr_b16 v[104:105], v253 offset:40960
    ds_read_b64_tr_b16 v[106:107], v14 offset:40960
    v_mfma_f32_32x32x16_bf16 v[160:175], v[76:79], v[84:87], v[160:175]
    v_mfma_f32_32x32x16_bf16 v[176:191], v[80:83], v[84:87], v[176:191]
    s_waitcnt lgkmcnt(6)
    ds_read_b64_tr_b16 v[120:121], v255 offset:49152
    ds_read_b64_tr_b16 v[122:123], v15 offset:49152
    ds_read_b64_tr_b16 v[112:113], v252 offset:49152
    ds_read_b64_tr_b16 v[114:115], v13 offset:49152
    ds_read_b64_tr_b16 v[116:117], v253 offset:49152
    ds_read_b64_tr_b16 v[118:119], v14 offset:49152
    v_mfma_f32_32x32x16_bf16 v[160:175], v[88:91], v[96:99], v[160:175]
    v_mfma_f32_32x32x16_bf16 v[176:191], v[92:95], v[96:99], v[176:191]
    s_waitcnt lgkmcnt(6)
    ds_read_b64_tr_b16 v[132:133], v255 offset:57344
    ds_read_b64_tr_b16 v[134:135], v15 offset:57344
    ds_read_b64_tr_b16 v[124:125], v252 offset:57344
    ds_read_b64_tr_b16 v[126:127], v13 offset:57344
    ds_read_b64_tr_b16 v[128:129], v253 offset:57344
    ds_read_b64_tr_b16 v[130:131], v14 offset:57344
    v_mfma_f32_32x32x16_bf16 v[160:175], v[100:103], v[108:111], v[160:175]
    v_mfma_f32_32x32x16_bf16 v[176:191], v[104:107], v[108:111], v[176:191]
    s_waitcnt lgkmcnt(6)
    v_mfma_f32_32x32x16_bf16 v[160:175], v[112:115], v[120:123], v[160:175]
    v_mfma_f32_32x32x16_bf16 v[176:191], v[116:119], v[120:123], v[176:191]
    s_waitcnt lgkmcnt(0)
    v_mfma_f32_32x32x16_bf16 v[160:175], v[124:127], v[132:135], v[160:175]
    v_mfma_f32_32x32x16_bf16 v[176:191], v[128:131], v[132:135], v[176:191]
    s_nop 10
    v_cvt_pk_bf16_f32 v140, v160, v161
    v_cvt_pk_bf16_f32 v141, v162, v163
    v_cvt_pk_bf16_f32 v142, v164, v165
    v_cvt_pk_bf16_f32 v143, v166, v167
    v_cvt_pk_bf16_f32 v144, v168, v169
    v_cvt_pk_bf16_f32 v145, v170, v171
    v_cvt_pk_bf16_f32 v146, v172, v173
    v_cvt_pk_bf16_f32 v147, v174, v175
    v_cvt_pk_bf16_f32 v148, v176, v177
    v_cvt_pk_bf16_f32 v149, v178, v179
    v_cvt_pk_bf16_f32 v150, v180, v181
    v_cvt_pk_bf16_f32 v151, v182, v183
    buffer_store_dwordx4 v[140:143], v11, s[12:15], s57 offen sc1
    buffer_store_dwordx4 v[144:147], v11, s[12:15], s57 offen offset:384 sc1
    buffer_store_dwordx4 v[148:151], v12, s[12:15], s57 offen offset:1536 sc1
    s_waitcnt vmcnt(0)
    s_barrier
    s_cmp_eq_u32 s26, 0
    s_cbranch_scc0 ini_8
    v_mov_b32 v2, 0
    s_mov_b32 s62, 0
inip_10:
    buffer_load_dword v3, v2, s[16:19], 0 offen sc1
    s_waitcnt vmcnt(0)
    v_readfirstlane_b32 s61, v3
    s_add_u32 s62, s62, 1
    s_cmp_ge_u32 s62, 0x40000
    s_cbranch_scc1 ini_9
    s_cmp_eq_u32 s61, 1
    s_cbranch_scc0 inip_10
ini_9:
ini_8:
    s_cmp_eq_u32 s42, 0
    s_cbranch_scc0 sig_11
    s_add_u32 s57, s46, 8
    s_lshl_b32 s57, s57, 8
    v_mov_b32 v2, s57
    v_mov_b32 v3, 1
    s_mov_b64 exec, 1
    buffer_atomic_add v3, v2, s[12:15], 0 offen sc1
    s_mov_b64 exec, -1
sig_11:
    s_cmp_lt_u32 s52, 96
    s_cbranch_scc0 nwd_12
    v_lshrrev_b32 v2, 4, v1
    v_bfe_u32 v3, v1, 2, 2
    v_and_b32 v4, 3, v1
    v_lshl_add_u32 v2, v2, 3, v3
    v_lshlrev_b32 v9, 4, v1
    v_mul_u32_u24 v5, 640, v2
    s_mul_i32 s57, s42, 160
    s_add_u32 s57, s57, 110592
    v_add_u32 v5, s57, v5
    v_lshl_add_u32 v6, v4, 4, v5
    v_lshl_add_u32 v7, v4, 3, v5
    ds_read_b64_tr_b16 v[40:41], v6 offset:0
    ds_read_b64_tr_b16 v[42:43], v6 offset:2560
    ds_read_b64_tr_b16 v[44:45], v6 offset:8
    ds_read_b64_tr_b16 v[46:47], v6 offset:2568
    ds_read_b64_tr_b16 v[48:49], v6 offset:64
    ds_read_b64_tr_b16 v[50:51], v6 offset:2624
    ds_read_b64_tr_b16 v[52:53], v6 offset:72
    ds_read_b64_tr_b16 v[54:55], v6 offset:2632
    ds_read_b64_tr_b16 v[56:57], v7 offset:128
    ds_read_b64_tr_b16 v[58:59], v7 offset:2688
    s_and_b32 s57, s41, 1
    s_lshl_b32 s57, s57, 2
    s_add_u32 s57, s57, s42
    s_mul_i32 s57, s57, 48
    s_lshr_b32 s58, s41, 1
    s_add_u32 s57, s57, s58
    s_mul_i32 s57, s57, 5120
    s_add_u32 s57, s57, 4980736
    s_add_u32 s58, s57, 4096
    s_waitcnt lgkmcnt(0)
    buffer_store_dwordx4 v[40:43], v9, s[12:15], s57 offen offset:0 sc1
    buffer_store_dwordx4 v[44:47], v9, s[12:15], s57 offen offset:1024 sc1
    buffer_store_dwordx4 v[48:51], v9, s[12:15], s57 offen offset:2048 sc1
    buffer_store_dwordx4 v[52:55], v9, s[12:15], s57 offen offset:3072 sc1
    buffer_store_dwordx4 v[56:59], v9, s[12:15], s58 offen offset:0 sc1
    s_branch pdo_13
nwd_12:
    v_lshrrev_b32 v2, 4, v1
    v_bfe_u32 v3, v1, 2, 2
    v_and_b32 v4, 3, v1
    v_lshl_add_u32 v2, v2, 3, v3
    v_lshlrev_b32 v9, 4, v1
    v_mul_u32_u24 v5, 384, v2
    s_mul_i32 s57, s42, 96
    s_add_u32 s57, s57, 110592
    v_add_u32 v5, s57, v5
    v_lshl_add_u32 v6, v4, 3, v5
    v_and_b32 v7, 1, v4
    v_lshl_add_u32 v7, v7, 3, v5
    v_lshrrev_b32 v8, 1, v4
    v_mul_u32_u24 v8, 12288, v8
    v_add3_u32 v7, v7, v8, 32
    ds_read_b64_tr_b16 v[40:41], v6 offset:0
    ds_read_b64_tr_b16 v[42:43], v6 offset:1536
    ds_read_b64_tr_b16 v[44:45], v6 offset:12288
    ds_read_b64_tr_b16 v[46:47], v6 offset:13824
    ds_read_b64_tr_b16 v[48:49], v7 offset:0
    ds_read_b64_tr_b16 v[50:51], v7 offset:1536
    ds_read_b64_tr_b16 v[52:53], v6 offset:48
    ds_read_b64_tr_b16 v[54:55], v6 offset:1584
    ds_read_b64_tr_b16 v[56:57], v6 offset:12336
    ds_read_b64_tr_b16 v[58:59], v6 offset:13872
    ds_read_b64_tr_b16 v[60:61], v7 offset:48
    ds_read_b64_tr_b16 v[62:63], v7 offset:1584
    s_and_b32 s57, s41, 7
    s_lshl_b32 s57, s57, 2
    s_add_u32 s57, s57, s42
    s_mul_i32 s57, s57, 40
    s_lshr_b32 s58, s41, 3
    s_add_u32 s57, s57, s58
    s_mul_i32 s57, s57, 3072
    s_add_u32 s57, s57, 1048576
    s_add_u32 s58, s57, 61440
    s_waitcnt lgkmcnt(0)
    buffer_store_dwordx4 v[40:43], v9, s[12:15], s57 offen offset:0 sc1
    buffer_store_dwordx4 v[44:47], v9, s[12:15], s57 offen offset:1024 sc1
    buffer_store_dwordx4 v[48:51], v9, s[12:15], s57 offen offset:2048 sc1
    buffer_store_dwordx4 v[52:55], v9, s[12:15], s58 offen offset:0 sc1
    buffer_store_dwordx4 v[56:59], v9, s[12:15], s58 offen offset:1024 sc1
    buffer_store_dwordx4 v[60:63], v9, s[12:15], s58 offen offset:2048 sc1
pdo_13:
    s_waitcnt vmcnt(0)
    s_barrier
    s_cmp_eq_u32 s42, 0
    s_cbranch_scc0 sig_14
    s_and_b32 s57, s52, 7
    s_add_u32 s57, s57, 48
    s_lshl_b32 s57, s57, 8
    v_mov_b32 v2, s57
    v_mov_b32 v3, 1
    s_mov_b64 exec, 1
    buffer_atomic_add v3, v2, s[12:15], 0 offen sc1
    s_mov_b64 exec, -1
sig_14:
    s_cmp_eq_u32 s26, 0
    s_cbranch_scc0 gok_15
    s_mov_b32 s57, 0
    v_add_u32 v2, s57, v1
    v_lshlrev_b32 v2, 8, v2
    s_mov_b64 exec, 255
    s_mov_b32 s62, 0
pp_17:
    s_sleep 4
    buffer_load_dword v3, v2, s[12:15], 0 offen sc1
    s_waitcnt vmcnt(0)
    v_cmp_gt_u32 vcc, 16, v3
    s_add_u32 s62, s62, 1
    s_cmp_ge_u32 s62, 0x40000
    s_cbranch_scc1 pd_18
    s_nop 1
    s_cbranch_vccnz pp_17
pd_18:
    s_mov_b64 exec, -1
pw_16:
    s_lshl_b32 s101, s51, 2
    s_add_u32 s101, s101, s42
    s_mul_i32 s101, s101, 61440
    s_add_u32 s101, s101, 1048576
    buffer_load_dwordx4 a[0:3], v10, s[12:15], s101 offen offset:0 sc1
    buffer_load_dwordx4 a[4:7], v10, s[12:15], s101 offen offset:1024 sc1
    buffer_load_dwordx4 a[8:11], v10, s[12:15], s101 offen offset:2048 sc1
    buffer_load_dwordx4 a[12:15], v10, s[12:15], s101 offen offset:3072 sc1
    s_add_u32 s101, s101, 4096
    buffer_load_dwordx4 a[16:19], v10, s[12:15], s101 offen offset:0 sc1
    buffer_load_dwordx4 a[20:23], v10, s[12:15], s101 offen offset:1024 sc1
    s_waitcnt vmcnt(4)
gok_15:
    s_mul_i32 s59, s50, 102400
    s_mul_i32 s60, s42, 25600
    s_add_u32 s59, s59, s60
    s_add_u32 s59, s59, 65536
    s_add_u32 m0, s60, 0
    s_nop 0
    buffer_load_dwordx4 v10, s[12:15], s59 offen offset:0 sc1 lds
    buffer_load_dwordx4 v10, s[12:15], s59 offen offset:1024 sc1 lds
    buffer_load_dwordx4 v10, s[12:15], s59 offen offset:2048 sc1 lds
    buffer_load_dwordx4 v10, s[12:15], s59 offen offset:3072 sc1 lds
    s_add_u32 m0, s60, 4096
    s_add_u32 s59, s59, 4096
    buffer_load_dwordx4 v10, s[12:15], s59 offen offset:0 sc1 lds
    buffer_load_dwordx4 v10, s[12:15], s59 offen offset:1024 sc1 lds
    buffer_load_dwordx4 v10, s[12:15], s59 offen offset:2048 sc1 lds
    buffer_load_dwordx4 v10, s[12:15], s59 offen offset:3072 sc1 lds
    s_add_u32 m0, s60, 8192
    s_add_u32 s59, s59, 4096
    buffer_load_dwordx4 v10, s[12:15], s59 offen offset:0 sc1 lds
    buffer_load_dwordx4 v10, s[12:15], s59 offen offset:1024 sc1 lds
    buffer_load_dwordx4 v10, s[12:15], s59 offen offset:2048 sc1 lds
    buffer_load_dwordx4 v10, s[12:15], s59 offen offset:3072 sc1 lds
    s_add_u32 m0, s60, 12288
    s_add_u32 s59, s59, 4096
    buffer_load_dwordx4 v10, s[12:15], s59 offen offset:0 sc1 lds
    buffer_load_dwordx4 v10, s[12:15], s59 offen offset:1024 sc1 lds
    buffer_load_dwordx4 v10, s[12:15], s59 offen offset:2048 sc1 lds
    buffer_load_dwordx4 v10, s[12:15], s59 offen offset:3072 sc1 lds
    s_add_u32 m0, s60, 16384
    s_add_u32 s59, s59, 4096
    buffer_load_dwordx4 v10, s[12:15], s59 offen offset:0 sc1 lds
    buffer_load_dwordx4 v10, s[12:15], s59 offen offset:1024 sc1 lds
    buffer_load_dwordx4 v10, s[12:15], s59 offen offset:2048 sc1 lds
    buffer_load_dwordx4 v10, s[12:15], s59 offen offset:3072 sc1 lds
    s_add_u32 m0, s60, 20480
    s_add_u32 s59, s59, 4096
    buffer_load_dwordx4 v10, s[12:15], s59 offen offset:0 sc1 lds
    buffer_load_dwordx4 v10, s[12:15], s59 offen offset:1024 sc1 lds
    buffer_load_dwordx4 v10, s[12:15], s59 offen offset:2048 sc1 lds
    buffer_load_dwordx4 v10, s[12:15], s59 offen offset:3072 sc1 lds
    s_add_u32 m0, s60, 24576
    s_add_u32 s59, s59, 4096
    buffer_load_dwordx4 v10, s[12:15], s59 offen offset:0 sc1 lds
    s_lshl_b32 s101, s51, 2
    s_add_u32 s101, s101, s42
    s_mul_i32 s101, s101, 61440
    s_add_u32 s101, s101, 1052672
    buffer_load_dwordx4 a[24:27], v10, s[12:15], s101 offen offset:2048 sc1
    buffer_load_dwordx4 a[28:31], v10, s[12:15], s101 offen offset:3072 sc1
    s_add_u32 s101, s101, 4096
    buffer_load_dwordx4 a[32:35], v10, s[12:15], s101 offen offset:0 sc1
    buffer_load_dwordx4 a[36:39], v10, s[12:15], s101 offen offset:1024 sc1
    buffer_load_dwordx4 a[40:43], v10, s[12:15], s101 offen offset:2048 sc1
    buffer_load_dwordx4 a[44:47], v10, s[12:15], s101 offen offset:3072 sc1
    s_add_u32 s101, s101, 4096
    buffer_load_dwordx4 a[48:51], v10, s[12:15], s101 offen offset:0 sc1
    buffer_load_dwordx4 a[52:55], v10, s[12:15], s101 offen offset:1024 sc1
    buffer_load_dwordx4 a[56:59], v10, s[12:15], s101 offen offset:2048 sc1
    buffer_load_dwordx4 a[60:63], v10, s[12:15], s101 offen offset:3072 sc1
    s_add_u32 s101, s101, 4096
    buffer_load_dwordx4 a[64:67], v10, s[12:15], s101 offen offset:0 sc1
    buffer_load_dwordx4 a[68:71], v10, s[12:15], s101 offen offset:1024 sc1
    buffer_load_dwordx4 a[72:75], v10, s[12:15], s101 offen offset:2048 sc1
    buffer_load_dwordx4 a[76:79], v10, s[12:15], s101 offen offset:3072 sc1
    s_add_u32 s101, s101, 4096
    buffer_load_dwordx4 a[80:83], v10, s[12:15], s101 offen offset:0 sc1
    buffer_load_dwordx4 a[84:87], v10, s[12:15], s101 offen offset:1024 sc1
    buffer_load_dwordx4 a[88:91], v10, s[12:15], s101 offen offset:2048 sc1
    buffer_load_dwordx4 a[92:95], v10, s[12:15], s101 offen offset:3072 sc1
    s_add_u32 s101, s101, 4096
    buffer_load_dwordx4 a[96:99], v10, s[12:15], s101 offen offset:0 sc1
    buffer_load_dwordx4 a[100:103], v10, s[12:15], s101 offen offset:1024 sc1
    buffer_load_dwordx4 a[104:107], v10, s[12:15], s101 offen offset:2048 sc1
    buffer_load_dwordx4 a[108:111], v10, s[12:15], s101 offen offset:3072 sc1
    s_add_u32 s101, s101, 4096
    buffer_load_dwordx4 a[112:115], v10, s[12:15], s101 offen offset:0 sc1
    buffer_load_dwordx4 a[116:119], v10, s[12:15], s101 offen offset:1024 sc1
    s_waitcnt vmcnt(30)
    buffer_load_dwordx4 a[120:123], v10, s[12:15], s101 offen offset:2048 sc1
    buffer_load_dwordx4 a[124:127], v10, s[12:15], s101 offen offset:3072 sc1
    s_add_u32 s101, s101, 4096
    buffer_load_dwordx4 a[128:131], v10, s[12:15], s101 offen offset:0 sc1
    buffer_load_dwordx4 a[132:135], v10, s[12:15], s101 offen offset:1024 sc1
    buffer_load_dwordx4 a[136:139], v10, s[12:15], s101 offen offset:2048 sc1
    buffer_load_dwordx4 a[140:143], v10, s[12:15], s101 offen offset:3072 sc1
    s_add_u32 s101, s101, 4096
    buffer_load_dwordx4 a[144:147], v10, s[12:15], s101 offen offset:0 sc1
    buffer_load_dwordx4 a[148:151], v10, s[12:15], s101 offen offset:1024 sc1
    buffer_load_dwordx4 a[152:155], v10, s[12:15], s101 offen offset:2048 sc1
    buffer_load_dwordx4 a[156:159], v10, s[12:15], s101 offen offset:3072 sc1
    s_add_u32 s101, s101, 4096
    buffer_load_dwordx4 a[160:163], v10, s[12:15], s101 offen offset:0 sc1
    buffer_load_dwordx4 a[164:167], v10, s[12:15], s101 offen offset:1024 sc1
    buffer_load_dwordx4 a[168:171], v10, s[12:15], s101 offen offset:2048 sc1
    buffer_load_dwordx4 a[172:175], v10, s[12:15], s101 offen offset:3072 sc1
    s_add_u32 s101, s101, 4096
    buffer_load_dwordx4 a[176:179], v10, s[12:15], s101 offen offset:0 sc1
    buffer_load_dwordx4 a[180:183], v10, s[12:15], s101 offen offset:1024 sc1
    buffer_load_dwordx4 a[184:187], v10, s[12:15], s101 offen offset:2048 sc1
    buffer_load_dwordx4 a[188:191], v10, s[12:15], s101 offen offset:3072 sc1
    s_branch L_p2
L_q:
    s_mov_b32 s12, s90
    s_and_b32 s13, s91, 0xffff
    s_mov_b32 s14, 33554432
    s_mov_b32 s15, 0x00020000
    s_mov_b32 s16, s88
    s_and_b32 s17, s89, 0xffff
    s_mov_b32 s18, 256
    s_mov_b32 s19, 0x00020000
    s_mov_b32 s20, s86
    s_and_b32 s21, s87, 0xffff
    s_mov_b32 s22, 2621440
    s_mov_b32 s23, 0x00020000
    s_mov_b32 s24, s76
    s_and_b32 s25, s77, 0xffff
    s_mov_b32 s26, 25600
    s_mov_b32 s27, 0x00020000
    s_mov_b64 s[32:33], s[78:79]
    s_mov_b64 s[34:35], s[80:81]
    s_mov_b64 s[36:37], s[82:83]
    s_mov_b64 s[38:39], s[84:85]
    s_lshr_b32 s58, s44, 3
    s_lshr_b32 s48, s43, 1
    s_lshl_b32 s48, s48, 2
    s_add_u32 s48, s48, s58
    s_bfe_u32 s49, s44, 0x10002
    s_and_b32 s58, s43, 1
    s_lshl_b32 s50, s58, 2
    s_and_b32 s59, s44, 3
    s_add_u32 s50, s50, s59
    s_and_b32 s58, s43, 1
    s_lshl_b32 s51, s58, 3
    s_and_b32 s59, s44, 7
    s_add_u32 s51, s51, s59
    s_mov_b32 s63, 0x3f803f80
    s_mov_b32 s66, 0x3fb8aa3b
    s_mov_b32 s67, 0x3fb8aa3b
    s_mul_i32 s57, s46, 3200
    v_lshlrev_b32 v2, 4, v0
    v_cmp_gt_u32 vcc, 200, v0
    s_lshl_b32 s58, s42, 10
    s_add_u32 m0, s58, 147456
    s_and_saveexec_b64 s[68:69], vcc
    buffer_load_dwordx4 v2, s[24:27], s57 offen lds
    s_mov_b64 exec, s[68:69]
    s_getpc_b64 s[28:29]
L_pc2:
    s_sub_u32 s28, s28, L_pc2-sequential_preLN__linear_kernel_hedgehog__geglu_ffn__prompt_kernel
    s_subb_u32 s29, s29, 0
    s_and_b32 s29, s29, 0xffff
    s_mov_b32 s30, L_end-sequential_preLN__linear_kernel_hedgehog__geglu_ffn__prompt_kernel
    s_mov_b32 s31, 0x00020000
    s_lshl_b32 s57, s44, 12
    buffer_load_dwordx4 v[4:7], v2, s[28:31], s57 offen
    s_or_b32 s57, s2, s42
    s_cmp_eq_u32 s57, 0
    s_cbranch_scc0 noz_19
    v_lshlrev_b32 v8, 8, v0
    v_mov_b32 v9, 0
    s_movk_i32 s58, 0x4000
    buffer_store_dword v9, v8, s[12:15], 0 offen sc1
    buffer_store_dword v9, v8, s[12:15], s58 offen sc1
    s_mov_b32 s58, 0x8000
    buffer_store_dword v9, v8, s[12:15], s58 offen sc1
noz_19:
    v_mov_b32 v25, 0
    v_mov_b32 v26, 0
    v_mov_b32 v27, 0
    v_mov_b32 v28, 0
    v_mov_b32 v29, 0
    v_mov_b32 v30, 0
    v_mov_b32 v31, 0
    v_mov_b32 v60, 0
    v_mov_b32 v61, 0
    v_mov_b32 v62, 0
    v_mov_b32 v63, 0
    v_mov_b32 v64, 0
    v_mov_b32 v65, 0
    v_mov_b32 v66, 0
    v_mov_b32 v67, 0
    v_mov_b32 v68, 0
    v_mov_b32 v69, 0
    v_mov_b32 v70, 0
    v_mov_b32 v71, 0
    v_mov_b32 v72, 0
    v_mov_b32 v73, 0
    v_mov_b32 v74, 0
    v_mov_b32 v75, 0
    v_mov_b32 v76, 0
    v_mov_b32 v77, 0
    v_mov_b32 v78, 0
    v_mov_b32 v79, 0
    v_mov_b32 v80, 0
    v_mov_b32 v81, 0
    v_mov_b32 v82, 0
    v_mov_b32 v83, 0
    v_mov_b32 v84, 0
    v_mov_b32 v85, 0
    v_mov_b32 v86, 0
    v_mov_b32 v87, 0
    v_mov_b32 v88, 0
    v_mov_b32 v89, 0
    v_mov_b32 v90, 0
    v_mov_b32 v91, 0
    v_mov_b32 v92, 0
    v_mov_b32 v93, 0
    v_mov_b32 v94, 0
    v_mov_b32 v95, 0
    v_mov_b32 v96, 0
    v_mov_b32 v97, 0
    v_mov_b32 v98, 0
    v_mov_b32 v99, 0
    v_mov_b32 v100, 0
    v_mov_b32 v101, 0
    v_mov_b32 v102, 0
    v_mov_b32 v103, 0
    v_mov_b32 v104, 0
    v_mov_b32 v105, 0
    v_mov_b32 v106, 0
    v_mov_b32 v107, 0
    v_mov_b32 v108, 0
    v_mov_b32 v109, 0
    v_mov_b32 v110, 0
    v_mov_b32 v111, 0
    v_mov_b32 v112, 0
    v_mov_b32 v113, 0
    v_mov_b32 v114, 0
    v_mov_b32 v115, 0
    v_mov_b32 v116, 0
    v_mov_b32 v117, 0
    v_mov_b32 v118, 0
    v_mov_b32 v119, 0
    v_mov_b32 v120, 0
    v_mov_b32 v121, 0
    v_mov_b32 v122, 0
    v_mov_b32 v123, 0
    v_mov_b32 v124, 0
    v_mov_b32 v125, 0
    v_mov_b32 v126, 0
    v_mov_b32 v127, 0
    v_mov_b32 v164, 0
    v_mov_b32 v165, 0
    v_mov_b32 v166, 0
    v_mov_b32 v167, 0
    v_lshlrev_b32 v2, 4, v0
    v_add_u32 v2, 150784, v2
    v_cmp_gt_u32 vcc, 128, v0
    s_nop 1
    s_and_saveexec_b64 s[68:69], vcc
    ds_write_b128 v2, v[60:63]
    s_mov_b64 exec, s[68:69]
    v_and_b32 v2, 31, v1
    v_lshrrev_b32 v3, 5, v1
    v_bfe_u32 v8, v2, 1, 3
    v_xor_b32 v3, v3, v8
    s_lshl_b32 s57, s42, 12
    v_lshlrev_b32 v2, 7, v2
    v_lshl_add_u32 v2, v3, 4, v2
    v_add_u32 v19, s57, v2
    v_lshrrev_b32 v2, 5, v1
    v_bfe_u32 v3, v1, 2, 2
    v_bfe_u32 v8, v1, 4, 1
    v_lshlrev_b32 v8, 1, v8
    v_bfe_u32 v9, v1, 1, 1
    v_add_u32 v8, v8, v9
    v_and_b32 v9, 1, v1
    v_lshl_add_u32 v24, v2, 3, v3
    v_mul_u32_u24 v24, 192, v24
    v_mul_u32_u24 v177, 96, v9
    v_lshl_add_u32 v177, v8, 3, v177
    v_add_u32 v24, v24, v177
    s_add_u32 s57, s42, 0
    s_and_b32 s57, s57, 3
    s_lshl_b32 s58, s57, 5
    s_mul_i32 s57, s57, 3072
    s_add_u32 s57, s57, 16384
    v_xor_b32 v20, s58, v19
    v_add_u32 v168, s57, v24
    s_add_u32 s57, s42, 1
    s_and_b32 s57, s57, 3
    s_lshl_b32 s58, s57, 5
    s_mul_i32 s57, s57, 3072
    s_add_u32 s57, s57, 16384
    v_xor_b32 v21, s58, v19
    v_add_u32 v169, s57, v24
    s_add_u32 s57, s42, 2
    s_and_b32 s57, s57, 3
    s_lshl_b32 s58, s57, 5
    s_mul_i32 s57, s57, 3072
    s_add_u32 s57, s57, 16384
    v_xor_b32 v22, s58, v19
    v_add_u32 v170, s57, v24
    s_add_u32 s57, s42, 3
    s_and_b32 s57, s57, 3
    s_lshl_b32 s58, s57, 5
    s_mul_i32 s57, s57, 3072
    s_add_u32 s57, s57, 16384
    v_xor_b32 v23, s58, v19
    v_add_u32 v171, s57, v24
    v_mul_u32_u24 v178, 40, v3
    v_mul_u32_u24 v177, 1600, v2
    v_add_u32 v177, v177, v178
    v_add_u32 v177, 147456, v177
    v_lshl_add_u32 v178, v8, 3, v177
    v_mov_b32 v24, 150784
    v_cmp_eq_u32 s[68:69], v2, v9
    s_nop 1
    v_cndmask_b32 v200, v24, v178, s[68:69]
    v_cmp_eq_u32 vcc, 0, v8
    s_nop 1
    s_and_b64 vcc, vcc, s[68:69]
    v_add_u32 v19, 32, v177
    v_cndmask_b32 v201, v24, v19, vcc
    v_cmp_lt_u32 vcc, 0, v8
    s_nop 1
    s_and_b64 vcc, vcc, s[68:69]
    v_add_u32 v19, 792, v178
    v_cndmask_b32 v202, v24, v19, vcc
    v_cmp_gt_u32 vcc, 2, v8
    s_nop 1
    s_and_b64 vcc, vcc, s[68:69]
    v_add_u32 v19, 824, v178
    v_cndmask_b32 v203, v24, v19, vcc
    s_lshl_b32 s54, s53, 7
    s_mul_i32 s55, s53, 245760
    s_add_u32 s53, s53, 1
    s_cmp_eq_u32 s53, 10
    s_cselect_b32 s53, 0, s53
    s_add_u32 m0, s56, 0
    s_nop 0
    buffer_load_dwordx4 v10, s[4:7], s54 offen lds
    s_add_u32 m0, s56, 1024
    s_nop 0
    buffer_load_dwordx4 v11, s[4:7], s54 offen lds
    s_add_u32 m0, s56, 2048
    s_nop 0
    buffer_load_dwordx4 v12, s[4:7], s54 offen lds
    s_add_u32 m0, s56, 3072
    s_nop 0
    buffer_load_dwordx4 v13, s[4:7], s54 offen lds
    s_add_u32 m0, s96, 0
    s_nop 0
    buffer_load_dwordx4 v14, s[8:11], s55 offen lds
    s_add_u32 m0, s96, 1024
    s_nop 0
    buffer_load_dwordx4 v15, s[8:11], s55 offen lds
    s_add_u32 m0, s96, 2048
    s_nop 0
    buffer_load_dwordx4 v16, s[8:11], s55 offen lds
    s_add_u32 s56, s56, 28672
    s_add_u32 s96, s96, 28672
    s_mov_b32 s97, 0
    s_mov_b32 s98, 28672
    s_mov_b32 s65, 0
    s_waitcnt vmcnt(7) lgkmcnt(0)
    .p2align 6
p1loop_20:
    s_waitcnt vmcnt(7)
    s_barrier
    s_cmp_eq_u32 s65, 1
    s_cbranch_scc1 hook_21
back_22:
    s_cmp_eq_u32 s65, 2
    s_cbranch_scc1 hook_23
back_24:
    s_cmp_eq_u32 s65, 3
    s_cbranch_scc1 hook_25
back_26:
    v_mfma_f32_32x32x16_bf16 v[80:95], v[60:63], v[164:167], v[80:95]
    ds_read_b128 v[32:35], v20
    ds_read_b64_tr_b16 v[40:41], v168 offset:0
    ds_read_b64_tr_b16 v[42:43], v168 offset:768
    s_lshl_b32 s54, s53, 7
    s_mul_i32 s55, s53, 245760
    s_add_u32 s53, s53, 1
    s_cmp_eq_u32 s53, 10
    s_cselect_b32 s53, 0, s53
    v_mfma_f32_32x32x16_bf16 v[96:111], v[64:67], v[164:167], v[96:111]
    s_add_u32 m0, s56, 0
    ds_read_b64_tr_b16 v[44:45], v168 offset:32
    ds_read_b64_tr_b16 v[46:47], v168 offset:800
    buffer_load_dwordx4 v10, s[4:7], s54 offen lds
    v_mfma_f32_32x32x16_bf16 v[112:127], v[68:71], v[164:167], v[112:127]
    s_add_u32 m0, s56, 1024
    ds_read_b64_tr_b16 v[48:49], v168 offset:64
    ds_read_b64_tr_b16 v[50:51], v168 offset:832
    buffer_load_dwordx4 v11, s[4:7], s54 offen lds
    s_waitcnt lgkmcnt(4)
    v_mfma_f32_32x32x16_bf16 v[80:95], v[40:43], v[32:35], v[80:95]
    s_add_u32 m0, s56, 2048
    ds_read_b128 v[36:39], v21
    ds_read_b64_tr_b16 v[60:61], v169 offset:0
    ds_read_b64_tr_b16 v[62:63], v169 offset:768
    buffer_load_dwordx4 v12, s[4:7], s54 offen lds
    s_waitcnt lgkmcnt(5)
    v_mfma_f32_32x32x16_bf16 v[96:111], v[44:47], v[32:35], v[96:111]
    s_add_u32 m0, s56, 3072
    ds_read_b64_tr_b16 v[64:65], v169 offset:32
    ds_read_b64_tr_b16 v[66:67], v169 offset:800
    buffer_load_dwordx4 v13, s[4:7], s54 offen lds
    s_waitcnt lgkmcnt(5)
    v_mfma_f32_32x32x16_bf16 v[112:127], v[48:51], v[32:35], v[112:127]
    s_add_u32 m0, s96, 0
    ds_read_b64_tr_b16 v[68:69], v169 offset:64
    ds_read_b64_tr_b16 v[70:71], v169 offset:832
    buffer_load_dwordx4 v14, s[8:11], s55 offen lds
    s_waitcnt lgkmcnt(4)
    v_mfma_f32_32x32x16_bf16 v[80:95], v[60:63], v[36:39], v[80:95]
    s_add_u32 m0, s96, 1024
    ds_read_b128 v[160:163], v22
    ds_read_b64_tr_b16 v[40:41], v170 offset:0
    ds_read_b64_tr_b16 v[42:43], v170 offset:768
    buffer_load_dwordx4 v15, s[8:11], s55 offen lds
    s_waitcnt lgkmcnt(5)
    v_mfma_f32_32x32x16_bf16 v[96:111], v[64:67], v[36:39], v[96:111]
    s_add_u32 m0, s96, 2048
    ds_read_b64_tr_b16 v[44:45], v170 offset:32
    ds_read_b64_tr_b16 v[46:47], v170 offset:800
    buffer_load_dwordx4 v16, s[8:11], s55 offen lds
    s_waitcnt lgkmcnt(5)
    v_mfma_f32_32x32x16_bf16 v[112:127], v[68:71], v[36:39], v[112:127]
    ds_read_b64_tr_b16 v[48:49], v170 offset:64
    ds_read_b64_tr_b16 v[50:51], v170 offset:832
    s_cmp_eq_u32 s97, 0
    s_cselect_b32 s58, 4294909952, s98
    s_add_u32 s56, s56, s58
    s_add_u32 s96, s96, s58
    s_waitcnt lgkmcnt(4)
    v_mfma_f32_32x32x16_bf16 v[80:95], v[40:43], v[160:163], v[80:95]
    ds_read_b128 v[164:167], v23
    ds_read_b64_tr_b16 v[60:61], v171 offset:0
    ds_read_b64_tr_b16 v[62:63], v171 offset:768
    s_waitcnt lgkmcnt(5)
    v_mfma_f32_32x32x16_bf16 v[96:111], v[44:47], v[160:163], v[96:111]
    ds_read_b64_tr_b16 v[64:65], v171 offset:32
    ds_read_b64_tr_b16 v[66:67], v171 offset:800
    s_waitcnt lgkmcnt(5)
    v_mfma_f32_32x32x16_bf16 v[112:127], v[48:51], v[160:163], v[112:127]
    ds_read_b64_tr_b16 v[68:69], v171 offset:64
    ds_read_b64_tr_b16 v[70:71], v171 offset:832
    s_add_u32 s97, s97, 1
    s_cmp_eq_u32 s97, 3
    s_cselect_b32 s57, 4294909952, s98
    s_cselect_b32 s97, 0, s97
    v_add_u32 v20, s57, v20
    v_add_u32 v21, s57, v21
    v_add_u32 v22, s57, v22
    v_add_u32 v23, s57, v23
    v_add_u32 v168, s57, v168
    v_add_u32 v169, s57, v169
    v_add_u32 v170, s57, v170
    v_add_u32 v171, s57, v171
    v_dot2c_f32_bf16 v25, s63, v32
    v_dot2c_f32_bf16 v26, v32, v32
    v_dot2c_f32_bf16 v25, s63, v33
    v_dot2c_f32_bf16 v26, v33, v33
    v_dot2c_f32_bf16 v25, s63, v34
    v_dot2c_f32_bf16 v26, v34, v34
    v_dot2c_f32_bf16 v25, s63, v35
    v_dot2c_f32_bf16 v26, v35, v35
    v_dot2c_f32_bf16 v25, s63, v36
    v_dot2c_f32_bf16 v26, v36, v36
    v_dot2c_f32_bf16 v25, s63, v37
    v_dot2c_f32_bf16 v26, v37, v37
    v_dot2c_f32_bf16 v25, s63, v38
    v_dot2c_f32_bf16 v26, v38, v38
    v_dot2c_f32_bf16 v25, s63, v39
    v_dot2c_f32_bf16 v26, v39, v39
    v_dot2c_f32_bf16 v25, s63, v160
    v_dot2c_f32_bf16 v26, v160, v160
    v_dot2c_f32_bf16 v25, s63, v161
    v_dot2c_f32_bf16 v26, v161, v161
    v_dot2c_f32_bf16 v25, s63, v162
    v_dot2c_f32_bf16 v26, v162, v162
    v_dot2c_f32_bf16 v25, s63, v163
    v_dot2c_f32_bf16 v26, v163, v163
    s_waitcnt lgkmcnt(0)
    v_dot2c_f32_bf16 v25, s63, v164
    v_dot2c_f32_bf16 v26, v164, v164
    v_dot2c_f32_bf16 v25, s63, v165
    v_dot2c_f32_bf16 v26, v165, v165
    v_dot2c_f32_bf16 v25, s63, v166
    v_dot2c_f32_bf16 v26, v166, v166
    v_dot2c_f32_bf16 v25, s63, v167
    v_dot2c_f32_bf16 v26, v167, v167
    v_dot2c_f32_bf16 v27, s63, v60
    v_dot2c_f32_bf16 v28, s63, v64
    v_dot2c_f32_bf16 v29, s63, v68
    v_dot2c_f32_bf16 v27, s63, v61
    v_dot2c_f32_bf16 v28, s63, v65
    v_dot2c_f32_bf16 v29, s63, v69
    v_dot2c_f32_bf16 v27, s63, v62
    v_dot2c_f32_bf16 v28, s63, v66
    v_dot2c_f32_bf16 v29, s63, v70
    v_dot2c_f32_bf16 v27, s63, v63
    v_dot2c_f32_bf16 v28, s63, v67
    v_dot2c_f32_bf16 v29, s63, v71
    s_add_u32 s65, s65, 1
    s_cmp_lt_u32 s65, 8
    s_cbranch_scc1 p1loop_20
    s_waitcnt vmcnt(7)
    s_barrier
    v_mfma_f32_32x32x16_bf16 v[80:95], v[60:63], v[164:167], v[80:95]
    v_mov_b32 v198, 0
    ds_read_b128 v[32:35], v20
    ds_read_b64_tr_b16 v[40:41], v168 offset:0
    ds_read_b64_tr_b16 v[42:43], v168 offset:768
    v_mov_b32 v24, 2147483648
    v_mfma_f32_32x32x16_bf16 v[96:111], v[64:67], v[164:167], v[96:111]
    ds_read_b64_tr_b16 v[44:45], v168 offset:32
    ds_read_b64_tr_b16 v[46:47], v168 offset:800
    buffer_load_dword v196, v198, s[16:19], 0 offen sc1
    v_mfma_f32_32x32x16_bf16 v[112:127], v[68:71], v[164:167], v[112:127]
    v_lshlrev_b32 v199, 8, v1
    ds_read_b64_tr_b16 v[48:49], v168 offset:64
    ds_read_b64_tr_b16 v[50:51], v168 offset:832
    v_cmp_gt_u32 vcc, 8, v1
    s_waitcnt lgkmcnt(4)
    v_mfma_f32_32x32x16_bf16 v[80:95], v[40:43], v[32:35], v[80:95]
    ds_read_b128 v[36:39], v21
    ds_read_b64_tr_b16 v[60:61], v169 offset:0
    ds_read_b64_tr_b16 v[62:63], v169 offset:768
    s_nop 0
    s_waitcnt lgkmcnt(5)
    v_mfma_f32_32x32x16_bf16 v[96:111], v[44:47], v[32:35], v[96:111]
    ds_read_b64_tr_b16 v[64:65], v169 offset:32
    ds_read_b64_tr_b16 v[66:67], v169 offset:800
    v_cndmask_b32 v199, v24, v199, vcc
    s_waitcnt lgkmcnt(5)
    v_mfma_f32_32x32x16_bf16 v[112:127], v[48:51], v[32:35], v[112:127]
    ds_read_b64_tr_b16 v[68:69], v169 offset:64
    ds_read_b64_tr_b16 v[70:71], v169 offset:832
    v_mov_b32 v218, 0
    s_waitcnt lgkmcnt(4)
    v_mfma_f32_32x32x16_bf16 v[80:95], v[60:63], v[36:39], v[80:95]
    ds_read_b128 v[160:163], v22
    ds_read_b64_tr_b16 v[40:41], v170 offset:0
    ds_read_b64_tr_b16 v[42:43], v170 offset:768
    v_mov_b32 v219, 0
    s_waitcnt lgkmcnt(5)
    v_mfma_f32_32x32x16_bf16 v[96:111], v[64:67], v[36:39], v[96:111]
    ds_read_b64_tr_b16 v[44:45], v170 offset:32
    ds_read_b64_tr_b16 v[46:47], v170 offset:800
    v_mov_b32 v240, 0
    s_waitcnt lgkmcnt(5)
    v_mfma_f32_32x32x16_bf16 v[112:127], v[68:71], v[36:39], v[112:127]
    ds_read_b64_tr_b16 v[48:49], v170 offset:64
    ds_read_b64_tr_b16 v[50:51], v170 offset:832
    v_mov_b32 v241, 0
    s_waitcnt lgkmcnt(4)
    v_mfma_f32_32x32x16_bf16 v[80:95], v[40:43], v[160:163], v[80:95]
    ds_read_b128 v[164:167], v23
    ds_read_b64_tr_b16 v[60:61], v171 offset:0
    ds_read_b64_tr_b16 v[62:63], v171 offset:768
    s_waitcnt lgkmcnt(5)
    v_mfma_f32_32x32x16_bf16 v[96:111], v[44:47], v[160:163], v[96:111]
    ds_read_b64_tr_b16 v[64:65], v171 offset:32
    ds_read_b64_tr_b16 v[66:67], v171 offset:800
    s_waitcnt lgkmcnt(5)
    v_mfma_f32_32x32x16_bf16 v[112:127], v[48:51], v[160:163], v[112:127]
    ds_read_b64_tr_b16 v[68:69], v171 offset:64
    ds_read_b64_tr_b16 v[70:71], v171 offset:832
    s_add_u32 s97, s97, 1
    s_cmp_eq_u32 s97, 3
    s_cselect_b32 s57, 4294909952, s98
    s_cselect_b32 s97, 0, s97
    v_add_u32 v20, s57, v20
    v_add_u32 v21, s57, v21
    v_add_u32 v22, s57, v22
    v_add_u32 v23, s57, v23
    v_add_u32 v168, s57, v168
    v_add_u32 v169, s57, v169
    v_add_u32 v170, s57, v170
    v_add_u32 v171, s57, v171
    v_dot2c_f32_bf16 v25, s63, v32
    v_dot2c_f32_bf16 v26, v32, v32
    v_dot2c_f32_bf16 v25, s63, v33
    v_dot2c_f32_bf16 v26, v33, v33
    v_dot2c_f32_bf16 v25, s63, v34
    v_dot2c_f32_bf16 v26, v34, v34
    v_dot2c_f32_bf16 v25, s63, v35
    v_dot2c_f32_bf16 v26, v35, v35
    v_dot2c_f32_bf16 v25, s63, v36
    v_dot2c_f32_bf16 v26, v36, v36
    v_dot2c_f32_bf16 v25, s63, v37
    v_dot2c_f32_bf16 v26, v37, v37
    v_dot2c_f32_bf16 v25, s63, v38
    v_dot2c_f32_bf16 v26, v38, v38
    v_dot2c_f32_bf16 v25, s63, v39
    v_dot2c_f32_bf16 v26, v39, v39
    v_dot2c_f32_bf16 v25, s63, v160
    v_dot2c_f32_bf16 v26, v160, v160
    v_dot2c_f32_bf16 v25, s63, v161
    v_dot2c_f32_bf16 v26, v161, v161
    v_dot2c_f32_bf16 v25, s63, v162
    v_dot2c_f32_bf16 v26, v162, v162
    v_dot2c_f32_bf16 v25, s63, v163
    v_dot2c_f32_bf16 v26, v163, v163
    s_waitcnt lgkmcnt(0)
    v_dot2c_f32_bf16 v25, s63, v164
    v_dot2c_f32_bf16 v26, v164, v164
    v_dot2c_f32_bf16 v25, s63, v165
    v_dot2c_f32_bf16 v26, v165, v165
    v_dot2c_f32_bf16 v25, s63, v166
    v_dot2c_f32_bf16 v26, v166, v166
    v_dot2c_f32_bf16 v25, s63, v167
    v_dot2c_f32_bf16 v26, v167, v167
    v_dot2c_f32_bf16 v27, s63, v60
    v_dot2c_f32_bf16 v28, s63, v64
    v_dot2c_f32_bf16 v29, s63, v68
    v_dot2c_f32_bf16 v27, s63, v61
    v_dot2c_f32_bf16 v28, s63, v65
    v_dot2c_f32_bf16 v29, s63, v69
    v_dot2c_f32_bf16 v27, s63, v62
    v_dot2c_f32_bf16 v28, s63, v66
    v_dot2c_f32_bf16 v29, s63, v70
    v_dot2c_f32_bf16 v27, s63, v63
    v_dot2c_f32_bf16 v28, s63, v67
    v_dot2c_f32_bf16 v29, s63, v71
    s_waitcnt vmcnt(0)
    s_barrier
    v_mfma_f32_32x32x16_bf16 v[80:95], v[60:63], v[164:167], v[80:95]
    ds_read_b128 v[32:35], v20
    ds_read_b64_tr_b16 v[40:41], v168 offset:0
    ds_read_b64_tr_b16 v[42:43], v168 offset:768
    v_mfma_f32_32x32x16_bf16 v[96:111], v[64:67], v[164:167], v[96:111]
    ds_read_b64_tr_b16 v[44:45], v168 offset:32
    ds_read_b64_tr_b16 v[46:47], v168 offset:800
    v_mfma_f32_32x32x16_bf16 v[112:127], v[68:71], v[164:167], v[112:127]
    ds_read_b64_tr_b16 v[48:49], v168 offset:64
    ds_read_b64_tr_b16 v[50:51], v168 offset:832
    buffer_load_dword v197, v199, s[12:15], 0 offen sc1
    s_waitcnt lgkmcnt(4)
    v_mfma_f32_32x32x16_bf16 v[80:95], v[40:43], v[32:35], v[80:95]
    ds_read_b128 v[36:39], v21
    ds_read_b64_tr_b16 v[60:61], v169 offset:0
    ds_read_b64_tr_b16 v[62:63], v169 offset:768
    s_waitcnt lgkmcnt(5)
    v_mfma_f32_32x32x16_bf16 v[96:111], v[44:47], v[32:35], v[96:111]
    ds_read_b64_tr_b16 v[64:65], v169 offset:32
    ds_read_b64_tr_b16 v[66:67], v169 offset:800
    s_waitcnt lgkmcnt(5)
    v_mfma_f32_32x32x16_bf16 v[112:127], v[48:51], v[32:35], v[112:127]
    ds_read_b64_tr_b16 v[68:69], v169 offset:64
    ds_read_b64_tr_b16 v[70:71], v169 offset:832
    s_waitcnt lgkmcnt(4)
    v_mfma_f32_32x32x16_bf16 v[80:95], v[60:63], v[36:39], v[80:95]
    ds_read_b128 v[160:163], v22
    ds_read_b64_tr_b16 v[40:41], v170 offset:0
    ds_read_b64_tr_b16 v[42:43], v170 offset:768
    s_waitcnt lgkmcnt(5)
    v_mfma_f32_32x32x16_bf16 v[96:111], v[64:67], v[36:39], v[96:111]
    ds_read_b64_tr_b16 v[44:45], v170 offset:32
    ds_read_b64_tr_b16 v[46:47], v170 offset:800
    s_waitcnt lgkmcnt(5)
    v_mfma_f32_32x32x16_bf16 v[112:127], v[68:71], v[36:39], v[112:127]
    ds_read_b64_tr_b16 v[48:49], v170 offset:64
    ds_read_b64_tr_b16 v[50:51], v170 offset:832
    s_waitcnt lgkmcnt(4)
    v_mfma_f32_32x32x16_bf16 v[80:95], v[40:43], v[160:163], v[80:95]
    ds_read_b128 v[164:167], v23
    ds_read_b64_tr_b16 v[60:61], v171 offset:0
    ds_read_b64_tr_b16 v[62:63], v171 offset:768
    s_waitcnt lgkmcnt(5)
    v_mfma_f32_32x32x16_bf16 v[96:111], v[44:47], v[160:163], v[96:111]
    ds_read_b64_tr_b16 v[64:65], v171 offset:32
    ds_read_b64_tr_b16 v[66:67], v171 offset:800
    s_waitcnt lgkmcnt(5)
    v_mfma_f32_32x32x16_bf16 v[112:127], v[48:51], v[160:163], v[112:127]
    ds_read_b64_tr_b16 v[68:69], v171 offset:64
    ds_read_b64_tr_b16 v[70:71], v171 offset:832
    s_add_u32 s97, s97, 1
    s_cmp_eq_u32 s97, 3
    s_cselect_b32 s57, 4294909952, s98
    s_cselect_b32 s97, 0, s97
    v_add_u32 v20, s57, v20
    v_add_u32 v21, s57, v21
    v_add_u32 v22, s57, v22
    v_add_u32 v23, s57, v23
    v_add_u32 v168, s57, v168
    v_add_u32 v169, s57, v169
    v_add_u32 v170, s57, v170
    v_add_u32 v171, s57, v171
    v_dot2c_f32_bf16 v25, s63, v32
    v_dot2c_f32_bf16 v26, v32, v32
    v_dot2c_f32_bf16 v25, s63, v33
    v_dot2c_f32_bf16 v26, v33, v33
    v_dot2c_f32_bf16 v25, s63, v34
    v_dot2c_f32_bf16 v26, v34, v34
    v_dot2c_f32_bf16 v25, s63, v35
    v_dot2c_f32_bf16 v26, v35, v35
    v_dot2c_f32_bf16 v25, s63, v36
    v_dot2c_f32_bf16 v26, v36, v36
    v_dot2c_f32_bf16 v25, s63, v37
    v_dot2c_f32_bf16 v26, v37, v37
    v_dot2c_f32_bf16 v25, s63, v38
    v_dot2c_f32_bf16 v26, v38, v38
    v_dot2c_f32_bf16 v25, s63, v39
    v_dot2c_f32_bf16 v26, v39, v39
    v_dot2c_f32_bf16 v25, s63, v160
    v_dot2c_f32_bf16 v26, v160, v160
    v_dot2c_f32_bf16 v25, s63, v161
    v_dot2c_f32_bf16 v26, v161, v161
    v_dot2c_f32_bf16 v25, s63, v162
    v_dot2c_f32_bf16 v26, v162, v162
    v_dot2c_f32_bf16 v25, s63, v163
    v_dot2c_f32_bf16 v26, v163, v163
    s_waitcnt lgkmcnt(0)
    v_dot2c_f32_bf16 v25, s63, v164
    v_dot2c_f32_bf16 v26, v164, v164
    v_dot2c_f32_bf16 v25, s63, v165
    v_dot2c_f32_bf16 v26, v165, v165
    v_dot2c_f32_bf16 v25, s63, v166
    v_dot2c_f32_bf16 v26, v166, v166
    v_dot2c_f32_bf16 v25, s63, v167
    v_dot2c_f32_bf16 v26, v167, v167
    v_dot2c_f32_bf16 v27, s63, v60
    v_dot2c_f32_bf16 v28, s63, v64
    v_dot2c_f32_bf16 v29, s63, v68
    v_dot2c_f32_bf16 v27, s63, v61
    v_dot2c_f32_bf16 v28, s63, v65
    v_dot2c_f32_bf16 v29, s63, v69
    v_dot2c_f32_bf16 v27, s63, v62
    v_dot2c_f32_bf16 v28, s63, v66
    v_dot2c_f32_bf16 v29, s63, v70
    v_dot2c_f32_bf16 v27, s63, v63
    v_dot2c_f32_bf16 v28, s63, v67
    v_dot2c_f32_bf16 v29, s63, v71
    v_mfma_f32_32x32x16_bf16 v[80:95], v[60:63], v[164:167], v[80:95]
    ds_read_b64_tr_b16 v[208:209], v200 offset:0
    ds_read_b64_tr_b16 v[210:211], v200 offset:160
    ds_read_b64_tr_b16 v[212:213], v200 offset:320
    ds_read_b64_tr_b16 v[214:215], v200 offset:480
    v_mfma_f32_32x32x16_bf16 v[96:111], v[64:67], v[164:167], v[96:111]
    ds_read_b64_tr_b16 v[216:217], v200 offset:640
    ds_read_b64_tr_b16 v[220:221], v201 offset:0
    ds_read_b64_tr_b16 v[222:223], v201 offset:160
    ds_read_b64_tr_b16 v[224:225], v201 offset:320
    v_mfma_f32_32x32x16_bf16 v[112:127], v[68:71], v[164:167], v[112:127]
    ds_read_b64_tr_b16 v[226:227], v201 offset:480
    ds_read_b64_tr_b16 v[228:229], v201 offset:640
    ds_read_b64_tr_b16 v[230:231], v202 offset:0
    ds_read_b64_tr_b16 v[232:233], v202 offset:160
    s_mov_b32 s24, s12
    s_mov_b32 s25, s13
    s_mov_b32 s26, s14
    s_mov_b32 s27, 0x00020000
    s_waitcnt vmcnt(0)
    v_readfirstlane_b32 s57, v196
    v_cmp_gt_u32 vcc, 16, v197
    s_nop 0
    s_xor_b32 s57, s57, 1
    s_and_b32 s58, vcc_lo, 0xff
    s_or_b32 s57, s57, s58
    s_cbranch_scc1 slow_27
fast_28:
    v_mov_b32 v180, v25
    v_mov_b32 v181, v26
    v_and_b32 v4, 31, v1
    v_lshlrev_b32 v4, 2, v4
    v_lshrrev_b32 v6, 5, v1
    s_lshl_b32 s57, s42, 9
    s_add_u32 s57, s57, 152832
    v_lshl_add_u32 v5, v6, 8, v4
    v_add_u32 v5, s57, v5
    v_cvt_pk_bf16_f32 v40, v27, v27
    v_and_b32 v40, 0xffff0000, v40
    v_sub_f32 v40, v27, v40
    v_cvt_pk_bf16_f32 v40, v27, v40
    s_waitcnt lgkmcnt(6)
    ds_write_b32 v5, v40 offset:0
    v_cvt_pk_bf16_f32 v41, v28, v28
    v_and_b32 v41, 0xffff0000, v41
    v_sub_f32 v41, v28, v41
    v_cvt_pk_bf16_f32 v41, v28, v41
    ds_write_b32 v5, v41 offset:2048
    v_cvt_pk_bf16_f32 v42, v29, v29
    v_and_b32 v42, 0xffff0000, v42
    v_sub_f32 v42, v29, v42
    v_cvt_pk_bf16_f32 v42, v29, v42
    ds_write_b32 v5, v42 offset:4096
    v_permlane32_swap_b32 v180, v25
    v_permlane32_swap_b32 v181, v26
    v_lshl_add_u32 v4, v6, 10, v4
    v_add_u32 v4, 152832, v4
    s_waitcnt lgkmcnt(0)
    s_barrier
    ds_read2st64_b32 v[40:41], v4 offset0:0 offset1:1
    ds_read2st64_b32 v[42:43], v4 offset0:2 offset1:3
    ds_read2st64_b32 v[44:45], v4 offset0:8 offset1:9
    ds_read2st64_b32 v[46:47], v4 offset0:10 offset1:11
    ds_read2st64_b32 v[48:49], v4 offset0:16 offset1:17
    ds_read2st64_b32 v[50:51], v4 offset0:18 offset1:19
    v_add_f32 v25, v25, v180
    v_add_f32 v7, v26, v181
    v_mul_f32 v9, 0xbacccccd, v25
    v_cvt_pk_bf16_f32 v32, v9, v9
    v_mul_f32 v2, 0x3acccccd, v7
    v_mov_b32 v33, v32
    v_mov_b32 v34, v32
    v_mov_b32 v35, v32
    v_fma_f32 v2, -v9, v9, v2
    v_max_f32 v2, 0, v2
    v_add_f32 v2, 0x3727c5ac, v2
    v_rsq_f32 v2, v2
    s_waitcnt lgkmcnt(4)
    v_mfma_f32_32x32x16_bf16 v[80:95], v[40:43], v[32:35], v[80:95]
    ds_read_b64_tr_b16 v[234:235], v202 offset:320
    ds_read_b64_tr_b16 v[236:237], v202 offset:480
    ds_read_b64_tr_b16 v[238:239], v202 offset:640
    s_waitcnt lgkmcnt(5)
    v_mfma_f32_32x32x16_bf16 v[96:111], v[44:47], v[32:35], v[96:111]
    ds_read_b64_tr_b16 v[242:243], v203 offset:0
    ds_read_b64_tr_b16 v[244:245], v203 offset:160
    ds_read_b64_tr_b16 v[246:247], v203 offset:320
    s_waitcnt lgkmcnt(6)
    v_mfma_f32_32x32x16_bf16 v[112:127], v[48:51], v[32:35], v[112:127]
    ds_read_b64_tr_b16 v[248:249], v203 offset:480
    ds_read_b64_tr_b16 v[250:251], v203 offset:640
    v_lshlrev_b32 v10, 4, v1
    v_pk_mul_f32 v[80:81], v[80:81], v[2:3] op_sel_hi:[1,0]
    v_pk_mul_f32 v[82:83], v[82:83], v[2:3] op_sel_hi:[1,0]
    v_pk_mul_f32 v[84:85], v[84:85], v[2:3] op_sel_hi:[1,0]
    v_pk_mul_f32 v[86:87], v[86:87], v[2:3] op_sel_hi:[1,0]
    v_pk_mul_f32 v[88:89], v[88:89], v[2:3] op_sel_hi:[1,0]
    v_pk_mul_f32 v[90:91], v[90:91], v[2:3] op_sel_hi:[1,0]
    v_pk_mul_f32 v[92:93], v[92:93], v[2:3] op_sel_hi:[1,0]
    v_pk_mul_f32 v[94:95], v[94:95], v[2:3] op_sel_hi:[1,0]
    v_pk_mul_f32 v[96:97], v[96:97], v[2:3] op_sel_hi:[1,0]
    v_pk_mul_f32 v[98:99], v[98:99], v[2:3] op_sel_hi:[1,0]
    v_pk_mul_f32 v[100:101], v[100:101], v[2:3] op_sel_hi:[1,0]
    v_pk_mul_f32 v[102:103], v[102:103], v[2:3] op_sel_hi:[1,0]
    v_pk_mul_f32 v[104:105], v[104:105], v[2:3] op_sel_hi:[1,0]
    v_pk_mul_f32 v[106:107], v[106:107], v[2:3] op_sel_hi:[1,0]
    v_pk_mul_f32 v[108:109], v[108:109], v[2:3] op_sel_hi:[1,0]
    v_pk_mul_f32 v[110:111], v[110:111], v[2:3] op_sel_hi:[1,0]
    v_pk_mul_f32 v[112:113], v[112:113], v[2:3] op_sel_hi:[1,0]
    v_pk_mul_f32 v[114:115], v[114:115], v[2:3] op_sel_hi:[1,0]
    v_pk_mul_f32 v[116:117], v[116:117], v[2:3] op_sel_hi:[1,0]
    v_pk_mul_f32 v[118:119], v[118:119], v[2:3] op_sel_hi:[1,0]
    v_cvt_pk_bf16_f32 v40, v80, v81
    v_cvt_pk_bf16_f32 v41, v82, v83
    v_cvt_pk_bf16_f32 v42, v84, v85
    v_cvt_pk_bf16_f32 v43, v86, v87
    v_cvt_pk_bf16_f32 v44, v88, v89
    v_cvt_pk_bf16_f32 v45, v90, v91
    v_cvt_pk_bf16_f32 v46, v92, v93
    v_cvt_pk_bf16_f32 v47, v94, v95
    v_cvt_pk_bf16_f32 v48, v96, v97
    v_cvt_pk_bf16_f32 v49, v98, v99
    v_cvt_pk_bf16_f32 v50, v100, v101
    v_cvt_pk_bf16_f32 v51, v102, v103
    v_cvt_pk_bf16_f32 v52, v104, v105
    v_cvt_pk_bf16_f32 v53, v106, v107
    v_cvt_pk_bf16_f32 v54, v108, v109
    v_cvt_pk_bf16_f32 v55, v110, v111
    v_cvt_pk_bf16_f32 v56, v112, v113
    v_cvt_pk_bf16_f32 v57, v114, v115
    v_cvt_pk_bf16_f32 v58, v116, v117
    v_cvt_pk_bf16_f32 v59, v118, v119
    s_waitcnt lgkmcnt(0)
    v_mfma_f32_32x32x16_bf16 v[160:175], v[208:211], v[40:43], 0
    v_mfma_f32_32x32x16_bf16 v[176:191], v[220:223], v[40:43], 0
    v_mfma_f32_32x32x16_bf16 v[160:175], v[212:215], v[44:47], v[160:175]
    v_mfma_f32_32x32x16_bf16 v[176:191], v[224:227], v[44:47], v[176:191]
    v_mfma_f32_32x32x16_bf16 v[160:175], v[216:219], v[48:51], v[160:175]
    v_mfma_f32_32x32x16_bf16 v[192:207], v[240:243], v[48:51], 0
    v_mfma_f32_32x32x16_bf16 v[176:191], v[228:231], v[48:51], v[176:191]
    v_mfma_f32_32x32x16_bf16 v[192:207], v[244:247], v[52:55], v[192:207]
    v_mfma_f32_32x32x16_bf16 v[176:191], v[232:235], v[52:55], v[176:191]
    v_mfma_f32_32x32x16_bf16 v[192:207], v[248:251], v[56:59], v[192:207]
    v_mfma_f32_32x32x16_bf16 v[176:191], v[236:239], v[56:59], v[176:191]
    s_mul_i32 s59, s50, 102400
    s_mul_i32 s60, s42, 25600
    s_add_u32 s59, s59, s60
    s_add_u32 s59, s59, 65536
    s_add_u32 m0, s60, 0
    s_nop 0
    buffer_load_dwordx4 v10, s[12:15], s59 offen offset:0 sc1 lds
    buffer_load_dwordx4 v10, s[12:15], s59 offen offset:1024 sc1 lds
    buffer_load_dwordx4 v10, s[12:15], s59 offen offset:2048 sc1 lds
    buffer_load_dwordx4 v10, s[12:15], s59 offen offset:3072 sc1 lds
    s_add_u32 m0, s60, 4096
    s_add_u32 s59, s59, 4096
    buffer_load_dwordx4 v10, s[12:15], s59 offen offset:0 sc1 lds
    buffer_load_dwordx4 v10, s[12:15], s59 offen offset:1024 sc1 lds
    buffer_load_dwordx4 v10, s[12:15], s59 offen offset:2048 sc1 lds
    v_max3_f32 v32, v160, v161, v162
    v_min3_f32 v33, v160, v161, v162
    v_max3_f32 v32, v32, v163, v164
    v_min3_f32 v33, v33, v163, v164
    v_max3_f32 v32, v32, v165, v166
    v_min3_f32 v33, v33, v165, v166
    buffer_load_dwordx4 v10, s[12:15], s59 offen offset:3072 sc1 lds
    v_max3_f32 v32, v32, v167, v168
    v_min3_f32 v33, v33, v167, v168
    v_max3_f32 v32, v32, v169, v170
    v_min3_f32 v33, v33, v169, v170
    v_max3_f32 v32, v32, v171, v172
    v_min3_f32 v33, v33, v171, v172
    s_add_u32 m0, s60, 8192
    s_add_u32 s59, s59, 4096
    buffer_load_dwordx4 v10, s[12:15], s59 offen offset:0 sc1 lds
    v_max3_f32 v32, v32, v173, v174
    v_min3_f32 v33, v33, v173, v174
    v_max3_f32 v32, v32, v175, v176
    v_min3_f32 v33, v33, v175, v176
    v_max3_f32 v32, v32, v177, v178
    v_min3_f32 v33, v33, v177, v178
    buffer_load_dwordx4 v10, s[12:15], s59 offen offset:1024 sc1 lds
    v_max_f32 v32, v32, v179
    v_min_f32 v33, v33, v179
    v_mul_f32 v32, 0xbfb8aa3b, v32
    v_mul_f32 v33, 0x3fb8aa3b, v33
    v_pk_fma_f32 v[84:85], v[160:161], s[66:67], v[32:33] op_sel_hi:[1,1,0]
    v_pk_fma_f32 v[160:161], v[160:161], s[66:67], v[32:33] op_sel:[0,0,1] op_sel_hi:[1,1,1] neg_lo:[1,0,0] neg_hi:[1,0,0]
    buffer_load_dwordx4 v10, s[12:15], s59 offen offset:2048 sc1 lds
    v_pk_fma_f32 v[86:87], v[162:163], s[66:67], v[32:33] op_sel_hi:[1,1,0]
    v_pk_fma_f32 v[162:163], v[162:163], s[66:67], v[32:33] op_sel:[0,0,1] op_sel_hi:[1,1,1] neg_lo:[1,0,0] neg_hi:[1,0,0]
    v_pk_fma_f32 v[88:89], v[164:165], s[66:67], v[32:33] op_sel_hi:[1,1,0]
    v_pk_fma_f32 v[164:165], v[164:165], s[66:67], v[32:33] op_sel:[0,0,1] op_sel_hi:[1,1,1] neg_lo:[1,0,0] neg_hi:[1,0,0]
    v_pk_fma_f32 v[90:91], v[166:167], s[66:67], v[32:33] op_sel_hi:[1,1,0]
    v_pk_fma_f32 v[166:167], v[166:167], s[66:67], v[32:33] op_sel:[0,0,1] op_sel_hi:[1,1,1] neg_lo:[1,0,0] neg_hi:[1,0,0]
    buffer_load_dwordx4 v10, s[12:15], s59 offen offset:3072 sc1 lds
    v_pk_fma_f32 v[92:93], v[168:169], s[66:67], v[32:33] op_sel_hi:[1,1,0]
    v_pk_fma_f32 v[168:169], v[168:169], s[66:67], v[32:33] op_sel:[0,0,1] op_sel_hi:[1,1,1] neg_lo:[1,0,0] neg_hi:[1,0,0]
    v_pk_fma_f32 v[94:95], v[170:171], s[66:67], v[32:33] op_sel_hi:[1,1,0]
    v_pk_fma_f32 v[170:171], v[170:171], s[66:67], v[32:33] op_sel:[0,0,1] op_sel_hi:[1,1,1] neg_lo:[1,0,0] neg_hi:[1,0,0]
    v_pk_fma_f32 v[96:97], v[172:173], s[66:67], v[32:33] op_sel_hi:[1,1,0]
    v_pk_fma_f32 v[172:173], v[172:173], s[66:67], v[32:33] op_sel:[0,0,1] op_sel_hi:[1,1,1] neg_lo:[1,0,0] neg_hi:[1,0,0]
    s_add_u32 m0, s60, 12288
    s_add_u32 s59, s59, 4096
    buffer_load_dwordx4 v10, s[12:15], s59 offen offset:0 sc1 lds
    v_pk_fma_f32 v[98:99], v[174:175], s[66:67], v[32:33] op_sel_hi:[1,1,0]
    v_pk_fma_f32 v[174:175], v[174:175], s[66:67], v[32:33] op_sel:[0,0,1] op_sel_hi:[1,1,1] neg_lo:[1,0,0] neg_hi:[1,0,0]
    v_pk_fma_f32 v[100:101], v[176:177], s[66:67], v[32:33] op_sel_hi:[1,1,0]
    v_pk_fma_f32 v[176:177], v[176:177], s[66:67], v[32:33] op_sel:[0,0,1] op_sel_hi:[1,1,1] neg_lo:[1,0,0] neg_hi:[1,0,0]
    v_pk_fma_f32 v[102:103], v[178:179], s[66:67], v[32:33] op_sel_hi:[1,1,0]
    v_pk_fma_f32 v[178:179], v[178:179], s[66:67], v[32:33] op_sel:[0,0,1] op_sel_hi:[1,1,1] neg_lo:[1,0,0] neg_hi:[1,0,0]
    buffer_load_dwordx4 v10, s[12:15], s59 offen offset:1024 sc1 lds
    v_exp_f32_e64 v84, v84
    v_exp_f32_e64 v160, v160
    v_exp_f32_e64 v85, v85
    v_exp_f32_e64 v161, v161
    v_exp_f32_e64 v86, v86
    v_exp_f32_e64 v162, v162
    buffer_load_dwordx4 v10, s[12:15], s59 offen offset:2048 sc1 lds
    v_exp_f32_e64 v87, v87
    v_exp_f32_e64 v163, v163
    v_exp_f32_e64 v88, v88
    v_exp_f32_e64 v164, v164
    v_exp_f32_e64 v89, v89
    v_exp_f32_e64 v165, v165
    buffer_load_dwordx4 v10, s[12:15], s59 offen offset:3072 sc1 lds
    v_exp_f32_e64 v90, v90
    v_exp_f32_e64 v166, v166
    v_exp_f32_e64 v91, v91
    v_exp_f32_e64 v167, v167
    v_exp_f32_e64 v92, v92
    v_exp_f32_e64 v168, v168
    s_add_u32 m0, s60, 16384
    s_add_u32 s59, s59, 4096
    buffer_load_dwordx4 v10, s[12:15], s59 offen offset:0 sc1 lds
    v_exp_f32_e64 v93, v93
    v_exp_f32_e64 v169, v169
    v_exp_f32_e64 v94, v94
    v_exp_f32_e64 v170, v170
    v_exp_f32_e64 v95, v95
    v_exp_f32_e64 v171, v171
    buffer_load_dwordx4 v10, s[12:15], s59 offen offset:1024 sc1 lds
    v_exp_f32_e64 v96, v96
    v_exp_f32_e64 v172, v172
    v_exp_f32_e64 v97, v97
    v_exp_f32_e64 v173, v173
    v_exp_f32_e64 v98, v98
    v_exp_f32_e64 v174, v174
    buffer_load_dwordx4 v10, s[12:15], s59 offen offset:2048 sc1 lds
    v_exp_f32_e64 v99, v99
    v_exp_f32_e64 v175, v175
    v_exp_f32_e64 v100, v100
    v_exp_f32_e64 v176, v176
    v_exp_f32_e64 v101, v101
    v_exp_f32_e64 v177, v177
    buffer_load_dwordx4 v10, s[12:15], s59 offen offset:3072 sc1 lds
    v_exp_f32_e64 v102, v102
    v_exp_f32_e64 v178, v178
    v_exp_f32_e64 v103, v103
    v_exp_f32_e64 v179, v179
    v_pk_add_f32 v[32:33], v[84:85], v[86:87]
    v_pk_add_f32 v[34:35], v[160:161], v[162:163]
    s_add_u32 m0, s60, 20480
    s_add_u32 s59, s59, 4096
    buffer_load_dwordx4 v10, s[12:15], s59 offen offset:0 sc1 lds
    v_pk_add_f32 v[32:33], v[32:33], v[88:89]
    v_pk_add_f32 v[34:35], v[34:35], v[164:165]
    v_pk_add_f32 v[32:33], v[32:33], v[90:91]
    v_pk_add_f32 v[34:35], v[34:35], v[166:167]
    v_pk_add_f32 v[32:33], v[32:33], v[92:93]
    v_pk_add_f32 v[34:35], v[34:35], v[168:169]
    buffer_load_dwordx4 v10, s[12:15], s59 offen offset:1024 sc1 lds
    v_pk_add_f32 v[32:33], v[32:33], v[94:95]
    v_pk_add_f32 v[34:35], v[34:35], v[170:171]
    v_pk_add_f32 v[32:33], v[32:33], v[96:97]
    v_pk_add_f32 v[34:35], v[34:35], v[172:173]
    v_pk_add_f32 v[32:33], v[32:33], v[98:99]
    v_pk_add_f32 v[34:35], v[34:35], v[174:175]
    buffer_load_dwordx4 v10, s[12:15], s59 offen offset:2048 sc1 lds
    v_pk_add_f32 v[32:33], v[32:33], v[100:101]
    v_pk_add_f32 v[34:35], v[34:35], v[176:177]
    v_pk_add_f32 v[32:33], v[32:33], v[102:103]
    v_pk_add_f32 v[34:35], v[34:35], v[178:179]
    v_add_f32 v32, v32, v33
    v_add_f32 v34, v34, v35
    buffer_load_dwordx4 v10, s[12:15], s59 offen offset:3072 sc1 lds
    v_rcp_f32 v32, v32
    v_rcp_f32 v34, v34
    v_pk_mul_f32 v[84:85], v[84:85], v[32:33] op_sel_hi:[1,0]
    v_pk_mul_f32 v[86:87], v[86:87], v[32:33] op_sel_hi:[1,0]
    v_pk_mul_f32 v[88:89], v[88:89], v[32:33] op_sel_hi:[1,0]
    v_pk_mul_f32 v[90:91], v[90:91], v[32:33] op_sel_hi:[1,0]
    s_add_u32 m0, s60, 24576
    s_add_u32 s59, s59, 4096
    buffer_load_dwordx4 v10, s[12:15], s59 offen offset:0 sc1 lds
    v_pk_mul_f32 v[92:93], v[92:93], v[32:33] op_sel_hi:[1,0]
    v_pk_mul_f32 v[94:95], v[94:95], v[32:33] op_sel_hi:[1,0]
    v_pk_mul_f32 v[96:97], v[96:97], v[32:33] op_sel_hi:[1,0]
    v_pk_mul_f32 v[98:99], v[98:99], v[32:33] op_sel_hi:[1,0]
    v_pk_mul_f32 v[100:101], v[100:101], v[32:33] op_sel_hi:[1,0]
    v_pk_mul_f32 v[102:103], v[102:103], v[32:33] op_sel_hi:[1,0]
    s_lshl_b32 s101, s51, 2
    s_add_u32 s101, s101, s42
    s_mul_i32 s101, s101, 61440
    s_add_u32 s101, s101, 1048576
    buffer_load_dwordx4 a[0:3], v10, s[12:15], s101 offen offset:0 sc1
    v_cvt_pk_bf16_f32 v208, v84, v85
    v_pk_mul_f32 v[160:161], v[160:161], v[34:35] op_sel_hi:[1,0]
    v_cvt_pk_bf16_f32 v209, v86, v87
    v_pk_mul_f32 v[162:163], v[162:163], v[34:35] op_sel_hi:[1,0]
    v_cvt_pk_bf16_f32 v210, v88, v89
    v_pk_mul_f32 v[164:165], v[164:165], v[34:35] op_sel_hi:[1,0]
    buffer_load_dwordx4 a[4:7], v10, s[12:15], s101 offen offset:1024 sc1
    v_cvt_pk_bf16_f32 v211, v90, v91
    v_pk_mul_f32 v[166:167], v[166:167], v[34:35] op_sel_hi:[1,0]
    v_cvt_pk_bf16_f32 v212, v92, v93
    v_pk_mul_f32 v[168:169], v[168:169], v[34:35] op_sel_hi:[1,0]
    v_cvt_pk_bf16_f32 v213, v94, v95
    v_pk_mul_f32 v[170:171], v[170:171], v[34:35] op_sel_hi:[1,0]
    buffer_load_dwordx4 a[8:11], v10, s[12:15], s101 offen offset:2048 sc1
    v_cvt_pk_bf16_f32 v214, v96, v97
    v_pk_mul_f32 v[172:173], v[172:173], v[34:35] op_sel_hi:[1,0]
    v_cvt_pk_bf16_f32 v215, v98, v99
    v_pk_mul_f32 v[174:175], v[174:175], v[34:35] op_sel_hi:[1,0]
    v_cvt_pk_bf16_f32 v216, v100, v101
    v_pk_mul_f32 v[176:177], v[176:177], v[34:35] op_sel_hi:[1,0]
    buffer_load_dwordx4 a[12:15], v10, s[12:15], s101 offen offset:3072 sc1
    v_cvt_pk_bf16_f32 v217, v102, v103
    v_pk_mul_f32 v[178:179], v[178:179], v[34:35] op_sel_hi:[1,0]
    v_cvt_pk_bf16_f32 v218, v160, v161
    v_cvt_pk_bf16_f32 v219, v162, v163
    v_cvt_pk_bf16_f32 v220, v164, v165
    v_cvt_pk_bf16_f32 v221, v166, v167
    s_add_u32 s101, s101, 4096
    buffer_load_dwordx4 a[16:19], v10, s[12:15], s101 offen offset:0 sc1
    v_cvt_pk_bf16_f32 v222, v168, v169
    v_cvt_pk_bf16_f32 v223, v170, v171
    v_cvt_pk_bf16_f32 v224, v172, v173
    v_cvt_pk_bf16_f32 v225, v174, v175
    v_cvt_pk_bf16_f32 v226, v176, v177
    v_cvt_pk_bf16_f32 v227, v178, v179
    buffer_load_dwordx4 a[20:23], v10, s[12:15], s101 offen offset:1024 sc1
    v_max3_f32 v36, v180, v181, v182
    v_min3_f32 v37, v180, v181, v182
    v_max3_f32 v36, v36, v183, v184
    v_min3_f32 v37, v37, v183, v184
    v_max3_f32 v36, v36, v185, v186
    v_min3_f32 v37, v37, v185, v186
    buffer_load_dwordx4 a[24:27], v10, s[12:15], s101 offen offset:2048 sc1
    v_max3_f32 v36, v36, v187, v188
    v_min3_f32 v37, v37, v187, v188
    v_max3_f32 v36, v36, v189, v190
    v_min3_f32 v37, v37, v189, v190
    v_max3_f32 v36, v36, v191, v192
    v_min3_f32 v37, v37, v191, v192
    buffer_load_dwordx4 a[28:31], v10, s[12:15], s101 offen offset:3072 sc1
    v_max3_f32 v36, v36, v193, v194
    v_min3_f32 v37, v37, v193, v194
    v_max3_f32 v36, v36, v195, v196
    v_min3_f32 v37, v37, v195, v196
    v_max3_f32 v36, v36, v197, v198
    v_min3_f32 v37, v37, v197, v198
    s_add_u32 s101, s101, 4096
    buffer_load_dwordx4 a[32:35], v10, s[12:15], s101 offen offset:0 sc1
    v_max_f32 v36, v36, v199
    v_min_f32 v37, v37, v199
    v_mul_f32 v36, 0xbfb8aa3b, v36
    v_mul_f32 v37, 0x3fb8aa3b, v37
    v_pk_fma_f32 v[104:105], v[180:181], s[66:67], v[36:37] op_sel_hi:[1,1,0]
    v_pk_fma_f32 v[180:181], v[180:181], s[66:67], v[36:37] op_sel:[0,0,1] op_sel_hi:[1,1,1] neg_lo:[1,0,0] neg_hi:[1,0,0]
    buffer_load_dwordx4 a[36:39], v10, s[12:15], s101 offen offset:1024 sc1
    v_pk_fma_f32 v[106:107], v[182:183], s[66:67], v[36:37] op_sel_hi:[1,1,0]
    v_pk_fma_f32 v[182:183], v[182:183], s[66:67], v[36:37] op_sel:[0,0,1] op_sel_hi:[1,1,1] neg_lo:[1,0,0] neg_hi:[1,0,0]
    v_pk_fma_f32 v[108:109], v[184:185], s[66:67], v[36:37] op_sel_hi:[1,1,0]
    v_pk_fma_f32 v[184:185], v[184:185], s[66:67], v[36:37] op_sel:[0,0,1] op_sel_hi:[1,1,1] neg_lo:[1,0,0] neg_hi:[1,0,0]
    v_pk_fma_f32 v[110:111], v[186:187], s[66:67], v[36:37] op_sel_hi:[1,1,0]
    v_pk_fma_f32 v[186:187], v[186:187], s[66:67], v[36:37] op_sel:[0,0,1] op_sel_hi:[1,1,1] neg_lo:[1,0,0] neg_hi:[1,0,0]
    buffer_load_dwordx4 a[40:43], v10, s[12:15], s101 offen offset:2048 sc1
    v_pk_fma_f32 v[112:113], v[188:189], s[66:67], v[36:37] op_sel_hi:[1,1,0]
    v_pk_fma_f32 v[188:189], v[188:189], s[66:67], v[36:37] op_sel:[0,0,1] op_sel_hi:[1,1,1] neg_lo:[1,0,0] neg_hi:[1,0,0]
    v_pk_fma_f32 v[114:115], v[190:191], s[66:67], v[36:37] op_sel_hi:[1,1,0]
    v_pk_fma_f32 v[190:191], v[190:191], s[66:67], v[36:37] op_sel:[0,0,1] op_sel_hi:[1,1,1] neg_lo:[1,0,0] neg_hi:[1,0,0]
    v_pk_fma_f32 v[116:117], v[192:193], s[66:67], v[36:37] op_sel_hi:[1,1,0]
    v_pk_fma_f32 v[192:193], v[192:193], s[66:67], v[36:37] op_sel:[0,0,1] op_sel_hi:[1,1,1] neg_lo:[1,0,0] neg_hi:[1,0,0]
    buffer_load_dwordx4 a[44:47], v10, s[12:15], s101 offen offset:3072 sc1
    v_pk_fma_f32 v[118:119], v[194:195], s[66:67], v[36:37] op_sel_hi:[1,1,0]
    v_pk_fma_f32 v[194:195], v[194:195], s[66:67], v[36:37] op_sel:[0,0,1] op_sel_hi:[1,1,1] neg_lo:[1,0,0] neg_hi:[1,0,0]
    v_pk_fma_f32 v[120:121], v[196:197], s[66:67], v[36:37] op_sel_hi:[1,1,0]
    v_pk_fma_f32 v[196:197], v[196:197], s[66:67], v[36:37] op_sel:[0,0,1] op_sel_hi:[1,1,1] neg_lo:[1,0,0] neg_hi:[1,0,0]
    v_pk_fma_f32 v[122:123], v[198:199], s[66:67], v[36:37] op_sel_hi:[1,1,0]
    v_pk_fma_f32 v[198:199], v[198:199], s[66:67], v[36:37] op_sel:[0,0,1] op_sel_hi:[1,1,1] neg_lo:[1,0,0] neg_hi:[1,0,0]
    s_add_u32 s101, s101, 4096
    buffer_load_dwordx4 a[48:51], v10, s[12:15], s101 offen offset:0 sc1
    v_exp_f32_e64 v104, v104
    v_exp_f32_e64 v180, v180
    v_exp_f32_e64 v105, v105
    v_exp_f32_e64 v181, v181
    v_exp_f32_e64 v106, v106
    v_exp_f32_e64 v182, v182
    buffer_load_dwordx4 a[52:55], v10, s[12:15], s101 offen offset:1024 sc1
    v_exp_f32_e64 v107, v107
    v_exp_f32_e64 v183, v183
    v_exp_f32_e64 v108, v108
    v_exp_f32_e64 v184, v184
    v_exp_f32_e64 v109, v109
    v_exp_f32_e64 v185, v185
    buffer_load_dwordx4 a[56:59], v10, s[12:15], s101 offen offset:2048 sc1
    v_exp_f32_e64 v110, v110
    v_exp_f32_e64 v186, v186
    v_exp_f32_e64 v111, v111
    v_exp_f32_e64 v187, v187
    v_exp_f32_e64 v112, v112
    v_exp_f32_e64 v188, v188
    buffer_load_dwordx4 a[60:63], v10, s[12:15], s101 offen offset:3072 sc1
    v_exp_f32_e64 v113, v113
    v_exp_f32_e64 v189, v189
    v_exp_f32_e64 v114, v114
    v_exp_f32_e64 v190, v190
    v_exp_f32_e64 v115, v115
    v_exp_f32_e64 v191, v191
    s_add_u32 s101, s101, 4096
    buffer_load_dwordx4 a[64:67], v10, s[12:15], s101 offen offset:0 sc1
    v_exp_f32_e64 v116, v116
    v_exp_f32_e64 v192, v192
    v_exp_f32_e64 v117, v117
    v_exp_f32_e64 v193, v193
    v_exp_f32_e64 v118, v118
    v_exp_f32_e64 v194, v194
    buffer_load_dwordx4 a[68:71], v10, s[12:15], s101 offen offset:1024 sc1
    v_exp_f32_e64 v119, v119
    v_exp_f32_e64 v195, v195
    v_exp_f32_e64 v120, v120
    v_exp_f32_e64 v196, v196
    v_exp_f32_e64 v121, v121
    v_exp_f32_e64 v197, v197
    buffer_load_dwordx4 a[72:75], v10, s[12:15], s101 offen offset:2048 sc1
    v_exp_f32_e64 v122, v122
    v_exp_f32_e64 v198, v198
    v_exp_f32_e64 v123, v123
    v_exp_f32_e64 v199, v199
    v_pk_add_f32 v[36:37], v[104:105], v[106:107]
    v_pk_add_f32 v[38:39], v[180:181], v[182:183]
    buffer_load_dwordx4 a[76:79], v10, s[12:15], s101 offen offset:3072 sc1
    v_pk_add_f32 v[36:37], v[36:37], v[108:109]
    v_pk_add_f32 v[38:39], v[38:39], v[184:185]
    v_pk_add_f32 v[36:37], v[36:37], v[110:111]
    v_pk_add_f32 v[38:39], v[38:39], v[186:187]
    v_pk_add_f32 v[36:37], v[36:37], v[112:113]
    v_pk_add_f32 v[38:39], v[38:39], v[188:189]
    s_add_u32 s101, s101, 4096
    buffer_load_dwordx4 a[80:83], v10, s[12:15], s101 offen offset:0 sc1
    v_pk_add_f32 v[36:37], v[36:37], v[114:115]
    v_pk_add_f32 v[38:39], v[38:39], v[190:191]
    v_pk_add_f32 v[36:37], v[36:37], v[116:117]
    v_pk_add_f32 v[38:39], v[38:39], v[192:193]
    v_pk_add_f32 v[36:37], v[36:37], v[118:119]
    v_pk_add_f32 v[38:39], v[38:39], v[194:195]
    buffer_load_dwordx4 a[84:87], v10, s[12:15], s101 offen offset:1024 sc1
    v_pk_add_f32 v[36:37], v[36:37], v[120:121]
    v_pk_add_f32 v[38:39], v[38:39], v[196:197]
    v_pk_add_f32 v[36:37], v[36:37], v[122:123]
    v_pk_add_f32 v[38:39], v[38:39], v[198:199]
    v_add_f32 v36, v36, v37
    v_add_f32 v38, v38, v39
    buffer_load_dwordx4 a[88:91], v10, s[12:15], s101 offen offset:2048 sc1
    v_rcp_f32 v36, v36
    v_rcp_f32 v38, v38
    v_pk_mul_f32 v[104:105], v[104:105], v[36:37] op_sel_hi:[1,0]
    v_pk_mul_f32 v[106:107], v[106:107], v[36:37] op_sel_hi:[1,0]
    v_pk_mul_f32 v[108:109], v[108:109], v[36:37] op_sel_hi:[1,0]
    v_pk_mul_f32 v[110:111], v[110:111], v[36:37] op_sel_hi:[1,0]
    buffer_load_dwordx4 a[92:95], v10, s[12:15], s101 offen offset:3072 sc1
    v_pk_mul_f32 v[112:113], v[112:113], v[36:37] op_sel_hi:[1,0]
    v_pk_mul_f32 v[114:115], v[114:115], v[36:37] op_sel_hi:[1,0]
    v_pk_mul_f32 v[116:117], v[116:117], v[36:37] op_sel_hi:[1,0]
    v_pk_mul_f32 v[118:119], v[118:119], v[36:37] op_sel_hi:[1,0]
    v_pk_mul_f32 v[120:121], v[120:121], v[36:37] op_sel_hi:[1,0]
    v_pk_mul_f32 v[122:123], v[122:123], v[36:37] op_sel_hi:[1,0]
    s_waitcnt vmcnt(36)
    v_cvt_pk_bf16_f32 v228, v104, v105
    v_pk_mul_f32 v[180:181], v[180:181], v[38:39] op_sel_hi:[1,0]
    v_cvt_pk_bf16_f32 v229, v106, v107
    v_pk_mul_f32 v[182:183], v[182:183], v[38:39] op_sel_hi:[1,0]
    v_cvt_pk_bf16_f32 v230, v108, v109
    v_pk_mul_f32 v[184:185], v[184:185], v[38:39] op_sel_hi:[1,0]
    s_add_u32 s101, s101, 4096
    buffer_load_dwordx4 a[96:99], v10, s[12:15], s101 offen offset:0 sc1
    v_cvt_pk_bf16_f32 v231, v110, v111
    v_pk_mul_f32 v[186:187], v[186:187], v[38:39] op_sel_hi:[1,0]
    v_cvt_pk_bf16_f32 v232, v112, v113
    v_pk_mul_f32 v[188:189], v[188:189], v[38:39] op_sel_hi:[1,0]
    v_cvt_pk_bf16_f32 v233, v114, v115
    v_pk_mul_f32 v[190:191], v[190:191], v[38:39] op_sel_hi:[1,0]
    buffer_load_dwordx4 a[100:103], v10, s[12:15], s101 offen offset:1024 sc1
    v_cvt_pk_bf16_f32 v234, v116, v117
    v_pk_mul_f32 v[192:193], v[192:193], v[38:39] op_sel_hi:[1,0]
    v_cvt_pk_bf16_f32 v235, v118, v119
    v_pk_mul_f32 v[194:195], v[194:195], v[38:39] op_sel_hi:[1,0]
    v_cvt_pk_bf16_f32 v236, v120, v121
    v_pk_mul_f32 v[196:197], v[196:197], v[38:39] op_sel_hi:[1,0]
    buffer_load_dwordx4 a[104:107], v10, s[12:15], s101 offen offset:2048 sc1
    v_cvt_pk_bf16_f32 v237, v122, v123
    v_pk_mul_f32 v[198:199], v[198:199], v[38:39] op_sel_hi:[1,0]
    v_cvt_pk_bf16_f32 v238, v180, v181
    v_cvt_pk_bf16_f32 v239, v182, v183
    v_cvt_pk_bf16_f32 v240, v184, v185
    v_cvt_pk_bf16_f32 v241, v186, v187
    buffer_load_dwordx4 a[108:111], v10, s[12:15], s101 offen offset:3072 sc1
    v_cvt_pk_bf16_f32 v242, v188, v189
    v_cvt_pk_bf16_f32 v243, v190, v191
    v_cvt_pk_bf16_f32 v244, v192, v193
    v_cvt_pk_bf16_f32 v245, v194, v195
    v_cvt_pk_bf16_f32 v246, v196, v197
    v_cvt_pk_bf16_f32 v247, v198, v199
    s_add_u32 s101, s101, 4096
    buffer_load_dwordx4 a[112:115], v10, s[12:15], s101 offen offset:0 sc1
    buffer_load_dwordx4 a[116:119], v10, s[12:15], s101 offen offset:1024 sc1
    buffer_load_dwordx4 a[120:123], v10, s[12:15], s101 offen offset:2048 sc1
    buffer_load_dwordx4 a[124:127], v10, s[12:15], s101 offen offset:3072 sc1
    s_add_u32 s101, s101, 4096
    buffer_load_dwordx4 a[128:131], v10, s[12:15], s101 offen offset:0 sc1
    buffer_load_dwordx4 a[132:135], v10, s[12:15], s101 offen offset:1024 sc1
    buffer_load_dwordx4 a[136:139], v10, s[12:15], s101 offen offset:2048 sc1
    buffer_load_dwordx4 a[140:143], v10, s[12:15], s101 offen offset:3072 sc1
    s_add_u32 s101, s101, 4096
    buffer_load_dwordx4 a[144:147], v10, s[12:15], s101 offen offset:0 sc1
    buffer_load_dwordx4 a[148:151], v10, s[12:15], s101 offen offset:1024 sc1
    buffer_load_dwordx4 a[152:155], v10, s[12:15], s101 offen offset:2048 sc1
    buffer_load_dwordx4 a[156:159], v10, s[12:15], s101 offen offset:3072 sc1
    s_add_u32 s101, s101, 4096
    buffer_load_dwordx4 a[160:163], v10, s[12:15], s101 offen offset:0 sc1
    buffer_load_dwordx4 a[164:167], v10, s[12:15], s101 offen offset:1024 sc1
    buffer_load_dwordx4 a[168:171], v10, s[12:15], s101 offen offset:2048 sc1
    buffer_load_dwordx4 a[172:175], v10, s[12:15], s101 offen offset:3072 sc1
    s_add_u32 s101, s101, 4096
    buffer_load_dwordx4 a[176:179], v10, s[12:15], s101 offen offset:0 sc1
    buffer_load_dwordx4 a[180:183], v10, s[12:15], s101 offen offset:1024 sc1
    buffer_load_dwordx4 a[184:187], v10, s[12:15], s101 offen offset:2048 sc1
    buffer_load_dwordx4 a[188:191], v10, s[12:15], s101 offen offset:3072 sc1
    v_and_b32 v2, 31, v1
    v_lshrrev_b32 v3, 5, v1
    v_lshlrev_b32 v4, 4, v2
    v_lshl_add_u32 v21, v3, 11, v4
    v_mov_b32 v5, 2147483648
    v_cmp_gt_u32 vcc, 24, v2
    s_nop 1
    v_cndmask_b32 v11, v5, v21, vcc
    v_and_b32 v2, 15, v1
    v_lshrrev_b32 v3, 3, v2
    v_bfe_u32 v4, v1, 4, 1
    v_cmp_eq_u32 s[68:69], v3, v4
    v_and_b32 v3, 1, v1
    v_lshlrev_b32 v3, 4, v3
    v_mov_b32 v4, 0x3f80
    v_lshlrev_b32 v4, v3, v4
    v_cndmask_b32 v4, 0, v4, s[68:69]
    v_bfe_u32 v3, v1, 1, 2
    v_cmp_eq_u32 vcc, 0, v3
    s_nop 1
    v_cndmask_b32 v12, 0, v4, vcc
    v_cmp_eq_u32 vcc, 1, v3
    s_nop 1
    v_cndmask_b32 v13, 0, v4, vcc
    v_cmp_eq_u32 vcc, 2, v3
    s_nop 1
    v_cndmask_b32 v14, 0, v4, vcc
    v_cmp_eq_u32 vcc, 3, v3
    s_nop 1
    v_cndmask_b32 v15, 0, v4, vcc
    v_and_b32 v2, 15, v1
    v_lshrrev_b32 v3, 5, v1
    v_bfe_u32 v4, v1, 4, 1
    v_lshl_add_u32 v2, v3, 4, v2
    v_lshlrev_b32 v2, 4, v2
    v_lshl_add_u32 v2, v4, 3, v2
    s_lshl_b32 s58, s42, 11
    s_add_u32 s58, s58, 135168
    v_add_u32 v16, s58, v2
    v_lshrrev_b32 v2, 5, v1
    v_bfe_u32 v3, v1, 2, 1
    v_bfe_u32 v4, v1, 3, 2
    v_and_b32 v5, 3, v1
    v_cmp_eq_u32 s[68:69], v2, v3
    v_lshlrev_b32 v2, 12, v2
    v_add_u32 v2, 135168, v2
    v_lshl_add_u32 v2, v5, 4, v2
    v_mov_b32 v8, 150784
    v_lshl_add_u32 v6, v4, 6, v2
    v_cndmask_b32 v17, v8, v6, s[68:69]
    v_add_u32 v6, 2048, v6
    v_cndmask_b32 v20, v8, v6, s[68:69]
    v_and_b32 v7, 1, v4
    v_lshl_add_u32 v6, v7, 6, v2
    v_add_u32 v6, 256, v6
    v_cmp_gt_u32 vcc, 2, v4
    s_nop 1
    s_and_b64 vcc, vcc, s[68:69]
    v_cndmask_b32 v18, v8, v6, vcc
    v_add_u32 v6, 2048, v6
    v_cmp_le_u32 vcc, 2, v4
    s_nop 1
    s_and_b64 vcc, vcc, s[68:69]
    v_cndmask_b32 v19, v8, v6, vcc
    v_bfe_u32 v2, v1, 4, 1
    v_mul_u32_u24 v2, 20480, v2
    v_lshrrev_b32 v3, 5, v1
    v_mul_u32_u24 v3, 1280, v3
    v_and_b32 v4, 15, v1
    v_lshlrev_b32 v4, 4, v4
    v_add3_u32 v22, v2, v3, v4
    s_lshl_b32 s100, s45, 3
    s_lshl_b32 s58, s42, 1
    s_add_u32 s100, s100, s58
    s_mul_i32 s100, s100, 20480
    s_mul_i32 s58, s46, 2560
    s_add_u32 s100, s100, s58
    s_add_u32 s100, s100, 7995392
    s_lshl_b32 s59, s46, 2
    s_add_u32 s59, s59, s42
    s_lshl_b32 s59, s59, 15
    s_add_u32 s59, s59, 6946816
    s_and_b32 s60, s45, 7
    s_lshl_b32 s60, s60, 12
    s_waitcnt vmcnt(0)
    s_cmp_eq_u32 s42, 0
    s_cbranch_scc0 pw_30
    s_add_u32 s57, s46, 8
    v_add_u32 v28, s57, v1
    v_lshlrev_b32 v28, 8, v28
    s_mov_b64 exec, 1
    s_mov_b32 s62, 0
pp_31:
    buffer_load_dword v29, v28, s[12:15], 0 offen sc1
    s_waitcnt vmcnt(0)
    v_cmp_gt_u32 vcc, 16, v29
    s_add_u32 s62, s62, 1
    s_cmp_ge_u32 s62, 0x40000
    s_cbranch_scc1 pd_32
    s_nop 1
    s_cbranch_vccnz pp_31
pd_32:
    s_mov_b64 exec, -1
pw_30:
    s_barrier
    s_add_u32 s57, s59, s60
    buffer_load_dwordx4 v[40:43], v21, s[12:15], s57 offen offset:0 sc1
    buffer_load_dwordx4 v[44:47], v21, s[12:15], s57 offen offset:512 sc1
    buffer_load_dwordx4 v[48:51], v21, s[12:15], s57 offen offset:1024 sc1
    buffer_load_dwordx4 v[52:55], v11, s[12:15], s57 offen offset:1536 sc1
    s_add_u32 s60, s60, 4096
    s_and_b32 s60, s60, 0x7fff
    s_add_u32 s57, s59, s60
    buffer_load_dwordx4 v[56:59], v21, s[12:15], s57 offen offset:0 sc1
    buffer_load_dwordx4 v[60:63], v21, s[12:15], s57 offen offset:512 sc1
    buffer_load_dwordx4 v[64:67], v21, s[12:15], s57 offen offset:1024 sc1
    buffer_load_dwordx4 v[68:71], v11, s[12:15], s57 offen offset:1536 sc1
    s_add_u32 s60, s60, 4096
    s_and_b32 s60, s60, 0x7fff
    s_add_u32 s57, s59, s60
    buffer_load_dwordx4 v[72:75], v21, s[12:15], s57 offen offset:0 sc1
    buffer_load_dwordx4 v[76:79], v21, s[12:15], s57 offen offset:512 sc1
    buffer_load_dwordx4 v[80:83], v21, s[12:15], s57 offen offset:1024 sc1
    buffer_load_dwordx4 v[84:87], v11, s[12:15], s57 offen offset:1536 sc1
    s_add_u32 s60, s60, 4096
    s_and_b32 s60, s60, 0x7fff
    s_add_u32 s57, s59, s60
    buffer_load_dwordx4 v[88:91], v21, s[12:15], s57 offen offset:0 sc1
    buffer_load_dwordx4 v[92:95], v21, s[12:15], s57 offen offset:512 sc1
    buffer_load_dwordx4 v[96:99], v21, s[12:15], s57 offen offset:1024 sc1
    buffer_load_dwordx4 v[100:103], v11, s[12:15], s57 offen offset:1536 sc1
    s_add_u32 s60, s60, 4096
    s_and_b32 s60, s60, 0x7fff
    s_add_u32 s57, s59, s60
    buffer_load_dwordx4 v[104:107], v21, s[12:15], s57 offen offset:0 sc1
    buffer_load_dwordx4 v[108:111], v21, s[12:15], s57 offen offset:512 sc1
    buffer_load_dwordx4 v[112:115], v21, s[12:15], s57 offen offset:1024 sc1
    buffer_load_dwordx4 v[116:119], v11, s[12:15], s57 offen offset:1536 sc1
    s_add_u32 s60, s60, 4096
    s_and_b32 s60, s60, 0x7fff
    s_add_u32 s57, s59, s60
    buffer_load_dwordx4 v[120:123], v21, s[12:15], s57 offen offset:0 sc1
    buffer_load_dwordx4 v[124:127], v21, s[12:15], s57 offen offset:512 sc1
    buffer_load_dwordx4 v[128:131], v21, s[12:15], s57 offen offset:1024 sc1
    buffer_load_dwordx4 v[132:135], v11, s[12:15], s57 offen offset:1536 sc1
    s_add_u32 s60, s60, 4096
    s_and_b32 s60, s60, 0x7fff
    s_add_u32 s57, s59, s60
    buffer_load_dwordx4 v[136:139], v21, s[12:15], s57 offen offset:0 sc1
    buffer_load_dwordx4 v[140:143], v21, s[12:15], s57 offen offset:512 sc1
    buffer_load_dwordx4 v[144:147], v21, s[12:15], s57 offen offset:1024 sc1
    buffer_load_dwordx4 v[148:151], v11, s[12:15], s57 offen offset:1536 sc1
    s_add_u32 s60, s60, 4096
    s_and_b32 s60, s60, 0x7fff
    s_add_u32 s57, s59, s60
    buffer_load_dwordx4 v[152:155], v21, s[12:15], s57 offen offset:0 sc1
    buffer_load_dwordx4 v[156:159], v21, s[12:15], s57 offen offset:512 sc1
    buffer_load_dwordx4 v[160:163], v21, s[12:15], s57 offen offset:1024 sc1
    buffer_load_dwordx4 v[164:167], v11, s[12:15], s57 offen offset:1536 sc1
    s_add_u32 s60, s60, 4096
    s_and_b32 s60, s60, 0x7fff
    s_waitcnt vmcnt(28)
    v_mfma_f32_16x16x32_bf16 v[168:171], v[12:15], v[40:43], 0
    v_mfma_f32_16x16x32_bf16 v[172:175], v[12:15], v[44:47], 0
    v_mfma_f32_16x16x32_bf16 v[176:179], v[12:15], v[48:51], 0
    v_mfma_f32_16x16x32_bf16 v[180:183], v[12:15], v[52:55], 0
    s_waitcnt vmcnt(24)
    v_mfma_f32_16x16x32_bf16 v[168:171], v[12:15], v[56:59], v[168:171]
    v_mfma_f32_16x16x32_bf16 v[172:175], v[12:15], v[60:63], v[172:175]
    v_mfma_f32_16x16x32_bf16 v[176:179], v[12:15], v[64:67], v[176:179]
    v_mfma_f32_16x16x32_bf16 v[180:183], v[12:15], v[68:71], v[180:183]
    s_waitcnt vmcnt(20)
    v_mfma_f32_16x16x32_bf16 v[168:171], v[12:15], v[72:75], v[168:171]
    v_mfma_f32_16x16x32_bf16 v[172:175], v[12:15], v[76:79], v[172:175]
    v_mfma_f32_16x16x32_bf16 v[176:179], v[12:15], v[80:83], v[176:179]
    v_mfma_f32_16x16x32_bf16 v[180:183], v[12:15], v[84:87], v[180:183]
    s_waitcnt vmcnt(16)
    v_mfma_f32_16x16x32_bf16 v[168:171], v[12:15], v[88:91], v[168:171]
    v_mfma_f32_16x16x32_bf16 v[172:175], v[12:15], v[92:95], v[172:175]
    v_mfma_f32_16x16x32_bf16 v[176:179], v[12:15], v[96:99], v[176:179]
    v_mfma_f32_16x16x32_bf16 v[180:183], v[12:15], v[100:103], v[180:183]
    s_waitcnt vmcnt(12)
    v_mfma_f32_16x16x32_bf16 v[168:171], v[12:15], v[104:107], v[168:171]
    v_mfma_f32_16x16x32_bf16 v[172:175], v[12:15], v[108:111], v[172:175]
    v_mfma_f32_16x16x32_bf16 v[176:179], v[12:15], v[112:115], v[176:179]
    v_mfma_f32_16x16x32_bf16 v[180:183], v[12:15], v[116:119], v[180:183]
    s_waitcnt vmcnt(8)
    v_mfma_f32_16x16x32_bf16 v[168:171], v[12:15], v[120:123], v[168:171]
    v_mfma_f32_16x16x32_bf16 v[172:175], v[12:15], v[124:127], v[172:175]
    v_mfma_f32_16x16x32_bf16 v[176:179], v[12:15], v[128:131], v[176:179]
    v_mfma_f32_16x16x32_bf16 v[180:183], v[12:15], v[132:135], v[180:183]
    s_waitcnt vmcnt(4)
    v_mfma_f32_16x16x32_bf16 v[168:171], v[12:15], v[136:139], v[168:171]
    v_mfma_f32_16x16x32_bf16 v[172:175], v[12:15], v[140:143], v[172:175]
    v_mfma_f32_16x16x32_bf16 v[176:179], v[12:15], v[144:147], v[176:179]
    v_mfma_f32_16x16x32_bf16 v[180:183], v[12:15], v[148:151], v[180:183]
    s_waitcnt vmcnt(0)
    v_mfma_f32_16x16x32_bf16 v[168:171], v[12:15], v[152:155], v[168:171]
    v_mfma_f32_16x16x32_bf16 v[172:175], v[12:15], v[156:159], v[172:175]
    v_mfma_f32_16x16x32_bf16 v[176:179], v[12:15], v[160:163], v[176:179]
    v_mfma_f32_16x16x32_bf16 v[180:183], v[12:15], v[164:167], v[180:183]
    s_nop 4
    v_cvt_pk_bf16_f32 v184, v168, v169
    v_cvt_pk_bf16_f32 v185, v170, v171
    ds_write_b64 v16, v[184:185] offset:0
    v_cvt_pk_bf16_f32 v186, v172, v173
    v_cvt_pk_bf16_f32 v187, v174, v175
    ds_write_b64 v16, v[186:187] offset:512
    v_cvt_pk_bf16_f32 v188, v176, v177
    v_cvt_pk_bf16_f32 v189, v178, v179
    ds_write_b64 v16, v[188:189] offset:1024
    v_cvt_pk_bf16_f32 v190, v180, v181
    v_cvt_pk_bf16_f32 v191, v182, v183
    ds_write_b64 v16, v[190:191] offset:1536
    s_waitcnt lgkmcnt(0)
    s_barrier
    ds_read_b128 v[40:43], v18 offset:0
    ds_read_b128 v[44:47], v19 offset:0
    ds_read_b128 v[48:51], v18 offset:384
    ds_read_b128 v[52:55], v19 offset:384
    ds_read_b128 v[56:59], v18 offset:768
    ds_read_b128 v[60:63], v19 offset:768
    ds_read_b128 v[64:67], v18 offset:1152
    ds_read_b128 v[68:71], v19 offset:1152
    ds_read_b128 v[72:75], v18 offset:1536
    ds_read_b128 v[76:79], v19 offset:1536
    ds_read_b128 v[80:83], v17 offset:0
    ds_read_b128 v[84:87], v20 offset:0
    ds_read_b128 v[88:91], v17 offset:384
    ds_read_b128 v[92:95], v20 offset:384
    s_waitcnt lgkmcnt(13)
    ds_read_b128 v[96:99], v17 offset:768
    v_mfma_f32_32x32x16_bf16 v[136:151], v[40:43], v[208:211], 0
    s_waitcnt lgkmcnt(13)
    ds_read_b128 v[100:103], v20 offset:768
    v_mfma_f32_32x32x16_bf16 v[136:151], v[44:47], v[228:231], v[136:151]
    s_waitcnt lgkmcnt(13)
    ds_read_b128 v[104:107], v17 offset:1152
    v_mfma_f32_32x32x16_bf16 v[136:151], v[48:51], v[212:215], v[136:151]
    s_waitcnt lgkmcnt(13)
    ds_read_b128 v[108:111], v20 offset:1152
    v_mfma_f32_32x32x16_bf16 v[136:151], v[52:55], v[232:235], v[136:151]
    s_waitcnt lgkmcnt(13)
    ds_read_b128 v[112:115], v17 offset:1536
    v_mfma_f32_32x32x16_bf16 v[136:151], v[56:59], v[216:219], v[136:151]
    s_waitcnt lgkmcnt(13)
    ds_read_b128 v[116:119], v20 offset:1536
    v_mfma_f32_32x32x16_bf16 v[136:151], v[60:63], v[236:239], v[136:151]
    s_waitcnt lgkmcnt(13)
    v_mfma_f32_32x32x16_bf16 v[136:151], v[64:67], v[220:223], v[136:151]
    s_waitcnt lgkmcnt(12)
    v_mfma_f32_32x32x16_bf16 v[136:151], v[68:71], v[240:243], v[136:151]
    s_waitcnt lgkmcnt(11)
    v_mfma_f32_32x32x16_bf16 v[136:151], v[72:75], v[224:227], v[136:151]
    s_waitcnt lgkmcnt(10)
    v_mfma_f32_32x32x16_bf16 v[136:151], v[76:79], v[244:247], v[136:151]
    s_waitcnt lgkmcnt(9)
    v_mfma_f32_32x32x16_bf16 v[120:135], v[80:83], v[208:211], 0
    s_waitcnt lgkmcnt(8)
    v_mfma_f32_32x32x16_bf16 v[152:167], v[84:87], v[228:231], 0
    s_waitcnt lgkmcnt(7)
    v_mfma_f32_32x32x16_bf16 v[120:135], v[88:91], v[212:215], v[120:135]
    s_waitcnt lgkmcnt(6)
    v_mfma_f32_32x32x16_bf16 v[152:167], v[92:95], v[232:235], v[152:167]
    s_nop 3
    v_add_f32 v2, 0x358637bd, v140
    v_add_f32 v4, 0x358637bd, v148
    s_waitcnt lgkmcnt(5)
    v_mfma_f32_32x32x16_bf16 v[120:135], v[96:99], v[216:219], v[120:135]
    v_rcp_f32 v2, v2
    v_rcp_f32 v4, v4
    s_waitcnt lgkmcnt(4)
    v_mfma_f32_32x32x16_bf16 v[152:167], v[100:103], v[236:239], v[152:167]
    v_mul_f32 v136, v136, v2
    v_mul_f32 v137, v137, v2
    s_waitcnt lgkmcnt(3)
    v_mfma_f32_32x32x16_bf16 v[120:135], v[104:107], v[220:223], v[120:135]
    v_mul_f32 v138, v138, v2
    v_mul_f32 v139, v139, v2
    s_waitcnt lgkmcnt(2)
    v_mfma_f32_32x32x16_bf16 v[152:167], v[108:111], v[240:243], v[152:167]
    v_mul_f32 v144, v144, v4
    v_mul_f32 v145, v145, v4
    s_waitcnt lgkmcnt(1)
    v_mfma_f32_32x32x16_bf16 v[120:135], v[112:115], v[224:227], v[120:135]
    v_mul_f32 v146, v146, v4
    v_mul_f32 v147, v147, v4
    s_waitcnt lgkmcnt(0)
    v_mfma_f32_32x32x16_bf16 v[152:167], v[116:119], v[244:247], v[152:167]
    v_cvt_pk_bf16_f32 v32, v136, v137
    v_cvt_pk_bf16_f32 v33, v138, v139
    v_cvt_pk_bf16_f32 v34, v144, v145
    v_cvt_pk_bf16_f32 v35, v146, v147
    buffer_store_dwordx4 v[32:35], v22, s[12:15], s100 offen offset:512 sc1
    s_nop 2
    v_pk_mul_f32 v[120:121], v[120:121], v[2:3] op_sel_hi:[1,0]
    v_pk_mul_f32 v[122:123], v[122:123], v[2:3] op_sel_hi:[1,0]
    v_pk_mul_f32 v[124:125], v[124:125], v[2:3] op_sel_hi:[1,0]
    v_pk_mul_f32 v[126:127], v[126:127], v[2:3] op_sel_hi:[1,0]
    v_cvt_pk_bf16_f32 v184, v120, v121
    v_cvt_pk_bf16_f32 v185, v122, v123
    v_cvt_pk_bf16_f32 v186, v124, v125
    v_cvt_pk_bf16_f32 v187, v126, v127
    buffer_store_dwordx4 v[184:187], v22, s[12:15], s100 offen offset:0 sc1
    v_pk_mul_f32 v[128:129], v[128:129], v[2:3] op_sel_hi:[1,0]
    v_pk_mul_f32 v[130:131], v[130:131], v[2:3] op_sel_hi:[1,0]
    v_pk_mul_f32 v[132:133], v[132:133], v[2:3] op_sel_hi:[1,0]
    v_pk_mul_f32 v[134:135], v[134:135], v[2:3] op_sel_hi:[1,0]
    v_cvt_pk_bf16_f32 v188, v128, v129
    v_cvt_pk_bf16_f32 v189, v130, v131
    v_cvt_pk_bf16_f32 v190, v132, v133
    v_cvt_pk_bf16_f32 v191, v134, v135
    buffer_store_dwordx4 v[188:191], v22, s[12:15], s100 offen offset:256 sc1
    v_pk_mul_f32 v[152:153], v[152:153], v[4:5] op_sel_hi:[1,0]
    v_pk_mul_f32 v[154:155], v[154:155], v[4:5] op_sel_hi:[1,0]
    v_pk_mul_f32 v[156:157], v[156:157], v[4:5] op_sel_hi:[1,0]
    v_pk_mul_f32 v[158:159], v[158:159], v[4:5] op_sel_hi:[1,0]
    v_cvt_pk_bf16_f32 v192, v152, v153
    v_cvt_pk_bf16_f32 v193, v154, v155
    v_cvt_pk_bf16_f32 v194, v156, v157
    v_cvt_pk_bf16_f32 v195, v158, v159
    buffer_store_dwordx4 v[192:195], v22, s[12:15], s100 offen offset:768 sc1
    v_pk_mul_f32 v[160:161], v[160:161], v[4:5] op_sel_hi:[1,0]
    v_pk_mul_f32 v[162:163], v[162:163], v[4:5] op_sel_hi:[1,0]
    v_pk_mul_f32 v[164:165], v[164:165], v[4:5] op_sel_hi:[1,0]
    v_pk_mul_f32 v[166:167], v[166:167], v[4:5] op_sel_hi:[1,0]
    v_cvt_pk_bf16_f32 v196, v160, v161
    v_cvt_pk_bf16_f32 v197, v162, v163
    v_cvt_pk_bf16_f32 v198, v164, v165
    v_cvt_pk_bf16_f32 v199, v166, v167
    buffer_store_dwordx4 v[196:199], v22, s[12:15], s100 offen offset:1024 sc1
    s_waitcnt vmcnt(0)
    s_barrier
    s_cmp_eq_u32 s42, 0
    s_cbranch_scc0 sig_33
    s_add_u32 s57, s45, 16
    s_lshl_b32 s57, s57, 8
    v_mov_b32 v2, s57
    v_mov_b32 v3, 1
    s_mov_b64 exec, 1
    buffer_atomic_add v3, v2, s[12:15], 0 offen sc1
    s_mov_b64 exec, -1
sig_33:
L_p2:
    s_lshr_b32 s58, s44, 3
    s_lshr_b32 s40, s43, 1
    s_lshl_b32 s40, s40, 2
    s_add_u32 s40, s40, s58
    s_lshl_b32 s98, s48, 3
    s_lshl_b32 s58, s42, 1
    s_add_u32 s98, s98, s58
    s_add_u32 s98, s98, s49
    v_and_b32 v2, 15, v1
    v_lshrrev_b32 v3, 4, v1
    v_mul_u32_u24 v4, 1280, v2
    v_lshl_add_u32 v11, v3, 4, v4
    v_lshl_add_u32 v12, v3, 3, v4
    s_mul_i32 s99, s98, 20480
    s_mul_i32 s58, s50, 160
    s_add_u32 s54, s99, 7995392
    s_add_u32 s55, s99, 10616832
    s_add_u32 s99, s99, s58
    s_waitcnt vmcnt(40)
    buffer_load_dwordx4 v[20:23], v11, s[4:7], s99 offen
    buffer_load_dwordx4 v[24:27], v11, s[4:7], s99 offen offset:64
    buffer_load_dwordx2 v[28:29], v12, s[4:7], s99 offen offset:128
    v_lshrrev_b32 v8, 5, v1
    v_lshlrev_b32 v8, 8, v8
    v_lshl_add_u32 v8, v2, 4, v8
    v_mov_b32 v9, 2147483648
    v_and_b32 v14, 16, v1
    v_cmp_eq_u32 vcc, 0, v14
    s_nop 1
    v_cndmask_b32 v8, v9, v8, vcc
    v_lshlrev_b32 v16, 3, v1
    v_cmp_gt_u32 vcc, 16, v1
    s_nop 1
    v_cndmask_b32 v16, v9, v16, vcc
    s_lshr_b32 s57, s50, 1
    s_mul_i32 s57, s57, 5120
    s_add_u32 s55, s55, s57
    s_and_b32 s59, s50, 1
    s_lshl_b32 s56, s59, 11
    s_add_u32 s56, s56, s55
    s_lshl_b32 s59, s59, 9
    s_add_u32 s55, s55, s59
    s_add_u32 s55, s55, 4096
    s_lshl_b32 s53, s98, 10
    s_lshl_b32 s58, s50, 7
    s_add_u32 s53, s53, s58
    s_add_u32 s53, s53, 13238272
    v_add_u32 v13, 0x10000, v10
    v_lshlrev_b32 v32, 8, v1
    v_add_u32 v32, 12288, v32
    s_add_u32 s57, s48, 16
    s_lshl_b32 s57, s57, 8
    v_mov_b32 v33, s57
    v_cmp_eq_u32 vcc, 8, v1
    s_nop 1
    v_cndmask_b32 v32, v32, v33, vcc
    v_cndmask_b32 v34, 16, 8, vcc
    v_mov_b32 v4, s63
    v_mov_b32 v5, s63
    v_mov_b32 v6, s63
    v_mov_b32 v7, s63
    s_waitcnt vmcnt(3)
    s_nop 0
    v_mfma_f32_16x16x32_bf16 a[240:243], a[0:3], v[4:7], 0
    v_mfma_f32_16x16x32_bf16 a[244:247], a[4:7], v[4:7], 0
    v_mfma_f32_16x16x32_bf16 a[248:251], a[8:11], v[4:7], 0
    v_mfma_f32_16x16x32_bf16 a[240:243], a[12:15], v[4:7], a[240:243]
    v_mfma_f32_16x16x32_bf16 a[244:247], a[16:19], v[4:7], a[244:247]
    v_mfma_f32_16x16x32_bf16 a[248:251], a[20:23], v[4:7], a[248:251]
    v_mfma_f32_16x16x32_bf16 a[240:243], a[24:27], v[4:7], a[240:243]
    v_mfma_f32_16x16x32_bf16 a[244:247], a[28:31], v[4:7], a[244:247]
    v_mfma_f32_16x16x32_bf16 a[248:251], a[32:35], v[4:7], a[248:251]
    v_mfma_f32_16x16x32_bf16 a[240:243], a[36:39], v[4:7], a[240:243]
    v_mfma_f32_16x16x32_bf16 a[244:247], a[40:43], v[4:7], a[244:247]
    v_mfma_f32_16x16x32_bf16 a[248:251], a[44:47], v[4:7], a[248:251]
    v_mfma_f32_16x16x32_bf16 a[240:243], a[48:51], v[4:7], a[240:243]
    v_mfma_f32_16x16x32_bf16 a[244:247], a[52:55], v[4:7], a[244:247]
    v_mfma_f32_16x16x32_bf16 a[248:251], a[56:59], v[4:7], a[248:251]
    v_mfma_f32_16x16x32_bf16 a[240:243], a[60:63], v[4:7], a[240:243]
    v_mfma_f32_16x16x32_bf16 a[244:247], a[64:67], v[4:7], a[244:247]
    v_mfma_f32_16x16x32_bf16 a[248:251], a[68:71], v[4:7], a[248:251]
    v_mfma_f32_16x16x32_bf16 a[240:243], a[72:75], v[4:7], a[240:243]
    v_mfma_f32_16x16x32_bf16 a[244:247], a[76:79], v[4:7], a[244:247]
    v_mfma_f32_16x16x32_bf16 a[248:251], a[80:83], v[4:7], a[248:251]
    v_mfma_f32_16x16x32_bf16 a[240:243], a[84:87], v[4:7], a[240:243]
    v_mfma_f32_16x16x32_bf16 a[244:247], a[88:91], v[4:7], a[244:247]
    v_mfma_f32_16x16x32_bf16 a[248:251], a[92:95], v[4:7], a[248:251]
    v_mfma_f32_16x16x32_bf16 a[240:243], a[96:99], v[4:7], a[240:243]
    v_mfma_f32_16x16x32_bf16 a[244:247], a[100:103], v[4:7], a[244:247]
    v_mfma_f32_16x16x32_bf16 a[248:251], a[104:107], v[4:7], a[248:251]
    v_mfma_f32_16x16x32_bf16 a[240:243], a[108:111], v[4:7], a[240:243]
    v_mfma_f32_16x16x32_bf16 a[244:247], a[112:115], v[4:7], a[244:247]
    v_mfma_f32_16x16x32_bf16 a[248:251], a[116:119], v[4:7], a[248:251]
    v_mfma_f32_16x16x32_bf16 a[240:243], a[120:123], v[4:7], a[240:243]
    v_mfma_f32_16x16x32_bf16 a[244:247], a[124:127], v[4:7], a[244:247]
    v_mfma_f32_16x16x32_bf16 a[248:251], a[128:131], v[4:7], a[248:251]
    v_mfma_f32_16x16x32_bf16 a[240:243], a[132:135], v[4:7], a[240:243]
    v_mfma_f32_16x16x32_bf16 a[244:247], a[136:139], v[4:7], a[244:247]
    v_mfma_f32_16x16x32_bf16 a[248:251], a[140:143], v[4:7], a[248:251]
    v_mfma_f32_16x16x32_bf16 a[240:243], a[144:147], v[4:7], a[240:243]
    v_mfma_f32_16x16x32_bf16 a[244:247], a[148:151], v[4:7], a[244:247]
    v_mfma_f32_16x16x32_bf16 a[248:251], a[152:155], v[4:7], a[248:251]
    v_mfma_f32_16x16x32_bf16 a[240:243], a[156:159], v[4:7], a[240:243]
    v_mfma_f32_16x16x32_bf16 a[244:247], a[160:163], v[4:7], a[244:247]
    v_mfma_f32_16x16x32_bf16 a[248:251], a[164:167], v[4:7], a[248:251]
    v_mfma_f32_16x16x32_bf16 a[240:243], a[168:171], v[4:7], a[240:243]
    v_mfma_f32_16x16x32_bf16 a[244:247], a[172:175], v[4:7], a[244:247]
    v_mfma_f32_16x16x32_bf16 a[248:251], a[176:179], v[4:7], a[248:251]
    v_mfma_f32_16x16x32_bf16 a[240:243], a[180:183], v[4:7], a[240:243]
    v_mfma_f32_16x16x32_bf16 a[244:247], a[184:187], v[4:7], a[244:247]
    v_mfma_f32_16x16x32_bf16 a[248:251], a[188:191], v[4:7], a[248:251]
    s_cmp_eq_u32 s42, 0
    s_cbranch_scc0 pw_34
    s_mov_b64 exec, 0x1ff
    s_mov_b32 s62, 0
pp_35:
    buffer_load_dword v33, v32, s[12:15], 0 offen sc1
    s_waitcnt vmcnt(0)
    v_cmp_gt_u32 vcc, v34, v33
    s_add_u32 s62, s62, 1
    s_cmp_ge_u32 s62, 0x40000
    s_cbranch_scc1 pd_36
    s_nop 1
    s_cbranch_vccnz pp_35
pd_36:
    s_mov_b64 exec, -1
pw_34:
    s_waitcnt vmcnt(3)
    s_barrier
    s_cmp_eq_u32 s47, 2
    s_cbranch_scc0 npd_37
    s_cmp_eq_u32 s42, 0
    s_cbranch_scc0 sig_38
    s_and_b32 s57, s52, 7
    s_add_u32 s57, s57, 48
    s_lshl_b32 s57, s57, 8
    v_mov_b32 v2, s57
    v_mov_b32 v3, 1
    s_mov_b64 exec, 1
    buffer_atomic_add v3, v2, s[12:15], 0 offen sc1
    s_mov_b64 exec, -1
sig_38:
npd_37:
    s_mov_b32 s97, s54
    buffer_load_dwordx4 v[40:43], v10, s[12:15], s97 offen offset:0 sc1
    buffer_load_dwordx4 v[44:47], v10, s[12:15], s97 offen offset:1024 sc1
    buffer_load_dwordx4 v[48:51], v10, s[12:15], s97 offen offset:2048 sc1
    buffer_load_dwordx4 v[52:55], v10, s[12:15], s97 offen offset:3072 sc1
    s_add_u32 s97, s97, 4096
    buffer_load_dwordx4 v[56:59], v10, s[12:15], s97 offen offset:0 sc1
    buffer_load_dwordx4 v[60:63], v10, s[12:15], s97 offen offset:1024 sc1
    buffer_load_dwordx4 v[64:67], v10, s[12:15], s97 offen offset:2048 sc1
    buffer_load_dwordx4 v[68:71], v10, s[12:15], s97 offen offset:3072 sc1
    s_add_u32 s97, s97, 4096
    ds_read_b128 v[120:123], v10 offset:0
    ds_read_b128 v[124:127], v10 offset:1024
    ds_read_b128 v[128:131], v10 offset:2048
    ds_read_b128 v[132:135], v10 offset:3072
    ds_read_b128 v[136:139], v10 offset:4096
    ds_read_b128 v[140:143], v10 offset:5120
    ds_read_b128 v[144:147], v10 offset:6144
    ds_read_b128 v[148:151], v10 offset:7168
    ds_read_b128 v[152:155], v10 offset:8192
    ds_read_b128 v[156:159], v10 offset:9216
    s_waitcnt vmcnt(7) lgkmcnt(5)
    v_mfma_f32_16x16x32_bf16 v[180:183], v[120:123], v[40:43], 0
    ds_read_b128 v[160:163], v10 offset:10240
    v_mfma_f32_16x16x32_bf16 v[184:187], v[124:127], v[40:43], 0
    ds_read_b128 v[164:167], v10 offset:11264
    buffer_load_dwordx4 v[72:75], v10, s[12:15], s97 offen offset:0 sc1
    v_mfma_f32_16x16x32_bf16 v[188:191], v[128:131], v[40:43], 0
    ds_read_b128 v[168:171], v10 offset:12288
    v_mfma_f32_16x16x32_bf16 v[192:195], v[132:135], v[40:43], 0
    ds_read_b128 v[172:175], v10 offset:13312
    v_mfma_f32_16x16x32_bf16 v[196:199], v[136:139], v[40:43], 0
    s_waitcnt vmcnt(7) lgkmcnt(4)
    ds_read_b128 v[176:179], v10 offset:14336
    buffer_load_dwordx4 v[76:79], v10, s[12:15], s97 offen offset:1024 sc1
    v_mfma_f32_16x16x32_bf16 v[180:183], v[140:143], v[44:47], v[180:183]
    ds_read_b128 v[120:123], v10 offset:15360
    v_mfma_f32_16x16x32_bf16 v[184:187], v[144:147], v[44:47], v[184:187]
    ds_read_b128 v[124:127], v10 offset:16384
    v_mfma_f32_16x16x32_bf16 v[188:191], v[148:151], v[44:47], v[188:191]
    ds_read_b128 v[128:131], v10 offset:17408
    buffer_load_dwordx4 v[80:83], v10, s[12:15], s97 offen offset:2048 sc1
    v_mfma_f32_16x16x32_bf16 v[192:195], v[152:155], v[44:47], v[192:195]
    ds_read_b128 v[132:135], v10 offset:18432
    v_mfma_f32_16x16x32_bf16 v[196:199], v[156:159], v[44:47], v[196:199]
    s_waitcnt vmcnt(8) lgkmcnt(4)
    ds_read_b128 v[136:139], v10 offset:19456
    v_mfma_f32_16x16x32_bf16 v[180:183], v[160:163], v[48:51], v[180:183]
    ds_read_b128 v[140:143], v10 offset:20480
    buffer_load_dwordx4 v[84:87], v10, s[12:15], s97 offen offset:3072 sc1
    s_add_u32 s97, s97, 4096
    v_mfma_f32_16x16x32_bf16 v[184:187], v[164:167], v[48:51], v[184:187]
    ds_read_b128 v[144:147], v10 offset:21504
    v_mfma_f32_16x16x32_bf16 v[188:191], v[168:171], v[48:51], v[188:191]
    ds_read_b128 v[148:151], v10 offset:22528
    v_mfma_f32_16x16x32_bf16 v[192:195], v[172:175], v[48:51], v[192:195]
    ds_read_b128 v[152:155], v10 offset:23552
    buffer_load_dwordx4 v[88:91], v10, s[12:15], s97 offen offset:0 sc1
    v_mfma_f32_16x16x32_bf16 v[196:199], v[176:179], v[48:51], v[196:199]
    s_waitcnt vmcnt(9) lgkmcnt(4)
    ds_read_b128 v[156:159], v10 offset:24576
    v_mfma_f32_16x16x32_bf16 v[180:183], v[120:123], v[52:55], v[180:183]
    ds_read_b128 v[160:163], v10 offset:25600
    v_mfma_f32_16x16x32_bf16 v[184:187], v[124:127], v[52:55], v[184:187]
    ds_read_b128 v[164:167], v10 offset:26624
    buffer_load_dwordx4 v[92:95], v10, s[12:15], s97 offen offset:1024 sc1
    v_mfma_f32_16x16x32_bf16 v[188:191], v[128:131], v[52:55], v[188:191]
    ds_read_b128 v[168:171], v10 offset:27648
    v_mfma_f32_16x16x32_bf16 v[192:195], v[132:135], v[52:55], v[192:195]
    ds_read_b128 v[172:175], v10 offset:28672
    v_mfma_f32_16x16x32_bf16 v[196:199], v[136:139], v[52:55], v[196:199]
    s_waitcnt vmcnt(9) lgkmcnt(4)
    ds_read_b128 v[176:179], v10 offset:29696
    buffer_load_dwordx4 v[96:99], v10, s[12:15], s97 offen offset:2048 sc1
    v_mfma_f32_16x16x32_bf16 v[180:183], v[140:143], v[56:59], v[180:183]
    ds_read_b128 v[120:123], v10 offset:30720
    v_mfma_f32_16x16x32_bf16 v[184:187], v[144:147], v[56:59], v[184:187]
    ds_read_b128 v[124:127], v10 offset:31744
    v_mfma_f32_16x16x32_bf16 v[188:191], v[148:151], v[56:59], v[188:191]
    ds_read_b128 v[128:131], v10 offset:32768
    buffer_load_dwordx4 v[100:103], v10, s[12:15], s97 offen offset:3072 sc1
    s_add_u32 s97, s97, 4096
    v_mfma_f32_16x16x32_bf16 v[192:195], v[152:155], v[56:59], v[192:195]
    ds_read_b128 v[132:135], v10 offset:33792
    v_mfma_f32_16x16x32_bf16 v[196:199], v[156:159], v[56:59], v[196:199]
    s_waitcnt vmcnt(10) lgkmcnt(4)
    ds_read_b128 v[136:139], v10 offset:34816
    v_mfma_f32_16x16x32_bf16 v[180:183], v[160:163], v[60:63], v[180:183]
    ds_read_b128 v[140:143], v10 offset:35840
    buffer_load_dwordx4 v[104:107], v10, s[12:15], s97 offen offset:0 sc1
    v_mfma_f32_16x16x32_bf16 v[184:187], v[164:167], v[60:63], v[184:187]
    ds_read_b128 v[144:147], v10 offset:36864
    v_mfma_f32_16x16x32_bf16 v[188:191], v[168:171], v[60:63], v[188:191]
    ds_read_b128 v[148:151], v10 offset:37888
    v_mfma_f32_16x16x32_bf16 v[192:195], v[172:175], v[60:63], v[192:195]
    ds_read_b128 v[152:155], v10 offset:38912
    buffer_load_dwordx4 v[108:111], v10, s[12:15], s97 offen offset:1024 sc1
    v_mfma_f32_16x16x32_bf16 v[196:199], v[176:179], v[60:63], v[196:199]
    s_waitcnt vmcnt(11) lgkmcnt(4)
    ds_read_b128 v[156:159], v10 offset:39936
    v_mfma_f32_16x16x32_bf16 v[180:183], v[120:123], v[64:67], v[180:183]
    ds_read_b128 v[160:163], v10 offset:40960
    v_mfma_f32_16x16x32_bf16 v[184:187], v[124:127], v[64:67], v[184:187]
    ds_read_b128 v[164:167], v10 offset:41984
    buffer_load_dwordx4 v[112:115], v10, s[12:15], s97 offen offset:2048 sc1
    v_mfma_f32_16x16x32_bf16 v[188:191], v[128:131], v[64:67], v[188:191]
    ds_read_b128 v[168:171], v10 offset:43008
    v_mfma_f32_16x16x32_bf16 v[192:195], v[132:135], v[64:67], v[192:195]
    ds_read_b128 v[172:175], v10 offset:44032
    v_mfma_f32_16x16x32_bf16 v[196:199], v[136:139], v[64:67], v[196:199]
    s_waitcnt vmcnt(11) lgkmcnt(4)
    ds_read_b128 v[176:179], v10 offset:45056
    buffer_load_dwordx4 v[116:119], v10, s[12:15], s97 offen offset:3072 sc1
    s_add_u32 s97, s97, 4096
    v_mfma_f32_16x16x32_bf16 v[180:183], v[140:143], v[68:71], v[180:183]
    ds_read_b128 v[120:123], v10 offset:46080
    v_mfma_f32_16x16x32_bf16 v[184:187], v[144:147], v[68:71], v[184:187]
    ds_read_b128 v[124:127], v10 offset:47104
    v_mfma_f32_16x16x32_bf16 v[188:191], v[148:151], v[68:71], v[188:191]
    ds_read_b128 v[128:131], v10 offset:48128
    s_lshl_b32 s101, s51, 2
    s_add_u32 s101, s101, s42
    s_mul_i32 s101, s101, 61440
    s_add_u32 s101, s101, 1097728
    buffer_load_dwordx4 a[192:195], v10, s[12:15], s101 offen offset:0 sc1
    v_mfma_f32_16x16x32_bf16 v[192:195], v[152:155], v[68:71], v[192:195]
    ds_read_b128 v[132:135], v10 offset:49152
    v_mfma_f32_16x16x32_bf16 v[196:199], v[156:159], v[68:71], v[196:199]
    s_waitcnt vmcnt(12) lgkmcnt(4)
    ds_read_b128 v[136:139], v10 offset:50176
    v_mfma_f32_16x16x32_bf16 v[180:183], v[160:163], v[72:75], v[180:183]
    ds_read_b128 v[140:143], v10 offset:51200
    buffer_load_dwordx4 a[196:199], v10, s[12:15], s101 offen offset:1024 sc1
    v_mfma_f32_16x16x32_bf16 v[184:187], v[164:167], v[72:75], v[184:187]
    ds_read_b128 v[144:147], v10 offset:52224
    v_mfma_f32_16x16x32_bf16 v[188:191], v[168:171], v[72:75], v[188:191]
    ds_read_b128 v[148:151], v10 offset:53248
    v_mfma_f32_16x16x32_bf16 v[192:195], v[172:175], v[72:75], v[192:195]
    ds_read_b128 v[152:155], v10 offset:54272
    buffer_load_dwordx4 a[200:203], v10, s[12:15], s101 offen offset:2048 sc1
    v_mfma_f32_16x16x32_bf16 v[196:199], v[176:179], v[72:75], v[196:199]
    s_waitcnt vmcnt(13) lgkmcnt(4)
    ds_read_b128 v[156:159], v10 offset:55296
    v_mfma_f32_16x16x32_bf16 v[180:183], v[120:123], v[76:79], v[180:183]
    ds_read_b128 v[160:163], v10 offset:56320
    v_mfma_f32_16x16x32_bf16 v[184:187], v[124:127], v[76:79], v[184:187]
    ds_read_b128 v[164:167], v10 offset:57344
    buffer_load_dwordx4 a[204:207], v10, s[12:15], s101 offen offset:3072 sc1
    v_mfma_f32_16x16x32_bf16 v[188:191], v[128:131], v[76:79], v[188:191]
    ds_read_b128 v[168:171], v10 offset:58368
    v_mfma_f32_16x16x32_bf16 v[192:195], v[132:135], v[76:79], v[192:195]
    ds_read_b128 v[172:175], v10 offset:59392
    v_mfma_f32_16x16x32_bf16 v[196:199], v[136:139], v[76:79], v[196:199]
    s_waitcnt vmcnt(13) lgkmcnt(4)
    ds_read_b128 v[176:179], v10 offset:60416
    s_add_u32 s101, s101, 4096
    buffer_load_dwordx4 a[208:211], v10, s[12:15], s101 offen offset:0 sc1
    v_mfma_f32_16x16x32_bf16 v[180:183], v[140:143], v[80:83], v[180:183]
    ds_read_b128 v[120:123], v10 offset:61440
    v_mfma_f32_16x16x32_bf16 v[184:187], v[144:147], v[80:83], v[184:187]
    ds_read_b128 v[124:127], v10 offset:62464
    v_mfma_f32_16x16x32_bf16 v[188:191], v[148:151], v[80:83], v[188:191]
    ds_read_b128 v[128:131], v10 offset:63488
    buffer_load_dwordx4 a[212:215], v10, s[12:15], s101 offen offset:1024 sc1
    v_mfma_f32_16x16x32_bf16 v[192:195], v[152:155], v[80:83], v[192:195]
    ds_read_b128 v[132:135], v10 offset:64512
    v_mfma_f32_16x16x32_bf16 v[196:199], v[156:159], v[80:83], v[196:199]
    s_waitcnt vmcnt(14) lgkmcnt(4)
    ds_read_b128 v[136:139], v13 offset:0
    v_mfma_f32_16x16x32_bf16 v[180:183], v[160:163], v[84:87], v[180:183]
    ds_read_b128 v[140:143], v13 offset:1024
    buffer_load_dwordx4 a[216:219], v10, s[12:15], s101 offen offset:2048 sc1
    v_mfma_f32_16x16x32_bf16 v[184:187], v[164:167], v[84:87], v[184:187]
    ds_read_b128 v[144:147], v13 offset:2048
    v_mfma_f32_16x16x32_bf16 v[188:191], v[168:171], v[84:87], v[188:191]
    ds_read_b128 v[148:151], v13 offset:3072
    v_mfma_f32_16x16x32_bf16 v[192:195], v[172:175], v[84:87], v[192:195]
    ds_read_b128 v[152:155], v13 offset:4096
    buffer_load_dwordx4 a[220:223], v10, s[12:15], s101 offen offset:3072 sc1
    v_mfma_f32_16x16x32_bf16 v[196:199], v[176:179], v[84:87], v[196:199]
    s_waitcnt vmcnt(15) lgkmcnt(4)
    ds_read_b128 v[156:159], v13 offset:5120
    v_mfma_f32_16x16x32_bf16 v[180:183], v[120:123], v[88:91], v[180:183]
    ds_read_b128 v[160:163], v13 offset:6144
    v_mfma_f32_16x16x32_bf16 v[184:187], v[124:127], v[88:91], v[184:187]
    ds_read_b128 v[164:167], v13 offset:7168
    s_add_u32 s101, s101, 4096
    buffer_load_dwordx4 a[224:227], v10, s[12:15], s101 offen offset:0 sc1
    v_mfma_f32_16x16x32_bf16 v[188:191], v[128:131], v[88:91], v[188:191]
    ds_read_b128 v[168:171], v13 offset:8192
    v_mfma_f32_16x16x32_bf16 v[192:195], v[132:135], v[88:91], v[192:195]
    ds_read_b128 v[172:175], v13 offset:9216
    v_mfma_f32_16x16x32_bf16 v[196:199], v[136:139], v[88:91], v[196:199]
    s_waitcnt vmcnt(15) lgkmcnt(4)
    ds_read_b128 v[176:179], v13 offset:10240
    buffer_load_dwordx4 a[228:231], v10, s[12:15], s101 offen offset:1024 sc1
    v_mfma_f32_16x16x32_bf16 v[180:183], v[140:143], v[92:95], v[180:183]
    ds_read_b128 v[120:123], v13 offset:11264
    v_mfma_f32_16x16x32_bf16 v[184:187], v[144:147], v[92:95], v[184:187]
    ds_read_b128 v[124:127], v13 offset:12288
    v_mfma_f32_16x16x32_bf16 v[188:191], v[148:151], v[92:95], v[188:191]
    ds_read_b128 v[128:131], v13 offset:13312
    buffer_load_dwordx4 a[232:235], v10, s[12:15], s101 offen offset:2048 sc1
    v_mfma_f32_16x16x32_bf16 v[192:195], v[152:155], v[92:95], v[192:195]
    ds_read_b128 v[132:135], v13 offset:14336
    v_mfma_f32_16x16x32_bf16 v[196:199], v[156:159], v[92:95], v[196:199]
    s_waitcnt vmcnt(16) lgkmcnt(4)
    ds_read_b128 v[136:139], v13 offset:15360
    v_mfma_f32_16x16x32_bf16 v[180:183], v[160:163], v[96:99], v[180:183]
    ds_read_b128 v[140:143], v13 offset:16384
    buffer_load_dwordx4 a[236:239], v10, s[12:15], s101 offen offset:3072 sc1
    v_mfma_f32_16x16x32_bf16 v[184:187], v[164:167], v[96:99], v[184:187]
    ds_read_b128 v[144:147], v13 offset:17408
    v_mfma_f32_16x16x32_bf16 v[188:191], v[168:171], v[96:99], v[188:191]
    ds_read_b128 v[148:151], v13 offset:18432
    v_mfma_f32_16x16x32_bf16 v[192:195], v[172:175], v[96:99], v[192:195]
    ds_read_b128 v[152:155], v13 offset:19456
    v_mfma_f32_16x16x32_bf16 v[196:199], v[176:179], v[96:99], v[196:199]
    s_waitcnt vmcnt(16) lgkmcnt(4)
    ds_read_b128 v[156:159], v13 offset:20480
    v_mfma_f32_16x16x32_bf16 v[180:183], v[120:123], v[100:103], v[180:183]
    ds_read_b128 v[160:163], v13 offset:21504
    v_mfma_f32_16x16x32_bf16 v[184:187], v[124:127], v[100:103], v[184:187]
    ds_read_b128 v[164:167], v13 offset:22528
    v_mfma_f32_16x16x32_bf16 v[188:191], v[128:131], v[100:103], v[188:191]
    ds_read_b128 v[168:171], v13 offset:23552
    v_mfma_f32_16x16x32_bf16 v[192:195], v[132:135], v[100:103], v[192:195]
    ds_read_b128 v[172:175], v13 offset:24576
    v_lshlrev_b32 v200, 16, v20
    v_mfma_f32_16x16x32_bf16 v[196:199], v[136:139], v[100:103], v[196:199]
    s_waitcnt vmcnt(15) lgkmcnt(4)
    ds_read_b128 v[176:179], v13 offset:25600
    v_and_b32 v201, 0xffff0000, v20
    v_mfma_f32_16x16x32_bf16 v[180:183], v[140:143], v[104:107], v[180:183]
    ds_read_b128 v[120:123], v13 offset:26624
    v_lshlrev_b32 v202, 16, v21
    v_mfma_f32_16x16x32_bf16 v[184:187], v[144:147], v[104:107], v[184:187]
    ds_read_b128 v[124:127], v13 offset:27648
    v_and_b32 v203, 0xffff0000, v21
    v_mfma_f32_16x16x32_bf16 v[188:191], v[148:151], v[104:107], v[188:191]
    ds_read_b128 v[128:131], v13 offset:28672
    v_lshlrev_b32 v204, 16, v22
    v_mfma_f32_16x16x32_bf16 v[192:195], v[152:155], v[104:107], v[192:195]
    ds_read_b128 v[132:135], v13 offset:29696
    v_and_b32 v205, 0xffff0000, v22
    v_mfma_f32_16x16x32_bf16 v[196:199], v[156:159], v[104:107], v[196:199]
    s_waitcnt vmcnt(14) lgkmcnt(4)
    ds_read_b128 v[136:139], v13 offset:30720
    v_lshlrev_b32 v206, 16, v23
    v_mfma_f32_16x16x32_bf16 v[180:183], v[160:163], v[108:111], v[180:183]
    ds_read_b128 v[140:143], v13 offset:31744
    v_and_b32 v207, 0xffff0000, v23
    v_mfma_f32_16x16x32_bf16 v[184:187], v[164:167], v[108:111], v[184:187]
    ds_read_b128 v[144:147], v13 offset:32768
    v_lshlrev_b32 v208, 16, v24
    v_mfma_f32_16x16x32_bf16 v[188:191], v[168:171], v[108:111], v[188:191]
    ds_read_b128 v[148:151], v13 offset:33792
    v_and_b32 v209, 0xffff0000, v24
    v_mfma_f32_16x16x32_bf16 v[192:195], v[172:175], v[108:111], v[192:195]
    ds_read_b128 v[152:155], v13 offset:34816
    v_lshlrev_b32 v210, 16, v25
    v_mfma_f32_16x16x32_bf16 v[196:199], v[176:179], v[108:111], v[196:199]
    s_waitcnt vmcnt(13) lgkmcnt(4)
    ds_read_b128 v[156:159], v13 offset:35840
    v_and_b32 v211, 0xffff0000, v25
    v_mfma_f32_16x16x32_bf16 v[180:183], v[120:123], v[112:115], v[180:183]
    v_lshlrev_b32 v212, 16, v26
    v_mfma_f32_16x16x32_bf16 v[184:187], v[124:127], v[112:115], v[184:187]
    v_and_b32 v213, 0xffff0000, v26
    v_mfma_f32_16x16x32_bf16 v[188:191], v[128:131], v[112:115], v[188:191]
    v_lshlrev_b32 v214, 16, v27
    v_mfma_f32_16x16x32_bf16 v[192:195], v[132:135], v[112:115], v[192:195]
    v_and_b32 v215, 0xffff0000, v27
    v_mfma_f32_16x16x32_bf16 v[196:199], v[136:139], v[112:115], v[196:199]
    s_waitcnt vmcnt(12) lgkmcnt(0)
    v_lshlrev_b32 v216, 16, v28
    v_mfma_f32_16x16x32_bf16 v[180:183], v[140:143], v[116:119], v[180:183]
    v_and_b32 v217, 0xffff0000, v28
    v_mfma_f32_16x16x32_bf16 v[184:187], v[144:147], v[116:119], v[184:187]
    v_lshlrev_b32 v218, 16, v29
    v_mfma_f32_16x16x32_bf16 v[188:191], v[148:151], v[116:119], v[188:191]
    v_and_b32 v219, 0xffff0000, v29
    v_mfma_f32_16x16x32_bf16 v[192:195], v[152:155], v[116:119], v[192:195]
    v_mfma_f32_16x16x32_bf16 v[196:199], v[156:159], v[116:119], v[196:199]
    s_nop 0
    v_pk_add_f32 v[200:201], v[200:201], v[180:181]
    v_pk_add_f32 v[202:203], v[202:203], v[182:183]
    v_cvt_pk_bf16_f32 v246, v200, v201
    v_pk_add_f32 v[204:205], v[204:205], v[184:185]
    v_cvt_pk_bf16_f32 v247, v202, v203
    v_pk_add_f32 v[206:207], v[206:207], v[186:187]
    v_cvt_pk_bf16_f32 v248, v204, v205
    v_pk_add_f32 v[208:209], v[208:209], v[188:189]
    v_cvt_pk_bf16_f32 v249, v206, v207
    buffer_store_dwordx4 v[246:249], v10, s[12:15], s56 offen sc1
    v_pk_add_f32 v[210:211], v[210:211], v[190:191]
    v_cvt_pk_bf16_f32 v250, v208, v209
    v_pk_add_f32 v[212:213], v[212:213], v[192:193]
    v_cvt_pk_bf16_f32 v251, v210, v211
    v_pk_add_f32 v[214:215], v[214:215], v[194:195]
    v_cvt_pk_bf16_f32 v252, v212, v213
    v_pk_add_f32 v[216:217], v[216:217], v[196:197]
    v_cvt_pk_bf16_f32 v253, v214, v215
    buffer_store_dwordx4 v[250:253], v10, s[12:15], s56 offen offset:1024 sc1
    v_pk_add_f32 v[218:219], v[218:219], v[198:199]
    v_cvt_pk_bf16_f32 v254, v216, v217
    v_cvt_pk_bf16_f32 v255, v218, v219
    v_mov_b32 v4, v254
    v_mov_b32 v5, v255
    v_mov_b32 v6, v254
    v_mov_b32 v7, v255
    v_mov_b32 v14, 0
    v_mov_b32 v15, 0
    v_permlane16_swap_b32 v4, v6
    v_permlane16_swap_b32 v5, v7
    buffer_store_dwordx4 v[4:7], v8, s[12:15], s55 offen sc1
    v_dot2c_f32_bf16 v14, s63, v246
    v_dot2c_f32_bf16 v15, v246, v246
    v_dot2c_f32_bf16 v14, s63, v247
    v_dot2c_f32_bf16 v15, v247, v247
    v_dot2c_f32_bf16 v14, s63, v248
    v_dot2c_f32_bf16 v15, v248, v248
    v_dot2c_f32_bf16 v14, s63, v249
    v_dot2c_f32_bf16 v15, v249, v249
    v_dot2c_f32_bf16 v14, s63, v250
    v_dot2c_f32_bf16 v15, v250, v250
    v_dot2c_f32_bf16 v14, s63, v251
    v_dot2c_f32_bf16 v15, v251, v251
    v_dot2c_f32_bf16 v14, s63, v252
    v_dot2c_f32_bf16 v15, v252, v252
    v_dot2c_f32_bf16 v14, s63, v253
    v_dot2c_f32_bf16 v15, v253, v253
    v_dot2c_f32_bf16 v14, s63, v254
    v_dot2c_f32_bf16 v15, v254, v254
    v_dot2c_f32_bf16 v14, s63, v255
    v_dot2c_f32_bf16 v15, v255, v255
    s_nop 1
    v_mov_b32 v18, v14
    v_mov_b32 v19, v15
    s_nop 0
    v_permlane32_swap_b32 v18, v14
    v_permlane32_swap_b32 v19, v15
    v_add_f32 v14, v14, v18
    v_add_f32 v15, v15, v19
    v_mov_b32 v18, v14
    v_mov_b32 v19, v15
    s_nop 0
    v_permlane16_swap_b32 v18, v14
    v_permlane16_swap_b32 v19, v15
    v_add_f32 v14, v14, v18
    v_add_f32 v15, v15, v19
    buffer_store_dwordx2 v[14:15], v16, s[12:15], s53 offen sc1
L_p3:
    s_waitcnt vmcnt(4)
    v_mov_b32 v184, s63
    v_mov_b32 v185, s63
    v_mov_b32 v186, s63
    v_mov_b32 v187, s63
    s_nop 1
    v_mfma_f32_16x16x32_bf16 a[240:243], a[192:195], v[184:187], a[240:243]
    v_mfma_f32_16x16x32_bf16 a[244:247], a[196:199], v[184:187], a[244:247]
    v_mfma_f32_16x16x32_bf16 a[248:251], a[200:203], v[184:187], a[248:251]
    v_mfma_f32_16x16x32_bf16 a[240:243], a[204:207], v[184:187], a[240:243]
    v_mfma_f32_16x16x32_bf16 a[244:247], a[208:211], v[184:187], a[244:247]
    v_mfma_f32_16x16x32_bf16 a[248:251], a[212:215], v[184:187], a[248:251]
    v_mfma_f32_16x16x32_bf16 a[240:243], a[216:219], v[184:187], a[240:243]
    v_mfma_f32_16x16x32_bf16 a[244:247], a[220:223], v[184:187], a[244:247]
    v_mfma_f32_16x16x32_bf16 a[248:251], a[224:227], v[184:187], a[248:251]
    v_mfma_f32_16x16x32_bf16 a[240:243], a[228:231], v[184:187], a[240:243]
    v_mfma_f32_16x16x32_bf16 a[244:247], a[232:235], v[184:187], a[244:247]
    v_mfma_f32_16x16x32_bf16 a[248:251], a[236:239], v[184:187], a[248:251]
    v_lshrrev_b32 v2, 5, v1
    v_mul_u32_u24 v2, 49152, v2
    v_and_b32 v3, 15, v1
    v_lshl_add_u32 v2, v3, 4, v2
    v_bfe_u32 v13, v1, 4, 1
    v_lshl_add_u32 v14, v13, 8, v2
    v_add_u32 v2, 512, v2
    v_mov_b32 v9, 2147483648
    v_cmp_eq_u32 vcc, 0, v13
    s_nop 1
    v_cndmask_b32 v15, v9, v2, vcc
    v_cmp_eq_u32 vcc, 0, v1
    s_nop 1
    v_cndmask_b32 v17, v9, v1, vcc
    v_mov_b32 v18, 1
    v_lshrrev_b32 v13, 4, v1
    v_lshlrev_b32 v3, 3, v3
    v_lshl_add_u32 v19, v13, 8, v3
    v_mov_b32 v16, v10
    s_lshl_b32 s57, s51, 2
    s_add_u32 s57, s57, s42
    s_mul_i32 s57, s57, 768
    s_mul_i32 s100, s40, 393216
    s_add_u32 s100, s100, s57
    s_add_u32 s100, s100, 13369344
    s_lshl_b32 s55, s40, 10
    s_add_u32 s55, s55, 16384
    s_lshl_b32 s41, s48, 10
    s_add_u32 s41, s41, 16384
    s_lshl_b32 s53, s40, 13
    s_lshl_b32 s57, s42, 11
    s_add_u32 s53, s53, s57
    s_add_u32 s53, s53, 13238272
    s_lshl_b32 s57, s42, 10
    v_add_u32 v4, 122880, v10
    v_add_u32 v7, s57, v4
    v_and_b32 v5, 15, v1
    v_lshlrev_b32 v5, 4, v5
    v_add_u32 v5, 122880, v5
    s_mul_i32 s56, s42, 10240
    s_mul_i32 s54, s40, 163840
    s_add_u32 s54, s54, 10616832
    s_lshr_b32 s59, s42, 1
    s_mul_i32 s59, s59, 20480
    s_and_b32 s60, s42, 1
    s_mul_i32 s60, s60, 5120
    s_add_u32 s59, s59, s60
    s_add_u32 s60, s59, s54
    s_add_u32 s54, s54, s56
    s_add_u32 s54, s54, 40960
    s_lshl_b32 s101, s50, 2
    s_add_u32 s101, s101, s42
    s_mul_i32 s101, s101, 61440
    s_add_u32 s101, s101, 4980736
    s_mov_b32 s96, s101
    s_add_u32 s101, s101, 12288
    s_lshl_b32 s97, s48, 3
    s_add_u32 s97, s97, s49
    s_mul_i32 s97, s97, 49152
    s_mul_i32 s58, s42, 12288
    s_add_u32 s97, s97, s58
    s_add_u32 s97, s97, 13369344
    v_lshlrev_b32 v8, 7, v1
    v_accvgpr_read_b32 v20, a240
    v_accvgpr_read_b32 v21, a241
    v_accvgpr_read_b32 v22, a242
    v_accvgpr_read_b32 v23, a243
    v_accvgpr_read_b32 v24, a244
    v_accvgpr_read_b32 v25, a245
    v_accvgpr_read_b32 v26, a246
    v_accvgpr_read_b32 v27, a247
    v_accvgpr_read_b32 v28, a248
    v_accvgpr_read_b32 v29, a249
    v_accvgpr_read_b32 v30, a250
    v_accvgpr_read_b32 v31, a251
    s_waitcnt vmcnt(0)
    s_barrier
    s_cmp_eq_u32 s42, 0
    s_cbranch_scc0 sig_40
    s_add_u32 s57, s48, 32
    s_lshl_b32 s57, s57, 8
    v_mov_b32 v2, s57
    v_mov_b32 v3, 1
    s_mov_b64 exec, 1
    buffer_atomic_add v3, v2, s[12:15], 0 offen sc1
    s_mov_b64 exec, -1
sig_40:
    s_cmp_eq_u32 s42, 0
    s_cbranch_scc0 pw_41
    s_add_u32 s57, s40, 32
    v_add_u32 v240, s57, v1
    v_lshlrev_b32 v240, 8, v240
    s_mov_b64 exec, 1
    s_mov_b32 s62, 0
pp_42:
    buffer_load_dword v241, v240, s[12:15], 0 offen sc1
    s_waitcnt vmcnt(0)
    v_cmp_gt_u32 vcc, 16, v241
    s_add_u32 s62, s62, 1
    s_cmp_ge_u32 s62, 0x40000
    s_cbranch_scc1 pd_43
    s_nop 1
    s_cbranch_vccnz pp_42
pd_43:
    s_mov_b64 exec, -1
pw_41:
    s_barrier
    buffer_load_dwordx2 v[176:177], v19, s[12:15], s53 offen offset:0 sc1
    buffer_load_dwordx2 v[178:179], v19, s[12:15], s53 offen offset:128 sc1
    buffer_load_dwordx2 v[180:181], v19, s[12:15], s53 offen offset:1024 sc1
    buffer_load_dwordx2 v[182:183], v19, s[12:15], s53 offen offset:1152 sc1
    s_add_u32 m0, s59, 0
    s_add_u32 s61, s60, 0
    buffer_load_dwordx4 v10, s[12:15], s61 offen offset:0 sc1 lds
    buffer_load_dwordx4 v10, s[12:15], s61 offen offset:1024 sc1 lds
    buffer_load_dwordx4 v10, s[12:15], s61 offen offset:2048 sc1 lds
    buffer_load_dwordx4 v10, s[12:15], s61 offen offset:3072 sc1 lds
    s_add_u32 m0, s59, 4096
    s_add_u32 s61, s60, 4096
    buffer_load_dwordx4 v10, s[12:15], s61 offen offset:0 sc1 lds
    s_add_u32 m0, s59, 10240
    s_add_u32 s61, s60, 10240
    buffer_load_dwordx4 v10, s[12:15], s61 offen offset:0 sc1 lds
    buffer_load_dwordx4 v10, s[12:15], s61 offen offset:1024 sc1 lds
    buffer_load_dwordx4 v10, s[12:15], s61 offen offset:2048 sc1 lds
    buffer_load_dwordx4 v10, s[12:15], s61 offen offset:3072 sc1 lds
    s_add_u32 m0, s59, 14336
    s_add_u32 s61, s60, 14336
    buffer_load_dwordx4 v10, s[12:15], s61 offen offset:0 sc1 lds
    s_waitcnt vmcnt(10)
    v_pk_add_f32 v[176:177], v[176:177], v[178:179]
    v_pk_add_f32 v[180:181], v[180:181], v[182:183]
    s_nop 1
    v_permlane32_swap_b32 v176, v180
    v_permlane32_swap_b32 v177, v181
    v_pk_add_f32 v[176:177], v[176:177], v[180:181]
    v_mov_b32 v178, v176
    v_mov_b32 v179, v177
    s_nop 0
    v_permlane16_swap_b32 v176, v178
    v_permlane16_swap_b32 v177, v179
    v_pk_add_f32 v[176:177], v[176:177], v[178:179]
    v_mul_f32 v184, 0xbacccccd, v176
    v_mul_f32 v177, 0x3acccccd, v177
    v_fma_f32 v177, -v184, v184, v177
    v_max_f32 v177, 0, v177
    v_add_f32 v187, 0x3727c5ac, v177
    v_rsq_f32 v176, v187
    s_nop 0
    v_mul_f32 v178, v176, v176
    v_mul_f32 v185, 3222493025, v176
    v_mul_f32 v178, v178, v176
    v_mul_f32 v186, 3184710632, v178
    ds_write_b128 v7, v[184:187]
    v_mov_b32 v18, 4
    s_waitcnt vmcnt(5) lgkmcnt(0)
    s_barrier
    ds_read_b128 v[80:83], v16 offset:0
    ds_read_b128 v[84:87], v16 offset:20480
    ds_read_b128 v[88:91], v16 offset:1024
    ds_read_b128 v[92:95], v16 offset:21504
    ds_read_b128 v[96:99], v16 offset:2048
    ds_read_b128 v[100:103], v16 offset:22528
    ds_read_b128 v[104:107], v16 offset:3072
    ds_read_b128 v[108:111], v16 offset:23552
    s_waitcnt lgkmcnt(4)
    v_mfma_f32_16x16x32_bf16 v[128:131], a[0:3], v[80:83], 0
    s_add_u32 m0, s56, 40960
    ds_read_b128 v[112:115], v16 offset:4096
    v_mfma_f32_16x16x32_bf16 v[140:143], a[0:3], v[84:87], 0
    s_nop 0
    buffer_load_dwordx4 v10, s[12:15], s54 offen offset:0 sc1 lds
    v_mfma_f32_16x16x32_bf16 v[144:147], a[4:7], v[84:87], 0
    v_mfma_f32_16x16x32_bf16 v[132:135], a[4:7], v[80:83], 0
    ds_read_b128 v[116:119], v16 offset:24576
    ds_read_b128 v[32:35], v5 offset:0
    v_mfma_f32_16x16x32_bf16 v[136:139], a[8:11], v[80:83], 0
    v_mfma_f32_16x16x32_bf16 v[148:151], a[8:11], v[84:87], 0
    v_mfma_f32_16x16x32_bf16 v[128:131], a[12:15], v[88:91], v[128:131]
    ds_read_b128 v[120:123], v16 offset:5120
    buffer_load_dwordx4 v10, s[12:15], s54 offen offset:1024 sc1 lds
    v_mfma_f32_16x16x32_bf16 v[140:143], a[12:15], v[92:95], v[140:143]
    ds_read_b128 v[36:39], v5 offset:512
    v_mfma_f32_16x16x32_bf16 v[144:147], a[16:19], v[92:95], v[144:147]
    v_mfma_f32_16x16x32_bf16 v[132:135], a[16:19], v[88:91], v[132:135]
    ds_read_b128 v[124:127], v16 offset:25600
    ds_read_b128 v[40:43], v4 offset:0
    v_mfma_f32_16x16x32_bf16 v[136:139], a[20:23], v[88:91], v[136:139]
    v_mfma_f32_16x16x32_bf16 v[148:151], a[20:23], v[92:95], v[148:151]
    s_waitcnt lgkmcnt(4)
    buffer_load_dwordx4 v10, s[12:15], s54 offen offset:2048 sc1 lds
    v_mfma_f32_16x16x32_bf16 v[128:131], a[24:27], v[96:99], v[128:131]
    ds_read_b128 v[80:83], v16 offset:6144
    ds_read_b128 v[44:47], v5 offset:1024
    v_mfma_f32_16x16x32_bf16 v[140:143], a[24:27], v[100:103], v[140:143]
    v_mfma_f32_16x16x32_bf16 v[144:147], a[28:31], v[100:103], v[144:147]
    v_mfma_f32_16x16x32_bf16 v[132:135], a[28:31], v[96:99], v[132:135]
    ds_read_b128 v[84:87], v16 offset:26624
    ds_read_b128 v[48:51], v5 offset:1536
    v_mfma_f32_16x16x32_bf16 v[136:139], a[32:35], v[96:99], v[136:139]
    buffer_load_dwordx4 v10, s[12:15], s54 offen offset:3072 sc1 lds
    v_mfma_f32_16x16x32_bf16 v[148:151], a[32:35], v[100:103], v[148:151]
    s_add_u32 m0, s56, 45056
    v_mfma_f32_16x16x32_bf16 v[128:131], a[36:39], v[104:107], v[128:131]
    s_add_u32 s54, s54, 4096
    ds_read_b128 v[88:91], v16 offset:7168
    ds_read_b128 v[52:55], v4 offset:1024
    v_mfma_f32_16x16x32_bf16 v[140:143], a[36:39], v[108:111], v[140:143]
    v_mfma_f32_16x16x32_bf16 v[144:147], a[40:43], v[108:111], v[144:147]
    v_mfma_f32_16x16x32_bf16 v[132:135], a[40:43], v[104:107], v[132:135]
    ds_read_b128 v[92:95], v16 offset:27648
    buffer_load_dwordx4 v10, s[12:15], s54 offen offset:0 sc1 lds
    v_mfma_f32_16x16x32_bf16 v[136:139], a[44:47], v[104:107], v[136:139]
    ds_read_b128 v[56:59], v5 offset:2048
    v_mfma_f32_16x16x32_bf16 v[148:151], a[44:47], v[108:111], v[148:151]
    s_waitcnt lgkmcnt(4)
    v_mfma_f32_16x16x32_bf16 v[128:131], a[48:51], v[112:115], v[128:131]
    ds_read_b128 v[96:99], v16 offset:8192
    ds_read_b128 v[60:63], v5 offset:2560
    v_mfma_f32_16x16x32_bf16 v[140:143], a[48:51], v[116:119], v[140:143]
    v_mfma_f32_16x16x32_bf16 v[144:147], a[52:55], v[116:119], v[144:147]
    buffer_load_dwordx4 v10, s[12:15], s54 offen offset:1024 sc1 lds
    v_mfma_f32_16x16x32_bf16 v[132:135], a[52:55], v[112:115], v[132:135]
    ds_read_b128 v[100:103], v16 offset:28672
    ds_read_b128 v[64:67], v4 offset:2048
    v_mfma_f32_16x16x32_bf16 v[136:139], a[56:59], v[112:115], v[136:139]
    v_mfma_f32_16x16x32_bf16 v[148:151], a[56:59], v[116:119], v[148:151]
    v_mfma_f32_16x16x32_bf16 v[128:131], a[60:63], v[120:123], v[128:131]
    ds_read_b128 v[104:107], v16 offset:9216
    ds_read_b128 v[68:71], v5 offset:3072
    v_mfma_f32_16x16x32_bf16 v[140:143], a[60:63], v[124:127], v[140:143]
    buffer_load_dwordx4 v10, s[12:15], s54 offen offset:2048 sc1 lds
    v_mfma_f32_16x16x32_bf16 v[144:147], a[64:67], v[124:127], v[144:147]
    v_mfma_f32_16x16x32_bf16 v[132:135], a[64:67], v[120:123], v[132:135]
    ds_read_b128 v[108:111], v16 offset:29696
    ds_read_b128 v[72:75], v5 offset:3584
    v_mfma_f32_16x16x32_bf16 v[136:139], a[68:71], v[120:123], v[136:139]
    v_mfma_f32_16x16x32_bf16 v[148:151], a[68:71], v[124:127], v[148:151]
    s_waitcnt vmcnt(7) lgkmcnt(4)
    s_barrier
    v_mfma_f32_16x16x32_bf16 v[128:131], a[72:75], v[80:83], v[128:131]
    ds_read_b128 v[112:115], v16 offset:10240
    buffer_load_dwordx4 v10, s[12:15], s54 offen offset:3072 sc1 lds
    v_mfma_f32_16x16x32_bf16 v[140:143], a[72:75], v[84:87], v[140:143]
    s_add_u32 m0, s56, 49152
    ds_read_b128 v[76:79], v4 offset:3072
    v_mfma_f32_16x16x32_bf16 v[144:147], a[76:79], v[84:87], v[144:147]
    s_add_u32 s54, s54, 4096
    v_mfma_f32_16x16x32_bf16 v[132:135], a[76:79], v[80:83], v[132:135]
    ds_read_b128 v[116:119], v16 offset:30720
    v_mfma_f32_16x16x32_bf16 v[136:139], a[80:83], v[80:83], v[136:139]
    v_mfma_f32_16x16x32_bf16 v[148:151], a[80:83], v[84:87], v[148:151]
    buffer_load_dwordx4 v10, s[12:15], s54 offen offset:0 sc1 lds
    v_mfma_f32_16x16x32_bf16 v[128:131], a[84:87], v[88:91], v[128:131]
    ds_read_b128 v[120:123], v16 offset:11264
    v_mfma_f32_16x16x32_bf16 v[140:143], a[84:87], v[92:95], v[140:143]
    v_mfma_f32_16x16x32_bf16 v[144:147], a[88:91], v[92:95], v[144:147]
    v_mfma_f32_16x16x32_bf16 v[132:135], a[88:91], v[88:91], v[132:135]
    ds_read_b128 v[124:127], v16 offset:31744
    v_mfma_f32_16x16x32_bf16 v[136:139], a[92:95], v[88:91], v[136:139]
    buffer_load_dwordx4 v10, s[12:15], s54 offen offset:1024 sc1 lds
    v_mfma_f32_16x16x32_bf16 v[148:151], a[92:95], v[92:95], v[148:151]
    s_waitcnt lgkmcnt(4)
    v_mfma_f32_16x16x32_bf16 v[128:131], a[96:99], v[96:99], v[128:131]
    s_add_u32 s54, s54, 32768
    ds_read_b128 v[80:83], v16 offset:12288
    v_mfma_f32_16x16x32_bf16 v[140:143], a[96:99], v[100:103], v[140:143]
    s_add_u32 m0, s56, 81920
    v_mfma_f32_16x16x32_bf16 v[144:147], a[100:103], v[100:103], v[144:147]
    s_nop 0
    v_mfma_f32_16x16x32_bf16 v[132:135], a[100:103], v[96:99], v[132:135]
    ds_read_b128 v[84:87], v16 offset:32768
    buffer_load_dwordx4 v10, s[12:15], s54 offen offset:0 sc1 lds
    v_mfma_f32_16x16x32_bf16 v[136:139], a[104:107], v[96:99], v[136:139]
    v_mfma_f32_16x16x32_bf16 v[148:151], a[104:107], v[100:103], v[148:151]
    v_mfma_f32_16x16x32_bf16 v[128:131], a[108:111], v[104:107], v[128:131]
    ds_read_b128 v[88:91], v16 offset:13312
    v_mfma_f32_16x16x32_bf16 v[140:143], a[108:111], v[108:111], v[140:143]
    v_mfma_f32_16x16x32_bf16 v[144:147], a[112:115], v[108:111], v[144:147]
    buffer_load_dwordx4 v10, s[12:15], s54 offen offset:1024 sc1 lds
    v_mfma_f32_16x16x32_bf16 v[132:135], a[112:115], v[104:107], v[132:135]
    ds_read_b128 v[92:95], v16 offset:33792
    v_mfma_f32_16x16x32_bf16 v[136:139], a[116:119], v[104:107], v[136:139]
    v_mfma_f32_16x16x32_bf16 v[148:151], a[116:119], v[108:111], v[148:151]
    s_waitcnt lgkmcnt(4)
    v_mfma_f32_16x16x32_bf16 v[128:131], a[120:123], v[112:115], v[128:131]
    ds_read_b128 v[96:99], v16 offset:14336
    v_mfma_f32_16x16x32_bf16 v[140:143], a[120:123], v[116:119], v[140:143]
    buffer_load_dwordx4 v10, s[12:15], s54 offen offset:2048 sc1 lds
    v_mfma_f32_16x16x32_bf16 v[144:147], a[124:127], v[116:119], v[144:147]
    v_mfma_f32_16x16x32_bf16 v[132:135], a[124:127], v[112:115], v[132:135]
    ds_read_b128 v[100:103], v16 offset:34816
    v_mfma_f32_16x16x32_bf16 v[136:139], a[128:131], v[112:115], v[136:139]
    v_mfma_f32_16x16x32_bf16 v[148:151], a[128:131], v[116:119], v[148:151]
    v_mfma_f32_16x16x32_bf16 v[128:131], a[132:135], v[120:123], v[128:131]
    ds_read_b128 v[104:107], v16 offset:15360
    buffer_load_dwordx4 v10, s[12:15], s54 offen offset:3072 sc1 lds
    v_mfma_f32_16x16x32_bf16 v[140:143], a[132:135], v[124:127], v[140:143]
    s_add_u32 m0, s56, 86016
    v_mfma_f32_16x16x32_bf16 v[144:147], a[136:139], v[124:127], v[144:147]
    s_add_u32 s54, s54, 4096
    v_mfma_f32_16x16x32_bf16 v[132:135], a[136:139], v[120:123], v[132:135]
    ds_read_b128 v[108:111], v16 offset:35840
    v_mfma_f32_16x16x32_bf16 v[136:139], a[140:143], v[120:123], v[136:139]
    v_mfma_f32_16x16x32_bf16 v[148:151], a[140:143], v[124:127], v[148:151]
    s_waitcnt lgkmcnt(4)
    buffer_load_dwordx4 v10, s[12:15], s54 offen offset:0 sc1 lds
    v_mfma_f32_16x16x32_bf16 v[128:131], a[144:147], v[80:83], v[128:131]
    ds_read_b128 v[112:115], v16 offset:16384
    v_mfma_f32_16x16x32_bf16 v[140:143], a[144:147], v[84:87], v[140:143]
    v_mfma_f32_16x16x32_bf16 v[144:147], a[148:151], v[84:87], v[144:147]
    v_mfma_f32_16x16x32_bf16 v[132:135], a[148:151], v[80:83], v[132:135]
    ds_read_b128 v[116:119], v16 offset:36864
    v_mfma_f32_16x16x32_bf16 v[136:139], a[152:155], v[80:83], v[136:139]
    buffer_load_dwordx4 v10, s[12:15], s54 offen offset:1024 sc1 lds
    v_mfma_f32_16x16x32_bf16 v[148:151], a[152:155], v[84:87], v[148:151]
    v_mfma_f32_16x16x32_bf16 v[128:131], a[156:159], v[88:91], v[128:131]
    ds_read_b128 v[120:123], v16 offset:17408
    v_mfma_f32_16x16x32_bf16 v[140:143], a[156:159], v[92:95], v[140:143]
    v_mfma_f32_16x16x32_bf16 v[144:147], a[160:163], v[92:95], v[144:147]
    v_mfma_f32_16x16x32_bf16 v[132:135], a[160:163], v[88:91], v[132:135]
    ds_read_b128 v[124:127], v16 offset:37888
    buffer_load_dwordx4 v10, s[12:15], s54 offen offset:2048 sc1 lds
    v_mfma_f32_16x16x32_bf16 v[136:139], a[164:167], v[88:91], v[136:139]
    v_mfma_f32_16x16x32_bf16 v[148:151], a[164:167], v[92:95], v[148:151]
    s_waitcnt lgkmcnt(4)
    v_mfma_f32_16x16x32_bf16 v[128:131], a[168:171], v[96:99], v[128:131]
    ds_read_b128 v[80:83], v16 offset:18432
    v_mfma_f32_16x16x32_bf16 v[140:143], a[168:171], v[100:103], v[140:143]
    v_mfma_f32_16x16x32_bf16 v[144:147], a[172:175], v[100:103], v[144:147]
    buffer_load_dwordx4 v10, s[12:15], s54 offen offset:3072 sc1 lds
    v_mfma_f32_16x16x32_bf16 v[132:135], a[172:175], v[96:99], v[132:135]
    s_add_u32 m0, s56, 90112
    ds_read_b128 v[84:87], v16 offset:38912
    v_mfma_f32_16x16x32_bf16 v[136:139], a[176:179], v[96:99], v[136:139]
    s_add_u32 s54, s54, 4096
    v_mfma_f32_16x16x32_bf16 v[148:151], a[176:179], v[100:103], v[148:151]
    v_mfma_f32_16x16x32_bf16 v[128:131], a[180:183], v[104:107], v[128:131]
    ds_read_b128 v[88:91], v16 offset:19456
    v_mfma_f32_16x16x32_bf16 v[140:143], a[180:183], v[108:111], v[140:143]
    buffer_load_dwordx4 v10, s[12:15], s54 offen offset:0 sc1 lds
    v_mfma_f32_16x16x32_bf16 v[144:147], a[184:187], v[108:111], v[144:147]
    v_mfma_f32_16x16x32_bf16 v[132:135], a[184:187], v[104:107], v[132:135]
    ds_read_b128 v[92:95], v16 offset:39936
    v_mfma_f32_16x16x32_bf16 v[136:139], a[188:191], v[104:107], v[136:139]
    v_mfma_f32_16x16x32_bf16 v[148:151], a[188:191], v[108:111], v[148:151]
    s_waitcnt vmcnt(9) lgkmcnt(0)
    v_add_u32 v16, 40960, v16
    s_barrier
    v_mfma_f32_16x16x32_bf16 v[128:131], a[192:195], v[112:115], v[128:131]
    ds_read_b128 v[96:99], v16 offset:0
    buffer_load_dwordx4 v10, s[12:15], s54 offen offset:1024 sc1 lds
    v_mfma_f32_16x16x32_bf16 v[140:143], a[192:195], v[116:119], v[140:143]
    s_add_u32 s54, s54, 32768
    v_mfma_f32_16x16x32_bf16 v[144:147], a[196:199], v[116:119], v[144:147]
    s_add_u32 m0, s56, 122880
    v_mfma_f32_16x16x32_bf16 v[132:135], a[196:199], v[112:115], v[132:135]
    s_nop 0
    ds_read_b128 v[100:103], v16 offset:20480
    v_mfma_f32_16x16x32_bf16 v[136:139], a[200:203], v[112:115], v[136:139]
    v_mfma_f32_16x16x32_bf16 v[148:151], a[200:203], v[116:119], v[148:151]
    buffer_load_dwordx4 v10, s[12:15], s54 offen offset:0 sc1 lds
    v_mfma_f32_16x16x32_bf16 v[128:131], a[204:207], v[120:123], v[128:131]
    ds_read_b128 v[104:107], v16 offset:1024
    v_mfma_f32_16x16x32_bf16 v[140:143], a[204:207], v[124:127], v[140:143]
    v_mfma_f32_16x16x32_bf16 v[144:147], a[208:211], v[124:127], v[144:147]
    v_mfma_f32_16x16x32_bf16 v[132:135], a[208:211], v[120:123], v[132:135]
    ds_read_b128 v[108:111], v16 offset:21504
    v_mfma_f32_16x16x32_bf16 v[136:139], a[212:215], v[120:123], v[136:139]
    buffer_load_dwordx4 v10, s[12:15], s54 offen offset:1024 sc1 lds
    v_mfma_f32_16x16x32_bf16 v[148:151], a[212:215], v[124:127], v[148:151]
    v_mfma_f32_16x16x32_bf16 v[128:131], a[216:219], v[80:83], v[128:131]
    ds_read_b128 v[112:115], v16 offset:2048
    v_mfma_f32_16x16x32_bf16 v[140:143], a[216:219], v[84:87], v[140:143]
    v_mfma_f32_16x16x32_bf16 v[144:147], a[220:223], v[84:87], v[144:147]
    v_mfma_f32_16x16x32_bf16 v[132:135], a[220:223], v[80:83], v[132:135]
    ds_read_b128 v[116:119], v16 offset:22528
    buffer_load_dwordx4 v10, s[12:15], s54 offen offset:2048 sc1 lds
    v_mfma_f32_16x16x32_bf16 v[136:139], a[224:227], v[80:83], v[136:139]
    v_mfma_f32_16x16x32_bf16 v[148:151], a[224:227], v[84:87], v[148:151]
    v_mfma_f32_16x16x32_bf16 v[128:131], a[228:231], v[88:91], v[128:131]
    ds_read_b128 v[120:123], v16 offset:3072
    v_mfma_f32_16x16x32_bf16 v[140:143], a[228:231], v[92:95], v[140:143]
    v_mfma_f32_16x16x32_bf16 v[144:147], a[232:235], v[92:95], v[144:147]
    buffer_load_dwordx4 v10, s[12:15], s54 offen offset:3072 sc1 lds
    v_mfma_f32_16x16x32_bf16 v[132:135], a[232:235], v[88:91], v[132:135]
    s_add_u32 m0, s56, 126976
    ds_read_b128 v[124:127], v16 offset:23552
    v_mfma_f32_16x16x32_bf16 v[136:139], a[236:239], v[88:91], v[136:139]
    s_add_u32 s54, s54, 4096
    v_mfma_f32_16x16x32_bf16 v[148:151], a[236:239], v[92:95], v[148:151]
    s_waitcnt lgkmcnt(4)
    v_mfma_f32_16x16x32_bf16 v[152:155], a[0:3], v[96:99], 0
    ds_read_b128 v[80:83], v16 offset:4096
    v_mfma_f32_16x16x32_bf16 v[164:167], a[0:3], v[100:103], 0
    buffer_load_dwordx4 v10, s[12:15], s54 offen offset:0 sc1 lds
    v_mfma_f32_16x16x32_bf16 v[168:171], a[4:7], v[100:103], 0
    v_mfma_f32_16x16x32_bf16 v[156:159], a[4:7], v[96:99], 0
    ds_read_b128 v[84:87], v16 offset:24576
    v_fmac_f32 v136, v28, v32
    v_fmac_f32 v137, v29, v32
    v_mfma_f32_16x16x32_bf16 v[160:163], a[8:11], v[96:99], 0
    v_fmac_f32 v138, v30, v32
    v_fmac_f32 v139, v31, v32
    v_mfma_f32_16x16x32_bf16 v[172:175], a[8:11], v[100:103], 0
    v_fmac_f32 v148, v28, v36
    v_fmac_f32 v149, v29, v36
    v_mfma_f32_16x16x32_bf16 v[152:155], a[12:15], v[104:107], v[152:155]
    ds_read_b128 v[88:91], v16 offset:5120
    buffer_load_dwordx4 v10, s[12:15], s54 offen offset:1024 sc1 lds
    v_fmac_f32 v150, v30, v36
    v_mfma_f32_16x16x32_bf16 v[164:167], a[12:15], v[108:111], v[164:167]
    v_fmac_f32 v151, v31, v36
    v_fmac_f32 v128, v20, v32
    v_mfma_f32_16x16x32_bf16 v[168:171], a[16:19], v[108:111], v[168:171]
    v_fmac_f32 v129, v21, v32
    v_fmac_f32 v130, v22, v32
    v_mfma_f32_16x16x32_bf16 v[156:159], a[16:19], v[104:107], v[156:159]
    ds_read_b128 v[92:95], v16 offset:25600
    v_fmac_f32 v131, v23, v32
    v_fmac_f32 v140, v20, v36
    v_mfma_f32_16x16x32_bf16 v[160:163], a[20:23], v[104:107], v[160:163]
    v_fmac_f32 v141, v21, v36
    v_fmac_f32 v142, v22, v36
    v_mfma_f32_16x16x32_bf16 v[172:175], a[20:23], v[108:111], v[172:175]
    s_waitcnt lgkmcnt(4)
    buffer_load_dwordx4 v10, s[12:15], s54 offen offset:2048 sc1 lds
    v_fmac_f32 v143, v23, v36
    v_mfma_f32_16x16x32_bf16 v[152:155], a[24:27], v[112:115], v[152:155]
    ds_read_b128 v[96:99], v16 offset:6144
    v_permlane32_swap_b32 v136, v148
    v_mfma_f32_16x16x32_bf16 v[164:167], a[24:27], v[116:119], v[164:167]
    v_permlane32_swap_b32 v137, v149
    v_mfma_f32_16x16x32_bf16 v[168:171], a[28:31], v[116:119], v[168:171]
    v_permlane32_swap_b32 v138, v150
    v_mfma_f32_16x16x32_bf16 v[156:159], a[28:31], v[112:115], v[156:159]
    ds_read_b128 v[100:103], v16 offset:26624
    v_permlane32_swap_b32 v139, v151
    v_mfma_f32_16x16x32_bf16 v[160:163], a[32:35], v[112:115], v[160:163]
    buffer_load_dwordx4 v10, s[12:15], s54 offen offset:3072 sc1 lds
    v_fmac_f32 v132, v24, v32
    v_mfma_f32_16x16x32_bf16 v[172:175], a[32:35], v[116:119], v[172:175]
    s_add_u32 m0, s56, 131072
    v_fmac_f32 v133, v25, v32
    v_fmac_f32 v134, v26, v32
    v_mfma_f32_16x16x32_bf16 v[152:155], a[36:39], v[120:123], v[152:155]
    s_add_u32 s54, s54, 4096
    ds_read_b128 v[104:107], v16 offset:7168
    v_fmac_f32 v135, v27, v32
    v_fmac_f32 v144, v24, v36
    v_mfma_f32_16x16x32_bf16 v[164:167], a[36:39], v[124:127], v[164:167]
    v_fmac_f32 v145, v25, v36
    v_fmac_f32 v146, v26, v36
    v_mfma_f32_16x16x32_bf16 v[168:171], a[40:43], v[124:127], v[168:171]
    v_fmac_f32 v147, v27, v36
    v_mfma_f32_16x16x32_bf16 v[156:159], a[40:43], v[120:123], v[156:159]
    ds_read_b128 v[108:111], v16 offset:27648
    buffer_load_dwordx4 v10, s[12:15], s54 offen offset:0 sc1 lds
    v_mul_f32 v176, v128, v128
    v_mfma_f32_16x16x32_bf16 v[160:163], a[44:47], v[120:123], v[160:163]
    v_fma_f32 v176, v176, v34, v33
    v_mul_f32 v177, v129, v129
    v_mfma_f32_16x16x32_bf16 v[172:175], a[44:47], v[124:127], v[172:175]
    s_waitcnt lgkmcnt(4)
    v_mul_f32 v176, v176, v128
    v_fma_f32 v177, v177, v34, v33
    v_mfma_f32_16x16x32_bf16 v[152:155], a[48:51], v[80:83], v[152:155]
    ds_read_b128 v[112:115], v16 offset:8192
    v_exp_f32 v176, v176
    v_mfma_f32_16x16x32_bf16 v[164:167], a[48:51], v[84:87], v[164:167]
    v_mul_f32 v177, v177, v129
    v_mul_f32 v128, v128, v132
    v_mfma_f32_16x16x32_bf16 v[168:171], a[52:55], v[84:87], v[168:171]
    buffer_load_dwordx4 v10, s[12:15], s54 offen offset:1024 sc1 lds
    v_fma_f32 v176, v176, v35, v35
    v_mfma_f32_16x16x32_bf16 v[156:159], a[52:55], v[80:83], v[156:159]
    s_add_u32 s54, s54, 32768
    ds_read_b128 v[116:119], v16 offset:28672
    v_rcp_f32 v176, v176
    v_mfma_f32_16x16x32_bf16 v[160:163], a[56:59], v[80:83], v[160:163]
    s_add_u32 m0, s56, 0
    v_exp_f32 v177, v177
    v_mfma_f32_16x16x32_bf16 v[172:175], a[56:59], v[84:87], v[172:175]
    s_nop 0
    v_mul_f32 v128, v128, v176
    v_mul_f32 v129, v129, v133
    v_mfma_f32_16x16x32_bf16 v[152:155], a[60:63], v[88:91], v[152:155]
    ds_read_b128 v[120:123], v16 offset:9216
    v_fma_f32 v177, v177, v35, v35
    v_mul_f32 v178, v130, v130
    v_mfma_f32_16x16x32_bf16 v[164:167], a[60:63], v[92:95], v[164:167]
    buffer_load_dwordx4 v10, s[12:15], s101 offen offset:0 sc1 lds
    v_fma_f32 v178, v178, v34, v33
    v_mfma_f32_16x16x32_bf16 v[168:171], a[64:67], v[92:95], v[168:171]
    v_rcp_f32 v177, v177
    v_mfma_f32_16x16x32_bf16 v[156:159], a[64:67], v[88:91], v[156:159]
    ds_read_b128 v[124:127], v16 offset:29696
    v_mul_f32 v178, v178, v130
    v_mul_f32 v129, v129, v177
    v_mfma_f32_16x16x32_bf16 v[160:163], a[68:71], v[88:91], v[160:163]
    v_exp_f32 v178, v178
    v_mfma_f32_16x16x32_bf16 v[172:175], a[68:71], v[92:95], v[172:175]
    s_waitcnt lgkmcnt(4)
    v_mul_f32 v130, v130, v134
    v_mul_f32 v179, v131, v131
    v_mfma_f32_16x16x32_bf16 v[152:155], a[72:75], v[96:99], v[152:155]
    ds_read_b128 v[80:83], v16 offset:10240
    buffer_load_dwordx4 v10, s[12:15], s101 offen offset:1024 sc1 lds
    v_fma_f32 v178, v178, v35, v35
    v_mfma_f32_16x16x32_bf16 v[164:167], a[72:75], v[100:103], v[164:167]
    v_rcp_f32 v178, v178
    v_mfma_f32_16x16x32_bf16 v[168:171], a[76:79], v[100:103], v[168:171]
    v_mul_f32 v130, v130, v178
    v_fma_f32 v179, v179, v34, v33
    v_mfma_f32_16x16x32_bf16 v[156:159], a[76:79], v[96:99], v[156:159]
    ds_read_b128 v[84:87], v16 offset:30720
    v_mul_f32 v179, v179, v131
    v_mul_f32 v180, v140, v140
    v_mfma_f32_16x16x32_bf16 v[160:163], a[80:83], v[96:99], v[160:163]
    v_exp_f32 v179, v179
    v_mfma_f32_16x16x32_bf16 v[172:175], a[80:83], v[100:103], v[172:175]
    buffer_load_dwordx4 v10, s[12:15], s101 offen offset:2048 sc1 lds
    v_mul_f32 v131, v131, v135
    v_mfma_f32_16x16x32_bf16 v[152:155], a[84:87], v[104:107], v[152:155]
    ds_read_b128 v[88:91], v16 offset:11264
    v_fma_f32 v179, v179, v35, v35
    v_fma_f32 v180, v180, v38, v37
    v_mfma_f32_16x16x32_bf16 v[164:167], a[84:87], v[108:111], v[164:167]
    v_rcp_f32 v179, v179
    v_mfma_f32_16x16x32_bf16 v[168:171], a[88:91], v[108:111], v[168:171]
    v_mul_f32 v180, v180, v140
    v_mul_f32 v131, v131, v179
    v_mfma_f32_16x16x32_bf16 v[156:159], a[88:91], v[104:107], v[156:159]
    ds_read_b128 v[92:95], v16 offset:31744
    v_exp_f32 v180, v180
    v_mfma_f32_16x16x32_bf16 v[160:163], a[92:95], v[104:107], v[160:163]
    buffer_load_dwordx4 v10, s[12:15], s101 offen offset:3072 sc1 lds
    v_mul_f32 v140, v140, v144
    v_mfma_f32_16x16x32_bf16 v[172:175], a[92:95], v[108:111], v[172:175]
    s_waitcnt lgkmcnt(4)
    v_fma_f32 v180, v180, v39, v39
    v_mul_f32 v181, v141, v141
    v_mfma_f32_16x16x32_bf16 v[152:155], a[96:99], v[112:115], v[152:155]
    s_add_u32 m0, s56, 4096
    ds_read_b128 v[96:99], v16 offset:12288
    v_rcp_f32 v180, v180
    v_mfma_f32_16x16x32_bf16 v[164:167], a[96:99], v[116:119], v[164:167]
    s_add_u32 s101, s101, 4096
    v_mul_f32 v140, v140, v180
    v_fma_f32 v181, v181, v38, v37
    v_mfma_f32_16x16x32_bf16 v[168:171], a[100:103], v[116:119], v[168:171]
    v_mul_f32 v181, v181, v141
    v_mul_f32 v182, v142, v142
    v_mfma_f32_16x16x32_bf16 v[156:159], a[100:103], v[112:115], v[156:159]
    ds_read_b128 v[100:103], v16 offset:32768
    buffer_load_dwordx4 v10, s[12:15], s101 offen offset:0 sc1 lds
    v_fma_f32 v182, v182, v38, v37
    v_mfma_f32_16x16x32_bf16 v[160:163], a[104:107], v[112:115], v[160:163]
    v_exp_f32 v181, v181
    v_mfma_f32_16x16x32_bf16 v[172:175], a[104:107], v[116:119], v[172:175]
    v_mul_f32 v182, v182, v142
    v_mul_f32 v141, v141, v145
    v_mfma_f32_16x16x32_bf16 v[152:155], a[108:111], v[120:123], v[152:155]
    ds_read_b128 v[104:107], v16 offset:13312
    v_exp_f32 v182, v182
    v_mfma_f32_16x16x32_bf16 v[164:167], a[108:111], v[124:127], v[164:167]
    v_fma_f32 v181, v181, v39, v39
    v_mul_f32 v142, v142, v146
    v_mfma_f32_16x16x32_bf16 v[168:171], a[112:115], v[124:127], v[168:171]
    buffer_load_dwordx4 v10, s[12:15], s101 offen offset:1024 sc1 lds
    v_fma_f32 v182, v182, v39, v39
    v_mfma_f32_16x16x32_bf16 v[156:159], a[112:115], v[120:123], v[156:159]
    ds_read_b128 v[108:111], v16 offset:33792
    v_rcp_f32 v181, v181
    v_mfma_f32_16x16x32_bf16 v[160:163], a[116:119], v[120:123], v[160:163]
    v_rcp_f32 v182, v182
    v_mfma_f32_16x16x32_bf16 v[172:175], a[116:119], v[124:127], v[172:175]
    s_waitcnt lgkmcnt(4)
    v_mul_f32 v141, v141, v181
    v_mul_f32 v142, v142, v182
    v_mfma_f32_16x16x32_bf16 v[152:155], a[120:123], v[80:83], v[152:155]
    ds_read_b128 v[112:115], v16 offset:14336
    v_mul_f32 v183, v143, v143
    v_mul_f32 v184, v136, v136
    v_mfma_f32_16x16x32_bf16 v[164:167], a[120:123], v[84:87], v[164:167]
    buffer_load_dwordx4 v10, s[12:15], s101 offen offset:2048 sc1 lds
    v_fma_f32 v183, v183, v38, v37
    v_mfma_f32_16x16x32_bf16 v[168:171], a[124:127], v[84:87], v[168:171]
    v_mul_f32 v183, v183, v143
    v_fma_f32 v184, v184, v42, v41
    v_mfma_f32_16x16x32_bf16 v[156:159], a[124:127], v[80:83], v[156:159]
    ds_read_b128 v[116:119], v16 offset:34816
    v_exp_f32 v183, v183
    v_mfma_f32_16x16x32_bf16 v[160:163], a[128:131], v[80:83], v[160:163]
    v_mul_f32 v184, v184, v136
    v_mul_f32 v143, v143, v147
    v_mfma_f32_16x16x32_bf16 v[172:175], a[128:131], v[84:87], v[172:175]
    v_exp_f32 v184, v184
    v_mfma_f32_16x16x32_bf16 v[152:155], a[132:135], v[88:91], v[152:155]
    ds_read_b128 v[120:123], v16 offset:15360
    buffer_load_dwordx4 v10, s[12:15], s101 offen offset:3072 sc1 lds
    v_fma_f32 v183, v183, v39, v39
    v_mfma_f32_16x16x32_bf16 v[164:167], a[132:135], v[92:95], v[164:167]
    s_add_u32 m0, s56, 8192
    v_rcp_f32 v183, v183
    v_mfma_f32_16x16x32_bf16 v[168:171], a[136:139], v[92:95], v[168:171]
    s_add_u32 s101, s101, 4096
    v_mul_f32 v143, v143, v183
    v_mul_f32 v136, v136, v148
    v_mfma_f32_16x16x32_bf16 v[156:159], a[136:139], v[88:91], v[156:159]
    ds_read_b128 v[124:127], v16 offset:35840
    v_fma_f32 v184, v184, v43, v43
    v_mul_f32 v185, v137, v137
    v_mfma_f32_16x16x32_bf16 v[160:163], a[140:143], v[88:91], v[160:163]
    v_rcp_f32 v184, v184
    v_mfma_f32_16x16x32_bf16 v[172:175], a[140:143], v[92:95], v[172:175]
    s_waitcnt lgkmcnt(4)
    buffer_load_dwordx4 v10, s[12:15], s101 offen offset:0 sc1 lds
    v_mul_f32 v136, v136, v184
    v_mfma_f32_16x16x32_bf16 v[152:155], a[144:147], v[96:99], v[152:155]
    ds_read_b128 v[80:83], v16 offset:16384
    v_fma_f32 v185, v185, v42, v41
    v_mfma_f32_16x16x32_bf16 v[164:167], a[144:147], v[100:103], v[164:167]
    v_mul_f32 v185, v185, v137
    v_mul_f32 v186, v138, v138
    v_mfma_f32_16x16x32_bf16 v[168:171], a[148:151], v[100:103], v[168:171]
    v_exp_f32 v185, v185
    v_mfma_f32_16x16x32_bf16 v[156:159], a[148:151], v[96:99], v[156:159]
    ds_read_b128 v[84:87], v16 offset:36864
    v_mul_f32 v137, v137, v149
    v_mfma_f32_16x16x32_bf16 v[160:163], a[152:155], v[96:99], v[160:163]
    buffer_load_dwordx4 v10, s[12:15], s101 offen offset:1024 sc1 lds
    v_fma_f32 v185, v185, v43, v43
    v_mfma_f32_16x16x32_bf16 v[172:175], a[152:155], v[100:103], v[172:175]
    s_add_u32 s101, s101, 2048
    v_rcp_f32 v185, v185
    v_mfma_f32_16x16x32_bf16 v[152:155], a[156:159], v[104:107], v[152:155]
    ds_read_b128 v[88:91], v16 offset:17408
    v_mul_f32 v137, v137, v185
    v_mfma_f32_16x16x32_bf16 v[164:167], a[156:159], v[108:111], v[164:167]
    v_fma_f32 v186, v186, v42, v41
    v_mul_f32 v187, v139, v139
    v_mfma_f32_16x16x32_bf16 v[168:171], a[160:163], v[108:111], v[168:171]
    v_mul_f32 v186, v186, v138
    v_fma_f32 v187, v187, v42, v41
    v_mfma_f32_16x16x32_bf16 v[156:159], a[160:163], v[104:107], v[156:159]
    ds_read_b128 v[92:95], v16 offset:37888
    buffer_load_dwordx4 v[196:199], v10, s[12:15], s96 offen offset:0 sc1
    v_mfma_f32_16x16x32_bf16 v[160:163], a[164:167], v[104:107], v[160:163]
    v_exp_f32 v186, v186
    v_mfma_f32_16x16x32_bf16 v[172:175], a[164:167], v[108:111], v[172:175]
    s_waitcnt lgkmcnt(4)
    v_mul_f32 v187, v187, v139
    v_mul_f32 v138, v138, v150
    v_mfma_f32_16x16x32_bf16 v[152:155], a[168:171], v[112:115], v[152:155]
    ds_read_b128 v[96:99], v16 offset:18432
    v_fma_f32 v186, v186, v43, v43
    v_mfma_f32_16x16x32_bf16 v[164:167], a[168:171], v[116:119], v[164:167]
    v_rcp_f32 v186, v186
    v_mfma_f32_16x16x32_bf16 v[168:171], a[172:175], v[116:119], v[168:171]
    buffer_load_dwordx4 v[200:203], v10, s[12:15], s96 offen offset:1024 sc1
    v_mul_f32 v138, v138, v186
    v_mfma_f32_16x16x32_bf16 v[156:159], a[172:175], v[112:115], v[156:159]
    ds_read_b128 v[100:103], v16 offset:38912
    v_mfma_f32_16x16x32_bf16 v[160:163], a[176:179], v[112:115], v[160:163]
    v_exp_f32 v187, v187
    v_mfma_f32_16x16x32_bf16 v[172:175], a[176:179], v[116:119], v[172:175]
    v_mul_f32 v139, v139, v151
    v_mfma_f32_16x16x32_bf16 v[152:155], a[180:183], v[120:123], v[152:155]
    ds_read_b128 v[104:107], v16 offset:19456
    v_fma_f32 v187, v187, v43, v43
    v_mfma_f32_16x16x32_bf16 v[164:167], a[180:183], v[124:127], v[164:167]
    buffer_load_dwordx4 v[204:207], v10, s[12:15], s96 offen offset:2048 sc1
    v_mfma_f32_16x16x32_bf16 v[168:171], a[184:187], v[124:127], v[168:171]
    v_rcp_f32 v187, v187
    v_mfma_f32_16x16x32_bf16 v[156:159], a[184:187], v[120:123], v[156:159]
    ds_read_b128 v[108:111], v16 offset:39936
    v_mul_f32 v139, v139, v187
    v_mfma_f32_16x16x32_bf16 v[160:163], a[188:191], v[120:123], v[160:163]
    v_cvt_pk_bf16_f32 v188, v128, v129
    v_cvt_pk_bf16_f32 v189, v130, v131
    v_mfma_f32_16x16x32_bf16 v[172:175], a[188:191], v[124:127], v[172:175]
    s_waitcnt vmcnt(23) lgkmcnt(0)
    v_add_u32 v16, 40960, v16
    s_barrier
    v_mfma_f32_16x16x32_bf16 v[152:155], a[192:195], v[80:83], v[152:155]
    ds_read_b128 v[112:115], v16 offset:0
    buffer_load_dwordx4 v[208:211], v10, s[12:15], s96 offen offset:3072 sc1
    v_cvt_pk_bf16_f32 v190, v140, v141
    v_mfma_f32_16x16x32_bf16 v[164:167], a[192:195], v[84:87], v[164:167]
    s_add_u32 s96, s96, 4096
    v_cvt_pk_bf16_f32 v191, v142, v143
    v_cvt_pk_bf16_f32 v192, v136, v137
    v_mfma_f32_16x16x32_bf16 v[168:171], a[196:199], v[84:87], v[168:171]
    v_cvt_pk_bf16_f32 v193, v138, v139
    v_mov_b32 v194, v192
    v_mfma_f32_16x16x32_bf16 v[156:159], a[196:199], v[80:83], v[156:159]
    ds_read_b128 v[116:119], v16 offset:20480
    v_mov_b32 v195, v193
    v_mfma_f32_16x16x32_bf16 v[160:163], a[200:203], v[80:83], v[160:163]
    v_permlane32_swap_b32 v188, v190
    v_mfma_f32_16x16x32_bf16 v[172:175], a[200:203], v[84:87], v[172:175]
    buffer_load_dwordx4 v[212:215], v10, s[12:15], s96 offen offset:0 sc1
    v_mfma_f32_16x16x32_bf16 v[152:155], a[204:207], v[88:91], v[152:155]
    ds_read_b128 v[120:123], v16 offset:1024
    v_permlane32_swap_b32 v189, v191
    v_mfma_f32_16x16x32_bf16 v[164:167], a[204:207], v[92:95], v[164:167]
    v_permlane16_swap_b32 v192, v194
    v_mfma_f32_16x16x32_bf16 v[168:171], a[208:211], v[92:95], v[168:171]
    v_permlane16_swap_b32 v193, v195
    v_mfma_f32_16x16x32_bf16 v[156:159], a[208:211], v[88:91], v[156:159]
    ds_read_b128 v[124:127], v16 offset:21504
    buffer_store_dwordx4 v[188:191], v14, s[12:15], s100 offen sc1
    buffer_store_dwordx4 v[192:195], v15, s[12:15], s100 offen sc1
    v_mfma_f32_16x16x32_bf16 v[160:163], a[212:215], v[88:91], v[160:163]
    s_add_u32 s100, s100, 98304
    buffer_load_dwordx4 v[216:219], v10, s[12:15], s96 offen offset:1024 sc1
    v_mfma_f32_16x16x32_bf16 v[172:175], a[212:215], v[92:95], v[172:175]
    v_mfma_f32_16x16x32_bf16 v[152:155], a[216:219], v[96:99], v[152:155]
    ds_read_b128 v[80:83], v16 offset:2048
    v_mfma_f32_16x16x32_bf16 v[164:167], a[216:219], v[100:103], v[164:167]
    v_mfma_f32_16x16x32_bf16 v[168:171], a[220:223], v[100:103], v[168:171]
    v_mfma_f32_16x16x32_bf16 v[156:159], a[220:223], v[96:99], v[156:159]
    ds_read_b128 v[84:87], v16 offset:22528
    buffer_load_dwordx4 v[220:223], v10, s[12:15], s96 offen offset:2048 sc1
    v_mfma_f32_16x16x32_bf16 v[160:163], a[224:227], v[96:99], v[160:163]
    v_mfma_f32_16x16x32_bf16 v[172:175], a[224:227], v[100:103], v[172:175]
    v_mfma_f32_16x16x32_bf16 v[152:155], a[228:231], v[104:107], v[152:155]
    ds_read_b128 v[88:91], v16 offset:3072
    v_mfma_f32_16x16x32_bf16 v[164:167], a[228:231], v[108:111], v[164:167]
    v_mfma_f32_16x16x32_bf16 v[168:171], a[232:235], v[108:111], v[168:171]
    buffer_load_dwordx4 v[224:227], v10, s[12:15], s96 offen offset:3072 sc1
    v_mfma_f32_16x16x32_bf16 v[156:159], a[232:235], v[104:107], v[156:159]
    s_add_u32 s96, s96, 4096
    ds_read_b128 v[92:95], v16 offset:23552
    v_mfma_f32_16x16x32_bf16 v[160:163], a[236:239], v[104:107], v[160:163]
    v_mfma_f32_16x16x32_bf16 v[172:175], a[236:239], v[108:111], v[172:175]
    s_waitcnt lgkmcnt(4)
    v_mfma_f32_16x16x32_bf16 v[128:131], a[0:3], v[112:115], 0
    ds_read_b128 v[96:99], v16 offset:4096
    v_mfma_f32_16x16x32_bf16 v[140:143], a[0:3], v[116:119], 0
    buffer_load_dwordx4 v[228:231], v10, s[12:15], s96 offen offset:0 sc1
    v_mfma_f32_16x16x32_bf16 v[144:147], a[4:7], v[116:119], 0
    v_mfma_f32_16x16x32_bf16 v[132:135], a[4:7], v[112:115], 0
    ds_read_b128 v[100:103], v16 offset:24576
    v_fmac_f32 v160, v28, v44
    v_fmac_f32 v161, v29, v44
    v_mfma_f32_16x16x32_bf16 v[136:139], a[8:11], v[112:115], 0
    v_fmac_f32 v162, v30, v44
    v_fmac_f32 v163, v31, v44
    v_mfma_f32_16x16x32_bf16 v[148:151], a[8:11], v[116:119], 0
    v_fmac_f32 v172, v28, v48
    v_fmac_f32 v173, v29, v48
    v_mfma_f32_16x16x32_bf16 v[128:131], a[12:15], v[120:123], v[128:131]
    ds_read_b128 v[104:107], v16 offset:5120
    buffer_load_dwordx4 v[232:235], v10, s[12:15], s96 offen offset:1024 sc1
    v_fmac_f32 v174, v30, v48
    v_mfma_f32_16x16x32_bf16 v[140:143], a[12:15], v[124:127], v[140:143]
    v_fmac_f32 v175, v31, v48
    v_fmac_f32 v152, v20, v44
    v_mfma_f32_16x16x32_bf16 v[144:147], a[16:19], v[124:127], v[144:147]
    v_fmac_f32 v153, v21, v44
    v_fmac_f32 v154, v22, v44
    v_mfma_f32_16x16x32_bf16 v[132:135], a[16:19], v[120:123], v[132:135]
    ds_read_b128 v[108:111], v16 offset:25600
    v_fmac_f32 v155, v23, v44
    v_fmac_f32 v164, v20, v48
    v_mfma_f32_16x16x32_bf16 v[136:139], a[20:23], v[120:123], v[136:139]
    v_fmac_f32 v165, v21, v48
    v_fmac_f32 v166, v22, v48
    v_mfma_f32_16x16x32_bf16 v[148:151], a[20:23], v[124:127], v[148:151]
    s_waitcnt lgkmcnt(4)
    buffer_load_dwordx4 v[236:239], v10, s[12:15], s96 offen offset:2048 sc1
    v_fmac_f32 v167, v23, v48
    v_mfma_f32_16x16x32_bf16 v[128:131], a[24:27], v[80:83], v[128:131]
    ds_read_b128 v[112:115], v16 offset:6144
    v_permlane32_swap_b32 v160, v172
    v_mfma_f32_16x16x32_bf16 v[140:143], a[24:27], v[84:87], v[140:143]
    v_permlane32_swap_b32 v161, v173
    v_mfma_f32_16x16x32_bf16 v[144:147], a[28:31], v[84:87], v[144:147]
    v_permlane32_swap_b32 v162, v174
    v_mfma_f32_16x16x32_bf16 v[132:135], a[28:31], v[80:83], v[132:135]
    ds_read_b128 v[116:119], v16 offset:26624
    v_permlane32_swap_b32 v163, v175
    v_mfma_f32_16x16x32_bf16 v[136:139], a[32:35], v[80:83], v[136:139]
    buffer_load_dwordx4 v[240:243], v10, s[12:15], s96 offen offset:3072 sc1
    v_fmac_f32 v156, v24, v44
    v_mfma_f32_16x16x32_bf16 v[148:151], a[32:35], v[84:87], v[148:151]
    s_add_u32 m0, s56, 40960
    v_fmac_f32 v157, v25, v44
    v_fmac_f32 v158, v26, v44
    v_mfma_f32_16x16x32_bf16 v[128:131], a[36:39], v[88:91], v[128:131]
    s_nop 0
    ds_read_b128 v[120:123], v16 offset:7168
    v_fmac_f32 v159, v27, v44
    v_fmac_f32 v168, v24, v48
    v_mfma_f32_16x16x32_bf16 v[140:143], a[36:39], v[92:95], v[140:143]
    v_fmac_f32 v169, v25, v48
    v_fmac_f32 v170, v26, v48
    v_mfma_f32_16x16x32_bf16 v[144:147], a[40:43], v[92:95], v[144:147]
    v_fmac_f32 v171, v27, v48
    v_mfma_f32_16x16x32_bf16 v[132:135], a[40:43], v[88:91], v[132:135]
    ds_read_b128 v[124:127], v16 offset:27648
    buffer_load_dwordx4 v10, s[12:15], s101 offen offset:0 sc1 lds
    v_mul_f32 v176, v152, v152
    v_mfma_f32_16x16x32_bf16 v[136:139], a[44:47], v[88:91], v[136:139]
    v_fma_f32 v176, v176, v46, v45
    v_mul_f32 v177, v153, v153
    v_mfma_f32_16x16x32_bf16 v[148:151], a[44:47], v[92:95], v[148:151]
    s_waitcnt lgkmcnt(4)
    v_mul_f32 v176, v176, v152
    v_fma_f32 v177, v177, v46, v45
    v_mfma_f32_16x16x32_bf16 v[128:131], a[48:51], v[96:99], v[128:131]
    ds_read_b128 v[80:83], v16 offset:8192
    v_exp_f32 v176, v176
    v_mfma_f32_16x16x32_bf16 v[140:143], a[48:51], v[100:103], v[140:143]
    v_mul_f32 v177, v177, v153
    v_mul_f32 v152, v152, v156
    v_mfma_f32_16x16x32_bf16 v[144:147], a[52:55], v[100:103], v[144:147]
    buffer_load_dwordx4 v10, s[12:15], s101 offen offset:1024 sc1 lds
    v_fma_f32 v176, v176, v47, v47
    v_mfma_f32_16x16x32_bf16 v[132:135], a[52:55], v[96:99], v[132:135]
    ds_read_b128 v[84:87], v16 offset:28672
    v_rcp_f32 v176, v176
    v_mfma_f32_16x16x32_bf16 v[136:139], a[56:59], v[96:99], v[136:139]
    v_exp_f32 v177, v177
    v_mfma_f32_16x16x32_bf16 v[148:151], a[56:59], v[100:103], v[148:151]
    v_mul_f32 v152, v152, v176
    v_mul_f32 v153, v153, v157
    v_mfma_f32_16x16x32_bf16 v[128:131], a[60:63], v[104:107], v[128:131]
    ds_read_b128 v[88:91], v16 offset:9216
    v_fma_f32 v177, v177, v47, v47
    v_mul_f32 v178, v154, v154
    v_mfma_f32_16x16x32_bf16 v[140:143], a[60:63], v[108:111], v[140:143]
    buffer_load_dwordx4 v10, s[12:15], s101 offen offset:2048 sc1 lds
    v_fma_f32 v178, v178, v46, v45
    v_mfma_f32_16x16x32_bf16 v[144:147], a[64:67], v[108:111], v[144:147]
    v_rcp_f32 v177, v177
    v_mfma_f32_16x16x32_bf16 v[132:135], a[64:67], v[104:107], v[132:135]
    ds_read_b128 v[92:95], v16 offset:29696
    v_mul_f32 v178, v178, v154
    v_mul_f32 v153, v153, v177
    v_mfma_f32_16x16x32_bf16 v[136:139], a[68:71], v[104:107], v[136:139]
    v_exp_f32 v178, v178
    v_mfma_f32_16x16x32_bf16 v[148:151], a[68:71], v[108:111], v[148:151]
    s_waitcnt lgkmcnt(4)
    v_mul_f32 v154, v154, v158
    v_mul_f32 v179, v155, v155
    v_mfma_f32_16x16x32_bf16 v[128:131], a[72:75], v[112:115], v[128:131]
    ds_read_b128 v[96:99], v16 offset:10240
    buffer_load_dwordx4 v10, s[12:15], s101 offen offset:3072 sc1 lds
    v_fma_f32 v178, v178, v47, v47
    v_mfma_f32_16x16x32_bf16 v[140:143], a[72:75], v[116:119], v[140:143]
    s_add_u32 m0, s56, 45056
    v_rcp_f32 v178, v178
    v_mfma_f32_16x16x32_bf16 v[144:147], a[76:79], v[116:119], v[144:147]
    s_add_u32 s101, s101, 4096
    v_mul_f32 v154, v154, v178
    v_fma_f32 v179, v179, v46, v45
    v_mfma_f32_16x16x32_bf16 v[132:135], a[76:79], v[112:115], v[132:135]
    ds_read_b128 v[100:103], v16 offset:30720
    v_mul_f32 v179, v179, v155
    v_mul_f32 v180, v164, v164
    v_mfma_f32_16x16x32_bf16 v[136:139], a[80:83], v[112:115], v[136:139]
    v_exp_f32 v179, v179
    v_mfma_f32_16x16x32_bf16 v[148:151], a[80:83], v[116:119], v[148:151]
    buffer_load_dwordx4 v10, s[12:15], s101 offen offset:0 sc1 lds
    v_mul_f32 v155, v155, v159
    v_mfma_f32_16x16x32_bf16 v[128:131], a[84:87], v[120:123], v[128:131]
    ds_read_b128 v[104:107], v16 offset:11264
    v_fma_f32 v179, v179, v47, v47
    v_fma_f32 v180, v180, v50, v49
    v_mfma_f32_16x16x32_bf16 v[140:143], a[84:87], v[124:127], v[140:143]
    v_rcp_f32 v179, v179
    v_mfma_f32_16x16x32_bf16 v[144:147], a[88:91], v[124:127], v[144:147]
    v_mul_f32 v180, v180, v164
    v_mul_f32 v155, v155, v179
    v_mfma_f32_16x16x32_bf16 v[132:135], a[88:91], v[120:123], v[132:135]
    ds_read_b128 v[108:111], v16 offset:31744
    v_exp_f32 v180, v180
    v_mfma_f32_16x16x32_bf16 v[136:139], a[92:95], v[120:123], v[136:139]
    buffer_load_dwordx4 v10, s[12:15], s101 offen offset:1024 sc1 lds
    v_mul_f32 v164, v164, v168
    v_mfma_f32_16x16x32_bf16 v[148:151], a[92:95], v[124:127], v[148:151]
    s_waitcnt lgkmcnt(4)
    v_fma_f32 v180, v180, v51, v51
    v_mul_f32 v181, v165, v165
    v_mfma_f32_16x16x32_bf16 v[128:131], a[96:99], v[80:83], v[128:131]
    ds_read_b128 v[112:115], v16 offset:12288
    v_rcp_f32 v180, v180
    v_mfma_f32_16x16x32_bf16 v[140:143], a[96:99], v[84:87], v[140:143]
    v_mul_f32 v164, v164, v180
    v_fma_f32 v181, v181, v50, v49
    v_mfma_f32_16x16x32_bf16 v[144:147], a[100:103], v[84:87], v[144:147]
    v_mul_f32 v181, v181, v165
    v_mul_f32 v182, v166, v166
    v_mfma_f32_16x16x32_bf16 v[132:135], a[100:103], v[80:83], v[132:135]
    ds_read_b128 v[116:119], v16 offset:32768
    buffer_load_dwordx4 v10, s[12:15], s101 offen offset:2048 sc1 lds
    v_fma_f32 v182, v182, v50, v49
    v_mfma_f32_16x16x32_bf16 v[136:139], a[104:107], v[80:83], v[136:139]
    v_exp_f32 v181, v181
    v_mfma_f32_16x16x32_bf16 v[148:151], a[104:107], v[84:87], v[148:151]
    v_mul_f32 v182, v182, v166
    v_mul_f32 v165, v165, v169
    v_mfma_f32_16x16x32_bf16 v[128:131], a[108:111], v[88:91], v[128:131]
    ds_read_b128 v[120:123], v16 offset:13312
    v_exp_f32 v182, v182
    v_mfma_f32_16x16x32_bf16 v[140:143], a[108:111], v[92:95], v[140:143]
    v_fma_f32 v181, v181, v51, v51
    v_mul_f32 v166, v166, v170
    v_mfma_f32_16x16x32_bf16 v[144:147], a[112:115], v[92:95], v[144:147]
    buffer_load_dwordx4 v10, s[12:15], s101 offen offset:3072 sc1 lds
    v_fma_f32 v182, v182, v51, v51
    v_mfma_f32_16x16x32_bf16 v[132:135], a[112:115], v[88:91], v[132:135]
    s_add_u32 m0, s56, 49152
    ds_read_b128 v[124:127], v16 offset:33792
    v_rcp_f32 v181, v181
    v_mfma_f32_16x16x32_bf16 v[136:139], a[116:119], v[88:91], v[136:139]
    s_add_u32 s101, s101, 4096
    v_rcp_f32 v182, v182
    v_mfma_f32_16x16x32_bf16 v[148:151], a[116:119], v[92:95], v[148:151]
    s_waitcnt lgkmcnt(4)
    v_mul_f32 v165, v165, v181
    v_mul_f32 v166, v166, v182
    v_mfma_f32_16x16x32_bf16 v[128:131], a[120:123], v[96:99], v[128:131]
    s_waitcnt vmcnt(15)
    s_barrier
    s_cmp_eq_u32 s42, 0
    s_cbranch_scc0 sa_44
    buffer_atomic_add v18, v17, s[12:15], s55 offen offset:0 sc1
sa_44:
    ds_read_b128 v[80:83], v16 offset:14336
    v_mfma_f32_16x16x32_bf16 v[140:143], a[120:123], v[100:103], v[140:143]
    buffer_load_dwordx4 v10, s[12:15], s101 offen offset:0 sc1 lds
    v_mul_f32 v183, v167, v167
    v_mfma_f32_16x16x32_bf16 v[144:147], a[124:127], v[100:103], v[144:147]
    v_fma_f32 v183, v183, v50, v49
    v_mul_f32 v184, v160, v160
    v_mfma_f32_16x16x32_bf16 v[132:135], a[124:127], v[96:99], v[132:135]
    ds_read_b128 v[84:87], v16 offset:34816
    v_mul_f32 v183, v183, v167
    v_fma_f32 v184, v184, v54, v53
    v_mfma_f32_16x16x32_bf16 v[136:139], a[128:131], v[96:99], v[136:139]
    v_exp_f32 v183, v183
    v_mfma_f32_16x16x32_bf16 v[148:151], a[128:131], v[100:103], v[148:151]
    v_mul_f32 v184, v184, v160
    v_mul_f32 v167, v167, v171
    v_mfma_f32_16x16x32_bf16 v[128:131], a[132:135], v[104:107], v[128:131]
    ds_read_b128 v[88:91], v16 offset:15360
    buffer_load_dwordx4 v10, s[12:15], s101 offen offset:1024 sc1 lds
    v_fma_f32 v183, v183, v51, v51
    v_mfma_f32_16x16x32_bf16 v[140:143], a[132:135], v[108:111], v[140:143]
    s_add_u32 s101, s101, 2048
    v_rcp_f32 v183, v183
    v_mfma_f32_16x16x32_bf16 v[144:147], a[136:139], v[108:111], v[144:147]
    v_exp_f32 v184, v184
    v_mfma_f32_16x16x32_bf16 v[132:135], a[136:139], v[104:107], v[132:135]
    ds_read_b128 v[92:95], v16 offset:35840
    v_mul_f32 v167, v167, v183
    v_mul_f32 v160, v160, v172
    v_mfma_f32_16x16x32_bf16 v[136:139], a[140:143], v[104:107], v[136:139]
    v_fma_f32 v184, v184, v55, v55
    v_mul_f32 v185, v161, v161
    v_mfma_f32_16x16x32_bf16 v[148:151], a[140:143], v[108:111], v[148:151]
    s_waitcnt lgkmcnt(4)
    v_rcp_f32 v184, v184
    v_mfma_f32_16x16x32_bf16 v[128:131], a[144:147], v[112:115], v[128:131]
    ds_read_b128 v[96:99], v16 offset:16384
    v_mul_f32 v160, v160, v184
    v_fma_f32 v185, v185, v54, v53
    v_mfma_f32_16x16x32_bf16 v[140:143], a[144:147], v[116:119], v[140:143]
    v_mul_f32 v185, v185, v161
    v_mul_f32 v186, v162, v162
    v_mfma_f32_16x16x32_bf16 v[144:147], a[148:151], v[116:119], v[144:147]
    v_exp_f32 v185, v185
    v_mfma_f32_16x16x32_bf16 v[132:135], a[148:151], v[112:115], v[132:135]
    ds_read_b128 v[100:103], v16 offset:36864
    v_mul_f32 v161, v161, v173
    v_mfma_f32_16x16x32_bf16 v[136:139], a[152:155], v[112:115], v[136:139]
    v_fma_f32 v185, v185, v55, v55
    v_fma_f32 v186, v186, v54, v53
    v_mfma_f32_16x16x32_bf16 v[148:151], a[152:155], v[116:119], v[148:151]
    v_rcp_f32 v185, v185
    v_mfma_f32_16x16x32_bf16 v[128:131], a[156:159], v[120:123], v[128:131]
    ds_read_b128 v[104:107], v16 offset:17408
    v_mul_f32 v186, v186, v162
    v_mfma_f32_16x16x32_bf16 v[140:143], a[156:159], v[124:127], v[140:143]
    v_exp_f32 v186, v186
    v_mfma_f32_16x16x32_bf16 v[144:147], a[160:163], v[124:127], v[144:147]
    v_mul_f32 v161, v161, v185
    v_mul_f32 v162, v162, v174
    v_mfma_f32_16x16x32_bf16 v[132:135], a[160:163], v[120:123], v[132:135]
    ds_read_b128 v[108:111], v16 offset:37888
    v_fma_f32 v186, v186, v55, v55
    v_mfma_f32_16x16x32_bf16 v[136:139], a[164:167], v[120:123], v[136:139]
    v_rcp_f32 v186, v186
    v_mfma_f32_16x16x32_bf16 v[148:151], a[164:167], v[124:127], v[148:151]
    s_waitcnt lgkmcnt(4)
    v_mul_f32 v162, v162, v186
    v_mul_f32 v187, v163, v163
    v_mfma_f32_16x16x32_bf16 v[128:131], a[168:171], v[80:83], v[128:131]
    ds_read_b128 v[112:115], v16 offset:18432
    v_fma_f32 v187, v187, v54, v53
    v_mfma_f32_16x16x32_bf16 v[140:143], a[168:171], v[84:87], v[140:143]
    v_mul_f32 v187, v187, v163
    v_mfma_f32_16x16x32_bf16 v[144:147], a[172:175], v[84:87], v[144:147]
    v_exp_f32 v187, v187
    v_mfma_f32_16x16x32_bf16 v[132:135], a[172:175], v[80:83], v[132:135]
    ds_read_b128 v[116:119], v16 offset:38912
    v_mul_f32 v163, v163, v175
    v_mfma_f32_16x16x32_bf16 v[136:139], a[176:179], v[80:83], v[136:139]
    v_fma_f32 v187, v187, v55, v55
    v_mfma_f32_16x16x32_bf16 v[148:151], a[176:179], v[84:87], v[148:151]
    v_rcp_f32 v187, v187
    v_mfma_f32_16x16x32_bf16 v[128:131], a[180:183], v[88:91], v[128:131]
    ds_read_b128 v[120:123], v16 offset:19456
    v_mul_f32 v163, v163, v187
    v_mfma_f32_16x16x32_bf16 v[140:143], a[180:183], v[92:95], v[140:143]
    v_cvt_pk_bf16_f32 v188, v152, v153
    v_cvt_pk_bf16_f32 v189, v154, v155
    v_mfma_f32_16x16x32_bf16 v[144:147], a[184:187], v[92:95], v[144:147]
    v_cvt_pk_bf16_f32 v190, v164, v165
    v_cvt_pk_bf16_f32 v191, v166, v167
    v_mfma_f32_16x16x32_bf16 v[132:135], a[184:187], v[88:91], v[132:135]
    ds_read_b128 v[124:127], v16 offset:39936
    v_cvt_pk_bf16_f32 v192, v160, v161
    v_mfma_f32_16x16x32_bf16 v[136:139], a[188:191], v[88:91], v[136:139]
    v_cvt_pk_bf16_f32 v193, v162, v163
    v_mov_b32 v194, v192
    v_mfma_f32_16x16x32_bf16 v[148:151], a[188:191], v[92:95], v[148:151]
    s_waitcnt vmcnt(34) lgkmcnt(0)
    v_add_u32 v16, 40960, v16
    s_barrier
    v_mfma_f32_16x16x32_bf16 v[128:131], a[192:195], v[96:99], v[128:131]
    s_add_u32 m0, s56, 81920
    ds_read_b128 v[80:83], v16 offset:0
    v_mov_b32 v195, v193
    v_mfma_f32_16x16x32_bf16 v[140:143], a[192:195], v[100:103], v[140:143]
    s_nop 0
    buffer_load_dwordx4 v10, s[12:15], s101 offen offset:0 sc1 lds
    v_mfma_f32_16x16x32_bf16 v[144:147], a[196:199], v[100:103], v[144:147]
    v_permlane32_swap_b32 v188, v190
    v_mfma_f32_16x16x32_bf16 v[132:135], a[196:199], v[96:99], v[132:135]
    ds_read_b128 v[84:87], v16 offset:20480
    v_mfma_f32_16x16x32_bf16 v[136:139], a[200:203], v[96:99], v[136:139]
    v_permlane32_swap_b32 v189, v191
    v_mfma_f32_16x16x32_bf16 v[148:151], a[200:203], v[100:103], v[148:151]
    v_permlane16_swap_b32 v192, v194
    v_mfma_f32_16x16x32_bf16 v[128:131], a[204:207], v[104:107], v[128:131]
    ds_read_b128 v[88:91], v16 offset:1024
    buffer_load_dwordx4 v10, s[12:15], s101 offen offset:1024 sc1 lds
    v_mfma_f32_16x16x32_bf16 v[140:143], a[204:207], v[108:111], v[140:143]
    v_permlane16_swap_b32 v193, v195
    v_mfma_f32_16x16x32_bf16 v[144:147], a[208:211], v[108:111], v[144:147]
    buffer_store_dwordx4 v[188:191], v14, s[12:15], s100 offen sc1
    buffer_store_dwordx4 v[192:195], v15, s[12:15], s100 offen sc1
    v_mfma_f32_16x16x32_bf16 v[132:135], a[208:211], v[104:107], v[132:135]
    s_add_u32 s100, s100, 98304
    ds_read_b128 v[92:95], v16 offset:21504
    v_mfma_f32_16x16x32_bf16 v[136:139], a[212:215], v[104:107], v[136:139]
    v_mfma_f32_16x16x32_bf16 v[148:151], a[212:215], v[108:111], v[148:151]
    buffer_load_dwordx4 v10, s[12:15], s101 offen offset:2048 sc1 lds
    v_mfma_f32_16x16x32_bf16 v[128:131], a[216:219], v[112:115], v[128:131]
    ds_read_b128 v[96:99], v16 offset:2048
    v_mfma_f32_16x16x32_bf16 v[140:143], a[216:219], v[116:119], v[140:143]
    v_mfma_f32_16x16x32_bf16 v[144:147], a[220:223], v[116:119], v[144:147]
    v_mfma_f32_16x16x32_bf16 v[132:135], a[220:223], v[112:115], v[132:135]
    ds_read_b128 v[100:103], v16 offset:22528
    v_mfma_f32_16x16x32_bf16 v[136:139], a[224:227], v[112:115], v[136:139]
    buffer_load_dwordx4 v10, s[12:15], s101 offen offset:3072 sc1 lds
    v_mfma_f32_16x16x32_bf16 v[148:151], a[224:227], v[116:119], v[148:151]
    s_add_u32 m0, s56, 86016
    v_mfma_f32_16x16x32_bf16 v[128:131], a[228:231], v[120:123], v[128:131]
    s_add_u32 s101, s101, 4096
    ds_read_b128 v[104:107], v16 offset:3072
    v_mfma_f32_16x16x32_bf16 v[140:143], a[228:231], v[124:127], v[140:143]
    v_mfma_f32_16x16x32_bf16 v[144:147], a[232:235], v[124:127], v[144:147]
    v_mfma_f32_16x16x32_bf16 v[132:135], a[232:235], v[120:123], v[132:135]
    ds_read_b128 v[108:111], v16 offset:23552
    buffer_load_dwordx4 v10, s[12:15], s101 offen offset:0 sc1 lds
    v_mfma_f32_16x16x32_bf16 v[136:139], a[236:239], v[120:123], v[136:139]
    v_mfma_f32_16x16x32_bf16 v[148:151], a[236:239], v[124:127], v[148:151]
    s_waitcnt lgkmcnt(4)
    v_mfma_f32_16x16x32_bf16 v[152:155], a[0:3], v[80:83], 0
    ds_read_b128 v[112:115], v16 offset:4096
    v_mfma_f32_16x16x32_bf16 v[164:167], a[0:3], v[84:87], 0
    v_mfma_f32_16x16x32_bf16 v[168:171], a[4:7], v[84:87], 0
    buffer_load_dwordx4 v10, s[12:15], s101 offen offset:1024 sc1 lds
    v_mfma_f32_16x16x32_bf16 v[156:159], a[4:7], v[80:83], 0
    ds_read_b128 v[116:119], v16 offset:24576
    v_fmac_f32 v136, v28, v56
    v_fmac_f32 v137, v29, v56
    v_mfma_f32_16x16x32_bf16 v[160:163], a[8:11], v[80:83], 0
    v_fmac_f32 v138, v30, v56
    v_fmac_f32 v139, v31, v56
    v_mfma_f32_16x16x32_bf16 v[172:175], a[8:11], v[84:87], 0
    v_fmac_f32 v148, v28, v60
    v_fmac_f32 v149, v29, v60
    v_mfma_f32_16x16x32_bf16 v[152:155], a[12:15], v[88:91], v[152:155]
    ds_read_b128 v[120:123], v16 offset:5120
    buffer_load_dword v2, v17, s[12:15], s41 offen offset:0 sc1
    v_fmac_f32 v150, v30, v60
    v_mfma_f32_16x16x32_bf16 v[164:167], a[12:15], v[92:95], v[164:167]
    buffer_load_dwordx4 v10, s[12:15], s101 offen offset:2048 sc1 lds
    v_fmac_f32 v151, v31, v60
    v_mfma_f32_16x16x32_bf16 v[168:171], a[16:19], v[92:95], v[168:171]
    v_fmac_f32 v128, v20, v56
    v_fmac_f32 v129, v21, v56
    v_mfma_f32_16x16x32_bf16 v[156:159], a[16:19], v[88:91], v[156:159]
    ds_read_b128 v[124:127], v16 offset:25600
    v_fmac_f32 v130, v22, v56
    v_fmac_f32 v131, v23, v56
    v_mfma_f32_16x16x32_bf16 v[160:163], a[20:23], v[88:91], v[160:163]
    v_fmac_f32 v140, v20, v60
    v_fmac_f32 v141, v21, v60
    v_mfma_f32_16x16x32_bf16 v[172:175], a[20:23], v[92:95], v[172:175]
    s_waitcnt lgkmcnt(4)
    v_fmac_f32 v142, v22, v60
    v_fmac_f32 v143, v23, v60
    v_mfma_f32_16x16x32_bf16 v[152:155], a[24:27], v[96:99], v[152:155]
    ds_read_b128 v[80:83], v16 offset:6144
    buffer_load_dwordx4 v10, s[12:15], s101 offen offset:3072 sc1 lds
    v_mfma_f32_16x16x32_bf16 v[164:167], a[24:27], v[100:103], v[164:167]
    s_add_u32 m0, s56, 90112
    v_permlane32_swap_b32 v136, v148
    v_mfma_f32_16x16x32_bf16 v[168:171], a[28:31], v[100:103], v[168:171]
    s_add_u32 s101, s101, 4096
    v_permlane32_swap_b32 v137, v149
    v_mfma_f32_16x16x32_bf16 v[156:159], a[28:31], v[96:99], v[156:159]
    ds_read_b128 v[84:87], v16 offset:26624
    v_permlane32_swap_b32 v138, v150
    v_mfma_f32_16x16x32_bf16 v[160:163], a[32:35], v[96:99], v[160:163]
    v_permlane32_swap_b32 v139, v151
    v_mfma_f32_16x16x32_bf16 v[172:175], a[32:35], v[100:103], v[172:175]
    buffer_load_dwordx4 v10, s[12:15], s101 offen offset:0 sc1 lds
    v_fmac_f32 v132, v24, v56
    v_mfma_f32_16x16x32_bf16 v[152:155], a[36:39], v[104:107], v[152:155]
    ds_read_b128 v[88:91], v16 offset:7168
    v_fmac_f32 v133, v25, v56
    v_fmac_f32 v134, v26, v56
    v_mfma_f32_16x16x32_bf16 v[164:167], a[36:39], v[108:111], v[164:167]
    v_fmac_f32 v135, v27, v56
    v_fmac_f32 v144, v24, v60
    v_mfma_f32_16x16x32_bf16 v[168:171], a[40:43], v[108:111], v[168:171]
    v_fmac_f32 v145, v25, v60
    v_fmac_f32 v146, v26, v60
    v_mfma_f32_16x16x32_bf16 v[156:159], a[40:43], v[104:107], v[156:159]
    ds_read_b128 v[92:95], v16 offset:27648
    v_fmac_f32 v147, v27, v60
    v_mfma_f32_16x16x32_bf16 v[160:163], a[44:47], v[104:107], v[160:163]
    buffer_load_dwordx4 v10, s[12:15], s101 offen offset:1024 sc1 lds
    v_mul_f32 v176, v128, v128
    v_mfma_f32_16x16x32_bf16 v[172:175], a[44:47], v[108:111], v[172:175]
    s_waitcnt lgkmcnt(4)
    v_fma_f32 v176, v176, v58, v57
    v_mul_f32 v177, v129, v129
    v_mfma_f32_16x16x32_bf16 v[152:155], a[48:51], v[112:115], v[152:155]
    s_add_u32 s101, s101, 2048
    ds_read_b128 v[96:99], v16 offset:8192
    v_mul_f32 v176, v176, v128
    v_fma_f32 v177, v177, v58, v57
    v_mfma_f32_16x16x32_bf16 v[164:167], a[48:51], v[116:119], v[164:167]
    s_add_u32 s96, s96, 34816
    v_exp_f32 v176, v176
    v_mfma_f32_16x16x32_bf16 v[168:171], a[52:55], v[116:119], v[168:171]
    v_mul_f32 v177, v177, v129
    v_mul_f32 v128, v128, v132
    v_mfma_f32_16x16x32_bf16 v[156:159], a[52:55], v[112:115], v[156:159]
    ds_read_b128 v[100:103], v16 offset:28672
    buffer_load_dwordx4 a[0:3], v10, s[12:15], s96 offen offset:0 sc1
    v_fma_f32 v176, v176, v59, v59
    v_mfma_f32_16x16x32_bf16 v[160:163], a[56:59], v[112:115], v[160:163]
    v_rcp_f32 v176, v176
    v_mfma_f32_16x16x32_bf16 v[172:175], a[56:59], v[116:119], v[172:175]
    v_exp_f32 v177, v177
    v_mfma_f32_16x16x32_bf16 v[152:155], a[60:63], v[120:123], v[152:155]
    ds_read_b128 v[104:107], v16 offset:9216
    v_mul_f32 v128, v128, v176
    v_mul_f32 v129, v129, v133
    v_mfma_f32_16x16x32_bf16 v[164:167], a[60:63], v[124:127], v[164:167]
    v_fma_f32 v177, v177, v59, v59
    v_mul_f32 v178, v130, v130
    v_mfma_f32_16x16x32_bf16 v[168:171], a[64:67], v[124:127], v[168:171]
    buffer_load_dwordx4 a[4:7], v10, s[12:15], s96 offen offset:1024 sc1
    v_fma_f32 v178, v178, v58, v57
    v_mfma_f32_16x16x32_bf16 v[156:159], a[64:67], v[120:123], v[156:159]
    ds_read_b128 v[108:111], v16 offset:29696
    v_rcp_f32 v177, v177
    v_mfma_f32_16x16x32_bf16 v[160:163], a[68:71], v[120:123], v[160:163]
    v_mul_f32 v178, v178, v130
    v_mul_f32 v129, v129, v177
    v_mfma_f32_16x16x32_bf16 v[172:175], a[68:71], v[124:127], v[172:175]
    s_waitcnt lgkmcnt(4)
    v_exp_f32 v178, v178
    v_mfma_f32_16x16x32_bf16 v[152:155], a[72:75], v[80:83], v[152:155]
    ds_read_b128 v[112:115], v16 offset:10240
    v_mul_f32 v130, v130, v134
    v_mul_f32 v179, v131, v131
    v_mfma_f32_16x16x32_bf16 v[164:167], a[72:75], v[84:87], v[164:167]
    buffer_load_dwordx4 a[8:11], v10, s[12:15], s96 offen offset:2048 sc1
    v_fma_f32 v178, v178, v59, v59
    v_mfma_f32_16x16x32_bf16 v[168:171], a[76:79], v[84:87], v[168:171]
    v_rcp_f32 v178, v178
    v_mfma_f32_16x16x32_bf16 v[156:159], a[76:79], v[80:83], v[156:159]
    ds_read_b128 v[116:119], v16 offset:30720
    v_mul_f32 v130, v130, v178
    v_fma_f32 v179, v179, v58, v57
    v_mfma_f32_16x16x32_bf16 v[160:163], a[80:83], v[80:83], v[160:163]
    v_mul_f32 v179, v179, v131
    v_mul_f32 v180, v140, v140
    v_mfma_f32_16x16x32_bf16 v[172:175], a[80:83], v[84:87], v[172:175]
    v_exp_f32 v179, v179
    v_mfma_f32_16x16x32_bf16 v[152:155], a[84:87], v[88:91], v[152:155]
    ds_read_b128 v[120:123], v16 offset:11264
    buffer_load_dwordx4 a[12:15], v10, s[12:15], s96 offen offset:3072 sc1
    v_mul_f32 v131, v131, v135
    v_mfma_f32_16x16x32_bf16 v[164:167], a[84:87], v[92:95], v[164:167]
    s_add_u32 s96, s96, 4096
    v_fma_f32 v179, v179, v59, v59
    v_fma_f32 v180, v180, v62, v61
    v_mfma_f32_16x16x32_bf16 v[168:171], a[88:91], v[92:95], v[168:171]
    v_rcp_f32 v179, v179
    v_mfma_f32_16x16x32_bf16 v[156:159], a[88:91], v[88:91], v[156:159]
    ds_read_b128 v[124:127], v16 offset:31744
    v_mul_f32 v180, v180, v140
    v_mul_f32 v131, v131, v179
    v_mfma_f32_16x16x32_bf16 v[160:163], a[92:95], v[88:91], v[160:163]
    v_exp_f32 v180, v180
    v_mfma_f32_16x16x32_bf16 v[172:175], a[92:95], v[92:95], v[172:175]
    s_waitcnt lgkmcnt(4)
    buffer_load_dwordx4 a[16:19], v10, s[12:15], s96 offen offset:0 sc1
    v_mul_f32 v140, v140, v144
    v_mfma_f32_16x16x32_bf16 v[152:155], a[96:99], v[96:99], v[152:155]
    s_waitcnt vmcnt(14)
    s_barrier
    s_cmp_eq_u32 s42, 0
    s_cbranch_scc0 sa_45
    buffer_atomic_add v18, v17, s[12:15], s55 offen offset:256 sc1
sa_45:
    ds_read_b128 v[80:83], v16 offset:12288
    v_mfma_f32_16x16x32_bf16 v[164:167], a[96:99], v[100:103], v[164:167]
    v_fma_f32 v180, v180, v63, v63
    v_mul_f32 v181, v141, v141
    v_mfma_f32_16x16x32_bf16 v[168:171], a[100:103], v[100:103], v[168:171]
    v_rcp_f32 v180, v180
    v_mfma_f32_16x16x32_bf16 v[156:159], a[100:103], v[96:99], v[156:159]
    ds_read_b128 v[84:87], v16 offset:32768
    v_mul_f32 v140, v140, v180
    v_fma_f32 v181, v181, v62, v61
    v_mfma_f32_16x16x32_bf16 v[160:163], a[104:107], v[96:99], v[160:163]
    buffer_load_dwordx4 a[20:23], v10, s[12:15], s96 offen offset:1024 sc1
    v_mul_f32 v181, v181, v141
    v_mfma_f32_16x16x32_bf16 v[172:175], a[104:107], v[100:103], v[172:175]
    v_exp_f32 v181, v181
    v_mfma_f32_16x16x32_bf16 v[152:155], a[108:111], v[104:107], v[152:155]
    ds_read_b128 v[88:91], v16 offset:13312
    v_mul_f32 v141, v141, v145
    v_mul_f32 v182, v142, v142
    v_mfma_f32_16x16x32_bf16 v[164:167], a[108:111], v[108:111], v[164:167]
    v_fma_f32 v181, v181, v63, v63
    v_fma_f32 v182, v182, v62, v61
    v_mfma_f32_16x16x32_bf16 v[168:171], a[112:115], v[108:111], v[168:171]
    v_rcp_f32 v181, v181
    v_mfma_f32_16x16x32_bf16 v[156:159], a[112:115], v[104:107], v[156:159]
    ds_read_b128 v[92:95], v16 offset:33792
    buffer_load_dwordx4 a[24:27], v10, s[12:15], s96 offen offset:2048 sc1
    v_mul_f32 v182, v182, v142
    v_mfma_f32_16x16x32_bf16 v[160:163], a[116:119], v[104:107], v[160:163]
    v_exp_f32 v182, v182
    v_mfma_f32_16x16x32_bf16 v[172:175], a[116:119], v[108:111], v[172:175]
    s_waitcnt lgkmcnt(4)
    v_mul_f32 v141, v141, v181
    v_mul_f32 v142, v142, v146
    v_mfma_f32_16x16x32_bf16 v[152:155], a[120:123], v[112:115], v[152:155]
    ds_read_b128 v[96:99], v16 offset:14336
    v_fma_f32 v182, v182, v63, v63
    v_mul_f32 v183, v143, v143
    v_mfma_f32_16x16x32_bf16 v[164:167], a[120:123], v[116:119], v[164:167]
    v_rcp_f32 v182, v182
    v_mfma_f32_16x16x32_bf16 v[168:171], a[124:127], v[116:119], v[168:171]
    buffer_load_dwordx4 a[28:31], v10, s[12:15], s96 offen offset:3072 sc1
    v_mul_f32 v142, v142, v182
    v_mfma_f32_16x16x32_bf16 v[156:159], a[124:127], v[112:115], v[156:159]
    s_add_u32 s96, s96, 4096
    ds_read_b128 v[100:103], v16 offset:34816
    v_fma_f32 v183, v183, v62, v61
    v_mul_f32 v184, v136, v136
    v_mfma_f32_16x16x32_bf16 v[160:163], a[128:131], v[112:115], v[160:163]
    v_mul_f32 v183, v183, v143
    v_fma_f32 v184, v184, v66, v65
    v_mfma_f32_16x16x32_bf16 v[172:175], a[128:131], v[116:119], v[172:175]
    v_exp_f32 v183, v183
    v_mfma_f32_16x16x32_bf16 v[152:155], a[132:135], v[120:123], v[152:155]
    ds_read_b128 v[104:107], v16 offset:15360
    v_mul_f32 v184, v184, v136
    v_mul_f32 v143, v143, v147
    v_mfma_f32_16x16x32_bf16 v[164:167], a[132:135], v[124:127], v[164:167]
    buffer_load_dwordx4 a[32:35], v10, s[12:15], s96 offen offset:0 sc1
    v_fma_f32 v183, v183, v63, v63
    v_mfma_f32_16x16x32_bf16 v[168:171], a[136:139], v[124:127], v[168:171]
    v_rcp_f32 v183, v183
    v_mfma_f32_16x16x32_bf16 v[156:159], a[136:139], v[120:123], v[156:159]
    ds_read_b128 v[108:111], v16 offset:35840
    v_exp_f32 v184, v184
    v_mfma_f32_16x16x32_bf16 v[160:163], a[140:143], v[120:123], v[160:163]
    v_mul_f32 v143, v143, v183
    v_mul_f32 v136, v136, v148
    v_mfma_f32_16x16x32_bf16 v[172:175], a[140:143], v[124:127], v[172:175]
    s_waitcnt lgkmcnt(4)
    v_fma_f32 v184, v184, v67, v67
    v_mul_f32 v185, v137, v137
    v_mfma_f32_16x16x32_bf16 v[152:155], a[144:147], v[80:83], v[152:155]
    ds_read_b128 v[112:115], v16 offset:16384
    buffer_load_dwordx4 a[36:39], v10, s[12:15], s96 offen offset:1024 sc1
    v_fma_f32 v185, v185, v66, v65
    v_mfma_f32_16x16x32_bf16 v[164:167], a[144:147], v[84:87], v[164:167]
    v_rcp_f32 v184, v184
    v_mfma_f32_16x16x32_bf16 v[168:171], a[148:151], v[84:87], v[168:171]
    v_mul_f32 v185, v185, v137
    v_mul_f32 v136, v136, v184
    v_mfma_f32_16x16x32_bf16 v[156:159], a[148:151], v[80:83], v[156:159]
    ds_read_b128 v[116:119], v16 offset:36864
    v_exp_f32 v185, v185
    v_mfma_f32_16x16x32_bf16 v[160:163], a[152:155], v[80:83], v[160:163]
    v_mul_f32 v137, v137, v149
    v_mul_f32 v186, v138, v138
    v_mfma_f32_16x16x32_bf16 v[172:175], a[152:155], v[84:87], v[172:175]
    buffer_load_dwordx4 a[40:43], v10, s[12:15], s96 offen offset:2048 sc1
    v_fma_f32 v185, v185, v67, v67
    v_mfma_f32_16x16x32_bf16 v[152:155], a[156:159], v[88:91], v[152:155]
    s_waitcnt vmcnt(15)
    v_readfirstlane_b32 s57, v2
    s_nop 1
    s_cmp_ge_u32 s57, 64
    s_cbranch_scc0 fs_46
fb_47:
    ds_read_b128 v[120:123], v16 offset:17408
    v_mfma_f32_16x16x32_bf16 v[164:167], a[156:159], v[92:95], v[164:167]
    v_rcp_f32 v185, v185
    v_mfma_f32_16x16x32_bf16 v[168:171], a[160:163], v[92:95], v[168:171]
    v_mul_f32 v137, v137, v185
    v_fma_f32 v186, v186, v66, v65
    v_mfma_f32_16x16x32_bf16 v[156:159], a[160:163], v[88:91], v[156:159]
    ds_read_b128 v[124:127], v16 offset:37888
    buffer_load_dwordx4 v[32:35], v10, s[12:15], s97 offen offset:0 sc1
    v_mul_f32 v186, v186, v138
    v_mfma_f32_16x16x32_bf16 v[160:163], a[164:167], v[88:91], v[160:163]
    buffer_load_dwordx4 a[44:47], v10, s[12:15], s96 offen offset:3072 sc1
    v_mul_f32 v187, v139, v139
    v_mfma_f32_16x16x32_bf16 v[172:175], a[164:167], v[92:95], v[172:175]
    s_waitcnt lgkmcnt(4)
    v_exp_f32 v186, v186
    v_mfma_f32_16x16x32_bf16 v[152:155], a[168:171], v[96:99], v[152:155]
    s_add_u32 s96, s96, 4096
    ds_read_b128 v[80:83], v16 offset:18432
    v_mul_f32 v138, v138, v150
    v_fma_f32 v187, v187, v66, v65
    v_mfma_f32_16x16x32_bf16 v[164:167], a[168:171], v[100:103], v[164:167]
    v_fma_f32 v186, v186, v67, v67
    v_mul_f32 v187, v187, v139
    v_mfma_f32_16x16x32_bf16 v[168:171], a[172:175], v[100:103], v[168:171]
    v_rcp_f32 v186, v186
    v_mfma_f32_16x16x32_bf16 v[156:159], a[172:175], v[96:99], v[156:159]
    ds_read_b128 v[84:87], v16 offset:38912
    buffer_load_dwordx4 a[48:51], v10, s[12:15], s96 offen offset:0 sc1
    buffer_load_dwordx4 v[36:39], v10, s[12:15], s97 offen offset:1024 sc1
    v_mfma_f32_16x16x32_bf16 v[160:163], a[176:179], v[96:99], v[160:163]
    v_exp_f32 v187, v187
    v_mfma_f32_16x16x32_bf16 v[172:175], a[176:179], v[100:103], v[172:175]
    v_mul_f32 v138, v138, v186
    v_mul_f32 v139, v139, v151
    v_mfma_f32_16x16x32_bf16 v[152:155], a[180:183], v[104:107], v[152:155]
    ds_read_b128 v[88:91], v16 offset:19456
    v_fma_f32 v187, v187, v67, v67
    v_mfma_f32_16x16x32_bf16 v[164:167], a[180:183], v[108:111], v[164:167]
    v_rcp_f32 v187, v187
    v_mfma_f32_16x16x32_bf16 v[168:171], a[184:187], v[108:111], v[168:171]
    buffer_load_dwordx4 a[52:55], v10, s[12:15], s96 offen offset:1024 sc1
    v_mul_f32 v139, v139, v187
    v_mfma_f32_16x16x32_bf16 v[156:159], a[184:187], v[104:107], v[156:159]
    ds_read_b128 v[92:95], v16 offset:39936
    buffer_load_dwordx4 v[40:43], v10, s[12:15], s97 offen offset:2048 sc1
    v_cvt_pk_bf16_f32 v188, v128, v129
    v_mfma_f32_16x16x32_bf16 v[160:163], a[188:191], v[104:107], v[160:163]
    v_cvt_pk_bf16_f32 v189, v130, v131
    v_cvt_pk_bf16_f32 v190, v140, v141
    v_mfma_f32_16x16x32_bf16 v[172:175], a[188:191], v[108:111], v[172:175]
    s_waitcnt vmcnt(63) lgkmcnt(0)
    s_barrier
    v_mfma_f32_16x16x32_bf16 v[152:155], a[192:195], v[112:115], v[152:155]
    v_cvt_pk_bf16_f32 v191, v142, v143
    v_cvt_pk_bf16_f32 v192, v136, v137
    v_cvt_pk_bf16_f32 v193, v138, v139
    v_mfma_f32_16x16x32_bf16 v[164:167], a[192:195], v[116:119], v[164:167]
    buffer_load_dwordx4 a[56:59], v10, s[12:15], s96 offen offset:2048 sc1
    v_mov_b32 v194, v192
    v_mfma_f32_16x16x32_bf16 v[168:171], a[196:199], v[116:119], v[168:171]
    v_mov_b32 v195, v193
    v_mfma_f32_16x16x32_bf16 v[156:159], a[196:199], v[112:115], v[156:159]
    v_permlane32_swap_b32 v188, v190
    v_mfma_f32_16x16x32_bf16 v[160:163], a[200:203], v[112:115], v[160:163]
    v_permlane32_swap_b32 v189, v191
    v_mfma_f32_16x16x32_bf16 v[172:175], a[200:203], v[116:119], v[172:175]
    v_permlane16_swap_b32 v192, v194
    v_mfma_f32_16x16x32_bf16 v[152:155], a[204:207], v[120:123], v[152:155]
    buffer_load_dwordx4 a[60:63], v10, s[12:15], s96 offen offset:3072 sc1
    v_mfma_f32_16x16x32_bf16 v[164:167], a[204:207], v[124:127], v[164:167]
    s_add_u32 s96, s96, 4096
    v_permlane16_swap_b32 v193, v195
    v_mfma_f32_16x16x32_bf16 v[168:171], a[208:211], v[124:127], v[168:171]
    buffer_store_dwordx4 v[188:191], v14, s[12:15], s100 offen sc1
    buffer_store_dwordx4 v[192:195], v15, s[12:15], s100 offen sc1
    v_mfma_f32_16x16x32_bf16 v[156:159], a[208:211], v[120:123], v[156:159]
    s_add_u32 s100, s100, 98304
    v_mfma_f32_16x16x32_bf16 v[160:163], a[212:215], v[120:123], v[160:163]
    v_mfma_f32_16x16x32_bf16 v[172:175], a[212:215], v[124:127], v[172:175]
    buffer_load_dwordx4 a[64:67], v10, s[12:15], s96 offen offset:0 sc1
    v_mfma_f32_16x16x32_bf16 v[152:155], a[216:219], v[80:83], v[152:155]
    buffer_load_dword v3, v17, s[12:15], s41 offen offset:256 sc1
    v_mfma_f32_16x16x32_bf16 v[164:167], a[216:219], v[84:87], v[164:167]
    v_mfma_f32_16x16x32_bf16 v[168:171], a[220:223], v[84:87], v[168:171]
    v_mfma_f32_16x16x32_bf16 v[156:159], a[220:223], v[80:83], v[156:159]
    v_mfma_f32_16x16x32_bf16 v[160:163], a[224:227], v[80:83], v[160:163]
    buffer_load_dwordx4 a[68:71], v10, s[12:15], s96 offen offset:1024 sc1
    v_mfma_f32_16x16x32_bf16 v[172:175], a[224:227], v[84:87], v[172:175]
    v_mfma_f32_16x16x32_bf16 v[152:155], a[228:231], v[88:91], v[152:155]
    v_mfma_f32_16x16x32_bf16 v[164:167], a[228:231], v[92:95], v[164:167]
    v_mfma_f32_16x16x32_bf16 v[168:171], a[232:235], v[92:95], v[168:171]
    v_mfma_f32_16x16x32_bf16 v[156:159], a[232:235], v[88:91], v[156:159]
    v_mfma_f32_16x16x32_bf16 v[160:163], a[236:239], v[88:91], v[160:163]
    v_mfma_f32_16x16x32_bf16 v[172:175], a[236:239], v[92:95], v[172:175]
    s_nop 6
    v_pk_fma_f32 v[160:161], v[28:29], v[68:69], v[160:161] op_sel:[0,0,0] op_sel_hi:[1,0,1]
    v_pk_fma_f32 v[162:163], v[30:31], v[68:69], v[162:163] op_sel:[0,0,0] op_sel_hi:[1,0,1]
    v_pk_fma_f32 v[172:173], v[28:29], v[72:73], v[172:173] op_sel:[0,0,0] op_sel_hi:[1,0,1]
    v_pk_fma_f32 v[174:175], v[30:31], v[72:73], v[174:175] op_sel:[0,0,0] op_sel_hi:[1,0,1]
    v_pk_fma_f32 v[152:153], v[20:21], v[68:69], v[152:153] op_sel:[0,0,0] op_sel_hi:[1,0,1]
    v_pk_fma_f32 v[154:155], v[22:23], v[68:69], v[154:155] op_sel:[0,0,0] op_sel_hi:[1,0,1]
    v_pk_fma_f32 v[164:165], v[20:21], v[72:73], v[164:165] op_sel:[0,0,0] op_sel_hi:[1,0,1]
    v_pk_fma_f32 v[166:167], v[22:23], v[72:73], v[166:167] op_sel:[0,0,0] op_sel_hi:[1,0,1]
    v_permlane32_swap_b32 v160, v172
    v_permlane32_swap_b32 v161, v173
    v_permlane32_swap_b32 v162, v174
    v_permlane32_swap_b32 v163, v175
    v_pk_fma_f32 v[156:157], v[24:25], v[68:69], v[156:157] op_sel:[0,0,0] op_sel_hi:[1,0,1]
    v_pk_fma_f32 v[158:159], v[26:27], v[68:69], v[158:159] op_sel:[0,0,0] op_sel_hi:[1,0,1]
    v_pk_fma_f32 v[168:169], v[24:25], v[72:73], v[168:169] op_sel:[0,0,0] op_sel_hi:[1,0,1]
    v_pk_fma_f32 v[170:171], v[26:27], v[72:73], v[170:171] op_sel:[0,0,0] op_sel_hi:[1,0,1]
    v_pk_mul_f32 v[176:177], v[152:153], v[152:153] op_sel:[0,0] op_sel_hi:[1,1]
    v_pk_mul_f32 v[178:179], v[154:155], v[154:155] op_sel:[0,0] op_sel_hi:[1,1]
    v_pk_mul_f32 v[180:181], v[164:165], v[164:165] op_sel:[0,0] op_sel_hi:[1,1]
    v_pk_mul_f32 v[182:183], v[166:167], v[166:167] op_sel:[0,0] op_sel_hi:[1,1]
    v_pk_mul_f32 v[184:185], v[160:161], v[160:161] op_sel:[0,0] op_sel_hi:[1,1]
    v_pk_mul_f32 v[186:187], v[162:163], v[162:163] op_sel:[0,0] op_sel_hi:[1,1]
    v_pk_fma_f32 v[176:177], v[176:177], v[70:71], v[68:69] op_sel:[0,0,1] op_sel_hi:[1,0,1]
    v_pk_fma_f32 v[178:179], v[178:179], v[70:71], v[68:69] op_sel:[0,0,1] op_sel_hi:[1,0,1]
    v_pk_fma_f32 v[180:181], v[180:181], v[74:75], v[72:73] op_sel:[0,0,1] op_sel_hi:[1,0,1]
    v_pk_fma_f32 v[182:183], v[182:183], v[74:75], v[72:73] op_sel:[0,0,1] op_sel_hi:[1,0,1]
    v_pk_fma_f32 v[184:185], v[184:185], v[78:79], v[76:77] op_sel:[0,0,1] op_sel_hi:[1,0,1]
    v_pk_fma_f32 v[186:187], v[186:187], v[78:79], v[76:77] op_sel:[0,0,1] op_sel_hi:[1,0,1]
    v_pk_mul_f32 v[176:177], v[176:177], v[152:153] op_sel:[0,0] op_sel_hi:[1,1]
    v_pk_mul_f32 v[178:179], v[178:179], v[154:155] op_sel:[0,0] op_sel_hi:[1,1]
    v_pk_mul_f32 v[180:181], v[180:181], v[164:165] op_sel:[0,0] op_sel_hi:[1,1]
    v_pk_mul_f32 v[182:183], v[182:183], v[166:167] op_sel:[0,0] op_sel_hi:[1,1]
    v_pk_mul_f32 v[184:185], v[184:185], v[160:161] op_sel:[0,0] op_sel_hi:[1,1]
    v_pk_mul_f32 v[186:187], v[186:187], v[162:163] op_sel:[0,0] op_sel_hi:[1,1]
    v_exp_f32 v176, v176
    v_exp_f32 v177, v177
    v_exp_f32 v178, v178
    v_exp_f32 v179, v179
    v_exp_f32 v180, v180
    v_exp_f32 v181, v181
    v_exp_f32 v182, v182
    v_exp_f32 v183, v183
    v_exp_f32 v184, v184
    v_exp_f32 v185, v185
    v_exp_f32 v186, v186
    v_exp_f32 v187, v187
    v_pk_mul_f32 v[152:153], v[152:153], v[156:157] op_sel:[0,0] op_sel_hi:[1,1]
    v_pk_mul_f32 v[154:155], v[154:155], v[158:159] op_sel:[0,0] op_sel_hi:[1,1]
    v_pk_mul_f32 v[164:165], v[164:165], v[168:169] op_sel:[0,0] op_sel_hi:[1,1]
    v_pk_mul_f32 v[166:167], v[166:167], v[170:171] op_sel:[0,0] op_sel_hi:[1,1]
    v_pk_mul_f32 v[160:161], v[160:161], v[172:173] op_sel:[0,0] op_sel_hi:[1,1]
    v_pk_mul_f32 v[162:163], v[162:163], v[174:175] op_sel:[0,0] op_sel_hi:[1,1]
    v_pk_fma_f32 v[176:177], v[176:177], v[70:71], v[70:71] op_sel:[0,1,1] op_sel_hi:[1,1,1]
    v_pk_fma_f32 v[178:179], v[178:179], v[70:71], v[70:71] op_sel:[0,1,1] op_sel_hi:[1,1,1]
    v_pk_fma_f32 v[180:181], v[180:181], v[74:75], v[74:75] op_sel:[0,1,1] op_sel_hi:[1,1,1]
    v_pk_fma_f32 v[182:183], v[182:183], v[74:75], v[74:75] op_sel:[0,1,1] op_sel_hi:[1,1,1]
    v_pk_fma_f32 v[184:185], v[184:185], v[78:79], v[78:79] op_sel:[0,1,1] op_sel_hi:[1,1,1]
    v_pk_fma_f32 v[186:187], v[186:187], v[78:79], v[78:79] op_sel:[0,1,1] op_sel_hi:[1,1,1]
    v_rcp_f32 v176, v176
    v_rcp_f32 v177, v177
    v_rcp_f32 v178, v178
    v_rcp_f32 v179, v179
    v_rcp_f32 v180, v180
    v_rcp_f32 v181, v181
    v_rcp_f32 v182, v182
    v_rcp_f32 v183, v183
    v_rcp_f32 v184, v184
    v_rcp_f32 v185, v185
    v_rcp_f32 v186, v186
    v_rcp_f32 v187, v187
    v_pk_mul_f32 v[152:153], v[152:153], v[176:177] op_sel:[0,0] op_sel_hi:[1,1]
    v_pk_mul_f32 v[154:155], v[154:155], v[178:179] op_sel:[0,0] op_sel_hi:[1,1]
    v_pk_mul_f32 v[164:165], v[164:165], v[180:181] op_sel:[0,0] op_sel_hi:[1,1]
    v_pk_mul_f32 v[166:167], v[166:167], v[182:183] op_sel:[0,0] op_sel_hi:[1,1]
    v_pk_mul_f32 v[160:161], v[160:161], v[184:185] op_sel:[0,0] op_sel_hi:[1,1]
    v_pk_mul_f32 v[162:163], v[162:163], v[186:187] op_sel:[0,0] op_sel_hi:[1,1]
    v_cvt_pk_bf16_f32 v188, v152, v153
    v_cvt_pk_bf16_f32 v189, v154, v155
    v_cvt_pk_bf16_f32 v190, v164, v165
    v_cvt_pk_bf16_f32 v191, v166, v167
    v_cvt_pk_bf16_f32 v192, v160, v161
    v_cvt_pk_bf16_f32 v193, v162, v163
    v_mov_b32 v194, v192
    v_mov_b32 v195, v193
    v_permlane32_swap_b32 v188, v190
    v_permlane32_swap_b32 v189, v191
    v_permlane16_swap_b32 v192, v194
    v_permlane16_swap_b32 v193, v195
    buffer_store_dwordx4 v[188:191], v14, s[12:15], s100 offen sc1
    buffer_store_dwordx4 v[192:195], v15, s[12:15], s100 offen sc1
    s_add_u32 s100, s100, 98304
    s_waitcnt vmcnt(5)
    s_barrier
    s_cmp_eq_u32 s42, 0
    s_cbranch_scc0 sa_48
    buffer_atomic_add v18, v17, s[12:15], s55 offen offset:512 sc1
sa_48:
    buffer_load_dwordx4 v[44:47], v10, s[12:15], s97 offen offset:3072 sc1
    s_add_u32 s97, s97, 4096
    buffer_load_dwordx4 v[48:51], v10, s[12:15], s97 offen offset:0 sc1
    buffer_load_dwordx4 v[52:55], v10, s[12:15], s97 offen offset:1024 sc1
    buffer_load_dwordx4 v[80:83], v10, s[12:15], s97 offen offset:2048 sc1
    buffer_load_dwordx4 v[84:87], v10, s[12:15], s97 offen offset:3072 sc1
    s_add_u32 s97, s97, 4096
    buffer_load_dwordx4 v[88:91], v10, s[12:15], s97 offen offset:0 sc1
    buffer_load_dwordx4 v[92:95], v10, s[12:15], s97 offen offset:1024 sc1
    buffer_load_dwordx4 v[96:99], v10, s[12:15], s97 offen offset:2048 sc1
    buffer_load_dwordx4 v[100:103], v10, s[12:15], s97 offen offset:3072 sc1
    s_add_u32 s97, s97, 90112
    v_add_u32 v11, s56, v10
    v_add_u32 v19, 0x10000, v11
    s_mul_i32 s58, s42, 5120
    s_add_u32 s58, s58, 122880
    v_and_b32 v4, 0x30, v1
    v_lshlrev_b32 v4, 2, v4
    v_xor_b32 v4, v4, v10
    v_add_u32 v16, s58, v4
    v_lshrrev_b32 v5, 2, v1
    s_lshl_b32 s58, s42, 2
    v_and_b32 v4, 3, v1
    v_add_u32 v4, s58, v4
    v_mul_u32_u24 v15, 1280, v4
    v_lshl_add_u32 v15, v5, 4, v15
    v_cmp_gt_u32 vcc, 40, v1
    s_nop 1
    v_cndmask_b32 v15, v9, v15, vcc
    v_min_u32 v5, 9, v5
    v_lshrrev_b32 v6, 2, v5
    v_lshlrev_b32 v6, 11, v6
    v_add_u32 v6, 122880, v6
    v_and_b32 v7, 3, v5
    v_cmp_le_u32 vcc, 8, v5
    v_lshlrev_b32 v8, 1, v7
    s_nop 0
    v_cndmask_b32 v7, v7, v8, vcc
    v_lshlrev_b32 v8, 2, v7
    v_xor_b32 v8, v8, v4
    v_lshl_add_u32 v13, v7, 8, v6
    v_lshl_add_u32 v13, v8, 4, v13
    v_xor_b32 v8, 4, v8
    v_add_u32 v7, 1, v7
    v_lshl_add_u32 v14, v7, 8, v6
    v_lshl_add_u32 v14, v8, 4, v14
    v_add_u32 v8, 0x400, v13
    v_cndmask_b32 v14, v8, v14, vcc
    s_lshl_b32 s99, s48, 3
    s_add_u32 s99, s99, s49
    s_mul_i32 s99, s99, 20480
    s_mul_i32 s58, s50, 160
    s_add_u32 s99, s99, s58
    v_subrev_u32 v4, 122880, v13
    v_subrev_u32 v5, 122880, v14
    v_and_b32 v6, 0x30, v1
    v_lshlrev_b32 v6, 2, v6
    v_xor_b32 v6, v6, v11
    s_waitcnt vmcnt(23)
    v_mfma_f32_16x16x32_bf16 v[104:107], v[196:199], v[32:35], 0
    ds_read_b128 a[120:123], v11 offset:0
    v_mfma_f32_16x16x32_bf16 v[108:111], v[200:203], v[32:35], 0
    ds_read_b128 a[124:127], v11 offset:1024
    v_mfma_f32_16x16x32_bf16 v[112:115], v[204:207], v[32:35], 0
    ds_read_b128 a[128:131], v11 offset:2048
    v_mfma_f32_16x16x32_bf16 v[116:119], v[208:211], v[32:35], 0
    ds_read_b128 a[132:135], v11 offset:3072
    v_mfma_f32_16x16x32_bf16 v[120:123], v[212:215], v[32:35], 0
    s_waitcnt vmcnt(20)
    ds_read_b128 a[136:139], v11 offset:4096
    v_mfma_f32_16x16x32_bf16 v[104:107], v[216:219], v[36:39], v[104:107]
    ds_read_b128 a[140:143], v11 offset:5120
    v_mfma_f32_16x16x32_bf16 v[108:111], v[220:223], v[36:39], v[108:111]
    ds_read_b128 a[144:147], v11 offset:6144
    v_mfma_f32_16x16x32_bf16 v[112:115], v[224:227], v[36:39], v[112:115]
    ds_read_b128 a[148:151], v11 offset:7168
    v_mfma_f32_16x16x32_bf16 v[116:119], v[228:231], v[36:39], v[116:119]
    ds_read_b128 a[152:155], v11 offset:8192
    v_mfma_f32_16x16x32_bf16 v[120:123], v[232:235], v[36:39], v[120:123]
    s_waitcnt vmcnt(18)
    ds_read_b128 a[156:159], v11 offset:9216
    v_mfma_f32_16x16x32_bf16 v[104:107], v[236:239], v[40:43], v[104:107]
    s_waitcnt vmcnt(12)
    v_readfirstlane_b32 s57, v3
    s_nop 1
    s_cmp_ge_u32 s57, 64
    s_cbranch_scc0 fs_49
fb_50:
    v_mfma_f32_16x16x32_bf16 v[108:111], v[240:243], v[40:43], v[108:111]
    s_waitcnt lgkmcnt(6)
    buffer_load_dwordx4 v[128:131], v10, s[12:15], s97 offen offset:0 sc1
    ds_read_b128 a[160:163], v11 offset:40960
    v_mfma_f32_16x16x32_bf16 v[112:115], a[120:123], v[40:43], v[112:115]
    ds_read_b128 a[164:167], v11 offset:41984
    ds_read_b128 a[168:171], v11 offset:43008
    v_mfma_f32_16x16x32_bf16 v[116:119], a[124:127], v[40:43], v[116:119]
    ds_read_b128 a[172:175], v11 offset:44032
    v_mfma_f32_16x16x32_bf16 v[120:123], a[128:131], v[40:43], v[120:123]
    s_waitcnt vmcnt(9)
    ds_read_b128 a[176:179], v11 offset:45056
    v_mfma_f32_16x16x32_bf16 v[104:107], a[132:135], v[44:47], v[104:107]
    s_waitcnt lgkmcnt(7)
    buffer_load_dwordx4 v[132:135], v10, s[12:15], s97 offen offset:1024 sc1
    ds_read_b128 a[180:183], v11 offset:46080
    v_mfma_f32_16x16x32_bf16 v[108:111], a[136:139], v[44:47], v[108:111]
    s_waitcnt vmcnt(11)
    s_barrier
    s_cmp_eq_u32 s42, 0
    s_cbranch_scc0 sa_51
    buffer_atomic_add v18, v17, s[12:15], s55 offen offset:768 sc1
sa_51:
    v_mfma_f32_16x16x32_bf16 v[112:115], a[140:143], v[44:47], v[112:115]
    buffer_load_dword v2, v17, s[12:15], s41 offen offset:512 sc1
    ds_read_b128 a[184:187], v11 offset:47104
    v_mfma_f32_16x16x32_bf16 v[116:119], a[144:147], v[44:47], v[116:119]
    ds_read_b128 a[188:191], v11 offset:48128
    ds_read_b128 a[192:195], v11 offset:49152
    v_mfma_f32_16x16x32_bf16 v[120:123], a[148:151], v[44:47], v[120:123]
    s_waitcnt vmcnt(10) lgkmcnt(7)
    buffer_load_dwordx4 v[136:139], v10, s[12:15], s97 offen offset:2048 sc1
    ds_read_b128 a[196:199], v11 offset:50176
    v_mfma_f32_16x16x32_bf16 v[104:107], a[152:155], v[48:51], v[104:107]
    s_waitcnt vmcnt(39)
    ds_read_b128 a[200:203], v19 offset:16384
    v_mfma_f32_16x16x32_bf16 v[108:111], a[156:159], v[48:51], v[108:111]
    ds_read_b128 a[204:207], v19 offset:17408
    v_mfma_f32_16x16x32_bf16 v[112:115], a[160:163], v[48:51], v[112:115]
    ds_read_b128 a[208:211], v19 offset:18432
    v_mfma_f32_16x16x32_bf16 v[116:119], a[164:167], v[48:51], v[116:119]
    s_waitcnt lgkmcnt(7)
    buffer_load_dwordx4 v[140:143], v10, s[12:15], s97 offen offset:3072 sc1
    ds_read_b128 a[212:215], v19 offset:19456
    v_mfma_f32_16x16x32_bf16 v[120:123], a[168:171], v[48:51], v[120:123]
    s_waitcnt vmcnt(11)
    ds_read_b128 a[216:219], v19 offset:20480
    v_mfma_f32_16x16x32_bf16 v[104:107], a[172:175], v[52:55], v[104:107]
    s_add_u32 s97, s97, 4096
    ds_read_b128 a[220:223], v19 offset:21504
    v_mfma_f32_16x16x32_bf16 v[108:111], a[176:179], v[52:55], v[108:111]
    ds_read_b128 a[224:227], v19 offset:22528
    v_mfma_f32_16x16x32_bf16 v[112:115], a[180:183], v[52:55], v[112:115]
    s_waitcnt lgkmcnt(7)
    buffer_load_dwordx4 v[144:147], v10, s[12:15], s97 offen offset:0 sc1
    ds_read_b128 a[228:231], v19 offset:23552
    v_mfma_f32_16x16x32_bf16 v[116:119], a[184:187], v[52:55], v[116:119]
    ds_read_b128 a[232:235], v19 offset:24576
    v_mfma_f32_16x16x32_bf16 v[120:123], a[188:191], v[52:55], v[120:123]
    s_waitcnt vmcnt(11)
    ds_read_b128 a[236:239], v19 offset:25600
    v_mfma_f32_16x16x32_bf16 v[104:107], a[192:195], v[80:83], v[104:107]
    v_lshlrev_b32 v56, 16, v246
    v_and_b32 v57, 0xffff0000, v246
    v_mfma_f32_16x16x32_bf16 v[108:111], a[196:199], v[80:83], v[108:111]
    s_waitcnt lgkmcnt(6)
    buffer_load_dwordx4 v[148:151], v10, s[12:15], s97 offen offset:1024 sc1
    v_lshlrev_b32 v58, 16, v247
    v_mfma_f32_16x16x32_bf16 v[112:115], a[200:203], v[80:83], v[112:115]
    v_and_b32 v59, 0xffff0000, v247
    v_lshlrev_b32 v60, 16, v248
    v_mfma_f32_16x16x32_bf16 v[116:119], a[204:207], v[80:83], v[116:119]
    v_and_b32 v61, 0xffff0000, v248
    v_lshlrev_b32 v62, 16, v249
    v_mfma_f32_16x16x32_bf16 v[120:123], a[208:211], v[80:83], v[120:123]
    s_waitcnt vmcnt(11)
    v_and_b32 v63, 0xffff0000, v249
    v_lshlrev_b32 v64, 16, v250
    v_mfma_f32_16x16x32_bf16 v[104:107], a[212:215], v[84:87], v[104:107]
    s_waitcnt lgkmcnt(2)
    buffer_load_dwordx4 v[152:155], v10, s[12:15], s97 offen offset:2048 sc1
    v_and_b32 v65, 0xffff0000, v250
    v_mfma_f32_16x16x32_bf16 v[108:111], a[216:219], v[84:87], v[108:111]
    v_lshlrev_b32 v66, 16, v251
    v_and_b32 v67, 0xffff0000, v251
    v_mfma_f32_16x16x32_bf16 v[112:115], a[220:223], v[84:87], v[112:115]
    v_lshlrev_b32 v68, 16, v252
    v_and_b32 v69, 0xffff0000, v252
    v_mfma_f32_16x16x32_bf16 v[116:119], a[224:227], v[84:87], v[116:119]
    v_lshlrev_b32 v70, 16, v253
    v_and_b32 v71, 0xffff0000, v253
    v_mfma_f32_16x16x32_bf16 v[120:123], a[228:231], v[84:87], v[120:123]
    s_waitcnt vmcnt(11) lgkmcnt(0)
    buffer_load_dwordx4 v[156:159], v10, s[12:15], s97 offen offset:3072 sc1
    v_lshlrev_b32 v72, 16, v254
    v_mfma_f32_16x16x32_bf16 v[104:107], a[232:235], v[88:91], v[104:107]
    s_add_u32 s97, s97, 4096
    v_and_b32 v73, 0xffff0000, v254
    v_lshlrev_b32 v74, 16, v255
    v_mfma_f32_16x16x32_bf16 v[108:111], a[236:239], v[88:91], v[108:111]
    s_waitcnt vmcnt(12)
    v_and_b32 v75, 0xffff0000, v255
    v_mfma_f32_16x16x32_bf16 v[112:115], a[0:3], v[88:91], v[112:115]
    v_mfma_f32_16x16x32_bf16 v[116:119], a[4:7], v[88:91], v[116:119]
    buffer_load_dwordx4 v[160:163], v10, s[12:15], s97 offen offset:0 sc1
    v_mfma_f32_16x16x32_bf16 v[120:123], a[8:11], v[88:91], v[120:123]
    s_waitcnt vmcnt(12)
    ds_write_b128 v6, v[56:59] offset:0
    v_mfma_f32_16x16x32_bf16 v[104:107], a[12:15], v[92:95], v[104:107]
    v_mfma_f32_16x16x32_bf16 v[108:111], a[16:19], v[92:95], v[108:111]
    ds_write_b128 v6, v[60:63] offset:1024
    v_mfma_f32_16x16x32_bf16 v[112:115], a[20:23], v[92:95], v[112:115]
    buffer_load_dwordx4 v[164:167], v10, s[12:15], s97 offen offset:1024 sc1
    v_mfma_f32_16x16x32_bf16 v[116:119], a[24:27], v[92:95], v[116:119]
    ds_write_b128 v6, v[64:67] offset:2048
    v_mfma_f32_16x16x32_bf16 v[120:123], a[28:31], v[92:95], v[120:123]
    s_waitcnt vmcnt(12)
    v_mfma_f32_16x16x32_bf16 v[104:107], a[32:35], v[96:99], v[104:107]
    ds_write_b128 v6, v[68:71] offset:3072
    v_mfma_f32_16x16x32_bf16 v[108:111], a[36:39], v[96:99], v[108:111]
    buffer_load_dwordx4 v[168:171], v10, s[12:15], s97 offen offset:2048 sc1
    v_mfma_f32_16x16x32_bf16 v[112:115], a[40:43], v[96:99], v[112:115]
    ds_write_b128 v6, v[72:75] offset:4096
    v_mfma_f32_16x16x32_bf16 v[116:119], a[44:47], v[96:99], v[116:119]
    v_mfma_f32_16x16x32_bf16 v[120:123], a[48:51], v[96:99], v[120:123]
    s_waitcnt vmcnt(12)
    v_mfma_f32_16x16x32_bf16 v[104:107], a[52:55], v[100:103], v[104:107]
    buffer_load_dwordx4 v[172:175], v10, s[12:15], s97 offen offset:3072 sc1
    v_mfma_f32_16x16x32_bf16 v[108:111], a[56:59], v[100:103], v[108:111]
    s_add_u32 s97, s97, 90112
    v_mfma_f32_16x16x32_bf16 v[112:115], a[60:63], v[100:103], v[112:115]
    v_mfma_f32_16x16x32_bf16 v[116:119], a[64:67], v[100:103], v[116:119]
    s_waitcnt lgkmcnt(0)
    v_mfma_f32_16x16x32_bf16 v[120:123], a[68:71], v[100:103], v[120:123]
    s_waitcnt vmcnt(10)
    v_readfirstlane_b32 s57, v2
    s_nop 1
    s_cmp_ge_u32 s57, 64
    s_cbranch_scc0 fs_52
fb_53:
    s_waitcnt vmcnt(12)
    v_mfma_f32_16x16x32_bf16 v[56:59], v[196:199], v[128:131], 0
    buffer_load_dwordx4 v[32:35], v10, s[12:15], s97 offen offset:0 sc1
    v_mfma_f32_16x16x32_bf16 v[60:63], v[200:203], v[128:131], 0
    v_mfma_f32_16x16x32_bf16 v[64:67], v[204:207], v[128:131], 0
    v_mfma_f32_16x16x32_bf16 v[68:71], v[208:211], v[128:131], 0
    ds_write_b128 v16, v[104:107] offset:0
    v_mfma_f32_16x16x32_bf16 v[72:75], v[212:215], v[128:131], 0
    s_waitcnt vmcnt(12)
    v_mfma_f32_16x16x32_bf16 v[56:59], v[216:219], v[132:135], v[56:59]
    buffer_load_dwordx4 v[36:39], v10, s[12:15], s97 offen offset:1024 sc1
    ds_write_b128 v16, v[108:111] offset:1024
    v_mfma_f32_16x16x32_bf16 v[60:63], v[220:223], v[132:135], v[60:63]
    v_mfma_f32_16x16x32_bf16 v[64:67], v[224:227], v[132:135], v[64:67]
    ds_write_b128 v16, v[112:115] offset:2048
    v_mfma_f32_16x16x32_bf16 v[68:71], v[228:231], v[132:135], v[68:71]
    v_mfma_f32_16x16x32_bf16 v[72:75], v[232:235], v[132:135], v[72:75]
    s_waitcnt vmcnt(11)
    ds_write_b128 v16, v[116:119] offset:3072
    v_mfma_f32_16x16x32_bf16 v[56:59], v[236:239], v[136:139], v[56:59]
    buffer_load_dwordx4 v[40:43], v10, s[12:15], s97 offen offset:2048 sc1
    v_mfma_f32_16x16x32_bf16 v[60:63], v[240:243], v[136:139], v[60:63]
    ds_write_b128 v16, v[120:123] offset:4096
    v_mfma_f32_16x16x32_bf16 v[64:67], a[120:123], v[136:139], v[64:67]
    v_mfma_f32_16x16x32_bf16 v[68:71], a[124:127], v[136:139], v[68:71]
    v_mfma_f32_16x16x32_bf16 v[72:75], a[128:131], v[136:139], v[72:75]
    s_waitcnt vmcnt(11)
    v_mfma_f32_16x16x32_bf16 v[56:59], a[132:135], v[140:143], v[56:59]
    buffer_load_dwordx4 v[44:47], v10, s[12:15], s97 offen offset:3072 sc1
    v_mfma_f32_16x16x32_bf16 v[60:63], a[136:139], v[140:143], v[60:63]
    s_add_u32 s97, s97, 4096
    buffer_load_dword v3, v17, s[12:15], s41 offen offset:768 sc1
    v_mfma_f32_16x16x32_bf16 v[64:67], a[140:143], v[140:143], v[64:67]
    v_mfma_f32_16x16x32_bf16 v[68:71], a[144:147], v[140:143], v[68:71]
    s_waitcnt lgkmcnt(0)
    s_barrier
    v_mfma_f32_16x16x32_bf16 v[72:75], a[148:151], v[140:143], v[72:75]
    s_waitcnt vmcnt(12)
    ds_read_b128 v[20:23], v4 offset:0
    v_mfma_f32_16x16x32_bf16 v[56:59], a[152:155], v[144:147], v[56:59]
    buffer_load_dwordx4 v[48:51], v10, s[12:15], s97 offen offset:0 sc1
    ds_read_b128 v[24:27], v5 offset:0
    v_mfma_f32_16x16x32_bf16 v[60:63], a[156:159], v[144:147], v[60:63]
    ds_read_b128 v[104:107], v13 offset:0
    v_mfma_f32_16x16x32_bf16 v[64:67], a[160:163], v[144:147], v[64:67]
    ds_read_b128 v[108:111], v14 offset:0
    v_mfma_f32_16x16x32_bf16 v[68:71], a[164:167], v[144:147], v[68:71]
    ds_read_b128 v[176:179], v13 offset:5120
    v_mfma_f32_16x16x32_bf16 v[72:75], a[168:171], v[144:147], v[72:75]
    s_waitcnt vmcnt(12)
    ds_read_b128 v[180:183], v14 offset:5120
    v_mfma_f32_16x16x32_bf16 v[56:59], a[172:175], v[148:151], v[56:59]
    buffer_load_dwordx4 v[52:55], v10, s[12:15], s97 offen offset:1024 sc1
    ds_read_b128 v[184:187], v13 offset:10240
    v_mfma_f32_16x16x32_bf16 v[60:63], a[176:179], v[148:151], v[60:63]
    ds_read_b128 v[188:191], v14 offset:10240
    v_mfma_f32_16x16x32_bf16 v[64:67], a[180:183], v[148:151], v[64:67]
    ds_read_b128 v[124:127], v13 offset:15360
    v_mfma_f32_16x16x32_bf16 v[68:71], a[184:187], v[148:151], v[68:71]
    ds_read_b128 v[76:79], v14 offset:15360
    v_mfma_f32_16x16x32_bf16 v[72:75], a[188:191], v[148:151], v[72:75]
    s_waitcnt vmcnt(12)
    v_mfma_f32_16x16x32_bf16 v[56:59], a[192:195], v[152:155], v[56:59]
    buffer_load_dwordx4 v[80:83], v10, s[12:15], s97 offen offset:2048 sc1
    v_mfma_f32_16x16x32_bf16 v[60:63], a[196:199], v[152:155], v[60:63]
    v_mfma_f32_16x16x32_bf16 v[64:67], a[200:203], v[152:155], v[64:67]
    s_waitcnt lgkmcnt(6)
    v_add_f32 v20, v20, v104
    v_add_f32 v21, v21, v105
    v_mfma_f32_16x16x32_bf16 v[68:71], a[204:207], v[152:155], v[68:71]
    v_add_f32 v22, v22, v106
    v_add_f32 v23, v23, v107
    v_mfma_f32_16x16x32_bf16 v[72:75], a[208:211], v[152:155], v[72:75]
    s_waitcnt vmcnt(12)
    v_add_f32 v24, v24, v108
    v_add_f32 v25, v25, v109
    v_mfma_f32_16x16x32_bf16 v[56:59], a[212:215], v[156:159], v[56:59]
    buffer_load_dwordx4 v[84:87], v10, s[12:15], s97 offen offset:3072 sc1
    v_add_f32 v26, v26, v110
    v_mfma_f32_16x16x32_bf16 v[60:63], a[216:219], v[156:159], v[60:63]
    s_add_u32 s97, s97, 4096
    v_add_f32 v27, v27, v111
    v_mfma_f32_16x16x32_bf16 v[64:67], a[220:223], v[156:159], v[64:67]
    s_waitcnt lgkmcnt(4)
    v_add_f32 v20, v20, v176
    v_add_f32 v21, v21, v177
    v_mfma_f32_16x16x32_bf16 v[68:71], a[224:227], v[156:159], v[68:71]
    v_add_f32 v22, v22, v178
    v_add_f32 v23, v23, v179
    v_mfma_f32_16x16x32_bf16 v[72:75], a[228:231], v[156:159], v[72:75]
    s_waitcnt vmcnt(12)
    v_add_f32 v24, v24, v180
    v_add_f32 v25, v25, v181
    v_mfma_f32_16x16x32_bf16 v[56:59], a[232:235], v[160:163], v[56:59]
    buffer_load_dwordx4 v[88:91], v10, s[12:15], s97 offen offset:0 sc1
    v_add_f32 v26, v26, v182
    v_mfma_f32_16x16x32_bf16 v[60:63], a[236:239], v[160:163], v[60:63]
    v_add_f32 v27, v27, v183
    v_mfma_f32_16x16x32_bf16 v[64:67], a[0:3], v[160:163], v[64:67]
    s_waitcnt lgkmcnt(2)
    v_add_f32 v20, v20, v184
    v_add_f32 v21, v21, v185
    v_mfma_f32_16x16x32_bf16 v[68:71], a[4:7], v[160:163], v[68:71]
    v_add_f32 v22, v22, v186
    v_add_f32 v23, v23, v187
    v_mfma_f32_16x16x32_bf16 v[72:75], a[8:11], v[160:163], v[72:75]
    s_waitcnt vmcnt(12)
    v_add_f32 v24, v24, v188
    v_add_f32 v25, v25, v189
    v_mfma_f32_16x16x32_bf16 v[56:59], a[12:15], v[164:167], v[56:59]
    buffer_load_dwordx4 v[92:95], v10, s[12:15], s97 offen offset:1024 sc1
    v_add_f32 v26, v26, v190
    v_mfma_f32_16x16x32_bf16 v[60:63], a[16:19], v[164:167], v[60:63]
    v_add_f32 v27, v27, v191
    v_mfma_f32_16x16x32_bf16 v[64:67], a[20:23], v[164:167], v[64:67]
    s_waitcnt lgkmcnt(0)
    v_add_f32 v20, v20, v124
    v_add_f32 v21, v21, v125
    v_mfma_f32_16x16x32_bf16 v[68:71], a[24:27], v[164:167], v[68:71]
    v_add_f32 v22, v22, v126
    v_add_f32 v23, v23, v127
    v_mfma_f32_16x16x32_bf16 v[72:75], a[28:31], v[164:167], v[72:75]
    s_waitcnt vmcnt(12)
    v_add_f32 v24, v24, v76
    v_add_f32 v25, v25, v77
    v_mfma_f32_16x16x32_bf16 v[56:59], a[32:35], v[168:171], v[56:59]
    buffer_load_dwordx4 v[96:99], v10, s[12:15], s97 offen offset:2048 sc1
    v_add_f32 v26, v26, v78
    v_mfma_f32_16x16x32_bf16 v[60:63], a[36:39], v[168:171], v[60:63]
    v_add_f32 v27, v27, v79
    v_cvt_pk_bf16_f32 v28, v20, v21
    v_mfma_f32_16x16x32_bf16 v[64:67], a[40:43], v[168:171], v[64:67]
    v_cvt_pk_bf16_f32 v29, v22, v23
    v_cvt_pk_bf16_f32 v30, v24, v25
    v_mfma_f32_16x16x32_bf16 v[68:71], a[44:47], v[168:171], v[68:71]
    v_cvt_pk_bf16_f32 v31, v26, v27
    buffer_store_dwordx4 v[28:31], v15, s[20:23], s99 offen
    v_mfma_f32_16x16x32_bf16 v[72:75], a[48:51], v[168:171], v[72:75]
    s_waitcnt vmcnt(13)
    v_mfma_f32_16x16x32_bf16 v[56:59], a[52:55], v[172:175], v[56:59]
    s_add_u32 s99, s99, 40960
    buffer_load_dwordx4 v[100:103], v10, s[12:15], s97 offen offset:3072 sc1
    v_mfma_f32_16x16x32_bf16 v[60:63], a[56:59], v[172:175], v[60:63]
    s_add_u32 s97, s97, 90112
    v_mfma_f32_16x16x32_bf16 v[64:67], a[60:63], v[172:175], v[64:67]
    v_mfma_f32_16x16x32_bf16 v[68:71], a[64:67], v[172:175], v[68:71]
    v_mfma_f32_16x16x32_bf16 v[72:75], a[68:71], v[172:175], v[72:75]
    s_waitcnt vmcnt(13)
    v_mfma_f32_16x16x32_bf16 v[104:107], v[196:199], v[32:35], 0
    v_mfma_f32_16x16x32_bf16 v[108:111], v[200:203], v[32:35], 0
    v_mfma_f32_16x16x32_bf16 v[112:115], v[204:207], v[32:35], 0
    v_mfma_f32_16x16x32_bf16 v[116:119], v[208:211], v[32:35], 0
    ds_write_b128 v16, v[56:59] offset:20480
    v_mfma_f32_16x16x32_bf16 v[120:123], v[212:215], v[32:35], 0
    s_waitcnt vmcnt(12)
    v_mfma_f32_16x16x32_bf16 v[104:107], v[216:219], v[36:39], v[104:107]
    ds_write_b128 v16, v[60:63] offset:21504
    v_mfma_f32_16x16x32_bf16 v[108:111], v[220:223], v[36:39], v[108:111]
    v_mfma_f32_16x16x32_bf16 v[112:115], v[224:227], v[36:39], v[112:115]
    ds_write_b128 v16, v[64:67] offset:22528
    v_mfma_f32_16x16x32_bf16 v[116:119], v[228:231], v[36:39], v[116:119]
    s_waitcnt vmcnt(9)
    v_readfirstlane_b32 s57, v3
    s_nop 1
    s_cmp_ge_u32 s57, 64
    s_cbranch_scc0 fs_54
fb_55:
    v_mfma_f32_16x16x32_bf16 v[120:123], v[232:235], v[36:39], v[120:123]
    s_waitcnt vmcnt(11)
    buffer_load_dwordx4 v[128:131], v10, s[12:15], s97 offen offset:0 sc1
    ds_write_b128 v16, v[68:71] offset:23552
    v_mfma_f32_16x16x32_bf16 v[104:107], v[236:239], v[40:43], v[104:107]
    v_mfma_f32_16x16x32_bf16 v[108:111], v[240:243], v[40:43], v[108:111]
    ds_write_b128 v16, v[72:75] offset:24576
    v_mfma_f32_16x16x32_bf16 v[112:115], a[120:123], v[40:43], v[112:115]
    v_mfma_f32_16x16x32_bf16 v[116:119], a[124:127], v[40:43], v[116:119]
    buffer_load_dwordx4 v[132:135], v10, s[12:15], s97 offen offset:1024 sc1
    v_mfma_f32_16x16x32_bf16 v[120:123], a[128:131], v[40:43], v[120:123]
    s_waitcnt vmcnt(12)
    v_mfma_f32_16x16x32_bf16 v[104:107], a[132:135], v[44:47], v[104:107]
    v_mfma_f32_16x16x32_bf16 v[108:111], a[136:139], v[44:47], v[108:111]
    v_mfma_f32_16x16x32_bf16 v[112:115], a[140:143], v[44:47], v[112:115]
    buffer_load_dwordx4 v[136:139], v10, s[12:15], s97 offen offset:2048 sc1
    v_mfma_f32_16x16x32_bf16 v[116:119], a[144:147], v[44:47], v[116:119]
    s_waitcnt lgkmcnt(0)
    s_barrier
    v_mfma_f32_16x16x32_bf16 v[120:123], a[148:151], v[44:47], v[120:123]
    s_waitcnt vmcnt(11)
    ds_read_b128 v[20:23], v4 offset:10240
    v_mfma_f32_16x16x32_bf16 v[104:107], a[152:155], v[48:51], v[104:107]
    ds_read_b128 v[24:27], v5 offset:10240
    v_mfma_f32_16x16x32_bf16 v[108:111], a[156:159], v[48:51], v[108:111]
    buffer_load_dwordx4 v[140:143], v10, s[12:15], s97 offen offset:3072 sc1
    ds_read_b128 v[56:59], v13 offset:20480
    v_mfma_f32_16x16x32_bf16 v[112:115], a[160:163], v[48:51], v[112:115]
    s_add_u32 s97, s97, 4096
    ds_read_b128 v[60:63], v14 offset:20480
    v_mfma_f32_16x16x32_bf16 v[116:119], a[164:167], v[48:51], v[116:119]
    ds_read_b128 v[176:179], v13 offset:25600
    v_mfma_f32_16x16x32_bf16 v[120:123], a[168:171], v[48:51], v[120:123]
    s_waitcnt vmcnt(11)
    ds_read_b128 v[180:183], v14 offset:25600
    v_mfma_f32_16x16x32_bf16 v[104:107], a[172:175], v[52:55], v[104:107]
    buffer_load_dwordx4 v[144:147], v10, s[12:15], s97 offen offset:0 sc1
    ds_read_b128 v[184:187], v13 offset:30720
    v_mfma_f32_16x16x32_bf16 v[108:111], a[176:179], v[52:55], v[108:111]
    ds_read_b128 v[188:191], v14 offset:30720
    v_mfma_f32_16x16x32_bf16 v[112:115], a[180:183], v[52:55], v[112:115]
    ds_read_b128 v[124:127], v13 offset:35840
    v_mfma_f32_16x16x32_bf16 v[116:119], a[184:187], v[52:55], v[116:119]
    ds_read_b128 v[76:79], v14 offset:35840
    v_mfma_f32_16x16x32_bf16 v[120:123], a[188:191], v[52:55], v[120:123]
    s_waitcnt vmcnt(11)
    buffer_load_dwordx4 v[148:151], v10, s[12:15], s97 offen offset:1024 sc1
    v_mfma_f32_16x16x32_bf16 v[104:107], a[192:195], v[80:83], v[104:107]
    v_mfma_f32_16x16x32_bf16 v[108:111], a[196:199], v[80:83], v[108:111]
    v_mfma_f32_16x16x32_bf16 v[112:115], a[200:203], v[80:83], v[112:115]
    s_waitcnt lgkmcnt(6)
    v_add_f32 v20, v20, v56
    v_add_f32 v21, v21, v57
    v_mfma_f32_16x16x32_bf16 v[116:119], a[204:207], v[80:83], v[116:119]
    buffer_load_dwordx4 v[152:155], v10, s[12:15], s97 offen offset:2048 sc1
    v_add_f32 v22, v22, v58
    v_mfma_f32_16x16x32_bf16 v[120:123], a[208:211], v[80:83], v[120:123]
    s_waitcnt vmcnt(12)
    v_add_f32 v23, v23, v59
    v_add_f32 v24, v24, v60
    v_mfma_f32_16x16x32_bf16 v[104:107], a[212:215], v[84:87], v[104:107]
    v_add_f32 v25, v25, v61
    v_add_f32 v26, v26, v62
    v_mfma_f32_16x16x32_bf16 v[108:111], a[216:219], v[84:87], v[108:111]
    v_add_f32 v27, v27, v63
    v_mfma_f32_16x16x32_bf16 v[112:115], a[220:223], v[84:87], v[112:115]
    s_waitcnt lgkmcnt(4)
    buffer_load_dwordx4 v[156:159], v10, s[12:15], s97 offen offset:3072 sc1
    v_add_f32 v20, v20, v176
    v_mfma_f32_16x16x32_bf16 v[116:119], a[224:227], v[84:87], v[116:119]
    s_add_u32 s97, s97, 4096
    v_add_f32 v21, v21, v177
    v_add_f32 v22, v22, v178
    v_mfma_f32_16x16x32_bf16 v[120:123], a[228:231], v[84:87], v[120:123]
    s_waitcnt vmcnt(12)
    v_add_f32 v23, v23, v179
    v_add_f32 v24, v24, v180
    v_mfma_f32_16x16x32_bf16 v[104:107], a[232:235], v[88:91], v[104:107]
    v_add_f32 v25, v25, v181
    v_add_f32 v26, v26, v182
    v_mfma_f32_16x16x32_bf16 v[108:111], a[236:239], v[88:91], v[108:111]
    buffer_load_dwordx4 v[160:163], v10, s[12:15], s97 offen offset:0 sc1
    v_add_f32 v27, v27, v183
    v_mfma_f32_16x16x32_bf16 v[112:115], a[0:3], v[88:91], v[112:115]
    s_waitcnt lgkmcnt(2)
    v_add_f32 v20, v20, v184
    v_add_f32 v21, v21, v185
    v_mfma_f32_16x16x32_bf16 v[116:119], a[4:7], v[88:91], v[116:119]
    v_add_f32 v22, v22, v186
    v_add_f32 v23, v23, v187
    v_mfma_f32_16x16x32_bf16 v[120:123], a[8:11], v[88:91], v[120:123]
    s_waitcnt vmcnt(12)
    v_add_f32 v24, v24, v188
    v_add_f32 v25, v25, v189
    v_mfma_f32_16x16x32_bf16 v[104:107], a[12:15], v[92:95], v[104:107]
    buffer_load_dwordx4 v[164:167], v10, s[12:15], s97 offen offset:1024 sc1
    v_add_f32 v26, v26, v190
    v_mfma_f32_16x16x32_bf16 v[108:111], a[16:19], v[92:95], v[108:111]
    v_add_f32 v27, v27, v191
    v_mfma_f32_16x16x32_bf16 v[112:115], a[20:23], v[92:95], v[112:115]
    s_waitcnt lgkmcnt(0)
    v_add_f32 v20, v20, v124
    v_add_f32 v21, v21, v125
    v_mfma_f32_16x16x32_bf16 v[116:119], a[24:27], v[92:95], v[116:119]
    v_add_f32 v22, v22, v126
    v_add_f32 v23, v23, v127
    v_mfma_f32_16x16x32_bf16 v[120:123], a[28:31], v[92:95], v[120:123]
    s_waitcnt vmcnt(12)
    buffer_load_dwordx4 v[168:171], v10, s[12:15], s97 offen offset:2048 sc1
    v_add_f32 v24, v24, v76
    v_mfma_f32_16x16x32_bf16 v[104:107], a[32:35], v[96:99], v[104:107]
    v_add_f32 v25, v25, v77
    v_add_f32 v26, v26, v78
    v_mfma_f32_16x16x32_bf16 v[108:111], a[36:39], v[96:99], v[108:111]
    v_add_f32 v27, v27, v79
    v_cvt_pk_bf16_f32 v28, v20, v21
    v_mfma_f32_16x16x32_bf16 v[112:115], a[40:43], v[96:99], v[112:115]
    v_cvt_pk_bf16_f32 v29, v22, v23
    v_cvt_pk_bf16_f32 v30, v24, v25
    v_mfma_f32_16x16x32_bf16 v[116:119], a[44:47], v[96:99], v[116:119]
    buffer_load_dwordx4 v[172:175], v10, s[12:15], s97 offen offset:3072 sc1
    v_cvt_pk_bf16_f32 v31, v26, v27
    v_mfma_f32_16x16x32_bf16 v[120:123], a[48:51], v[96:99], v[120:123]
    s_waitcnt vmcnt(12)
    buffer_store_dwordx4 v[28:31], v15, s[20:23], s99 offen
    v_mfma_f32_16x16x32_bf16 v[104:107], a[52:55], v[100:103], v[104:107]
    s_add_u32 s97, s97, 90112
    v_mfma_f32_16x16x32_bf16 v[108:111], a[56:59], v[100:103], v[108:111]
    s_add_u32 s99, s99, 40960
    v_mfma_f32_16x16x32_bf16 v[112:115], a[60:63], v[100:103], v[112:115]
    v_mfma_f32_16x16x32_bf16 v[116:119], a[64:67], v[100:103], v[116:119]
    v_mfma_f32_16x16x32_bf16 v[120:123], a[68:71], v[100:103], v[120:123]
    s_waitcnt vmcnt(12)
    v_mfma_f32_16x16x32_bf16 v[56:59], v[196:199], v[128:131], 0
    v_mfma_f32_16x16x32_bf16 v[60:63], v[200:203], v[128:131], 0
    v_mfma_f32_16x16x32_bf16 v[64:67], v[204:207], v[128:131], 0
    v_mfma_f32_16x16x32_bf16 v[68:71], v[208:211], v[128:131], 0
    ds_write_b128 v16, v[104:107] offset:0
    v_mfma_f32_16x16x32_bf16 v[72:75], v[212:215], v[128:131], 0
    s_waitcnt vmcnt(11)
    v_mfma_f32_16x16x32_bf16 v[56:59], v[216:219], v[132:135], v[56:59]
    ds_write_b128 v16, v[108:111] offset:1024
    v_mfma_f32_16x16x32_bf16 v[60:63], v[220:223], v[132:135], v[60:63]
    v_mfma_f32_16x16x32_bf16 v[64:67], v[224:227], v[132:135], v[64:67]
    ds_write_b128 v16, v[112:115] offset:2048
    v_mfma_f32_16x16x32_bf16 v[68:71], v[228:231], v[132:135], v[68:71]
    v_mfma_f32_16x16x32_bf16 v[72:75], v[232:235], v[132:135], v[72:75]
    s_waitcnt vmcnt(10)
    ds_write_b128 v16, v[116:119] offset:3072
    v_mfma_f32_16x16x32_bf16 v[56:59], v[236:239], v[136:139], v[56:59]
    v_mfma_f32_16x16x32_bf16 v[60:63], v[240:243], v[136:139], v[60:63]
    ds_write_b128 v16, v[120:123] offset:4096
    v_mfma_f32_16x16x32_bf16 v[64:67], a[120:123], v[136:139], v[64:67]
    v_mfma_f32_16x16x32_bf16 v[68:71], a[124:127], v[136:139], v[68:71]
    v_mfma_f32_16x16x32_bf16 v[72:75], a[128:131], v[136:139], v[72:75]
    s_waitcnt vmcnt(9)
    v_mfma_f32_16x16x32_bf16 v[56:59], a[132:135], v[140:143], v[56:59]
    v_mfma_f32_16x16x32_bf16 v[60:63], a[136:139], v[140:143], v[60:63]
    v_mfma_f32_16x16x32_bf16 v[64:67], a[140:143], v[140:143], v[64:67]
    v_mfma_f32_16x16x32_bf16 v[68:71], a[144:147], v[140:143], v[68:71]
    s_waitcnt lgkmcnt(0)
    s_barrier
    v_mfma_f32_16x16x32_bf16 v[72:75], a[148:151], v[140:143], v[72:75]
    s_waitcnt vmcnt(8)
    ds_read_b128 v[20:23], v4 offset:20480
    v_mfma_f32_16x16x32_bf16 v[56:59], a[152:155], v[144:147], v[56:59]
    ds_read_b128 v[24:27], v5 offset:20480
    v_mfma_f32_16x16x32_bf16 v[60:63], a[156:159], v[144:147], v[60:63]
    ds_read_b128 v[104:107], v13 offset:0
    v_mfma_f32_16x16x32_bf16 v[64:67], a[160:163], v[144:147], v[64:67]
    ds_read_b128 v[108:111], v14 offset:0
    v_mfma_f32_16x16x32_bf16 v[68:71], a[164:167], v[144:147], v[68:71]
    ds_read_b128 v[176:179], v13 offset:5120
    v_mfma_f32_16x16x32_bf16 v[72:75], a[168:171], v[144:147], v[72:75]
    s_waitcnt vmcnt(7)
    ds_read_b128 v[180:183], v14 offset:5120
    v_mfma_f32_16x16x32_bf16 v[56:59], a[172:175], v[148:151], v[56:59]
    ds_read_b128 v[184:187], v13 offset:10240
    v_mfma_f32_16x16x32_bf16 v[60:63], a[176:179], v[148:151], v[60:63]
    ds_read_b128 v[188:191], v14 offset:10240
    v_mfma_f32_16x16x32_bf16 v[64:67], a[180:183], v[148:151], v[64:67]
    ds_read_b128 v[124:127], v13 offset:15360
    v_mfma_f32_16x16x32_bf16 v[68:71], a[184:187], v[148:151], v[68:71]
    ds_read_b128 v[76:79], v14 offset:15360
    v_mfma_f32_16x16x32_bf16 v[72:75], a[188:191], v[148:151], v[72:75]
    s_waitcnt vmcnt(6)
    v_mfma_f32_16x16x32_bf16 v[56:59], a[192:195], v[152:155], v[56:59]
    v_mfma_f32_16x16x32_bf16 v[60:63], a[196:199], v[152:155], v[60:63]
    v_mfma_f32_16x16x32_bf16 v[64:67], a[200:203], v[152:155], v[64:67]
    s_waitcnt lgkmcnt(6)
    v_add_f32 v20, v20, v104
    v_add_f32 v21, v21, v105
    v_mfma_f32_16x16x32_bf16 v[68:71], a[204:207], v[152:155], v[68:71]
    v_add_f32 v22, v22, v106
    v_add_f32 v23, v23, v107
    v_mfma_f32_16x16x32_bf16 v[72:75], a[208:211], v[152:155], v[72:75]
    s_waitcnt vmcnt(5)
    v_add_f32 v24, v24, v108
    v_add_f32 v25, v25, v109
    v_mfma_f32_16x16x32_bf16 v[56:59], a[212:215], v[156:159], v[56:59]
    v_add_f32 v26, v26, v110
    v_add_f32 v27, v27, v111
    v_mfma_f32_16x16x32_bf16 v[60:63], a[216:219], v[156:159], v[60:63]
    s_waitcnt lgkmcnt(4)
    v_add_f32 v20, v20, v176
    v_add_f32 v21, v21, v177
    v_mfma_f32_16x16x32_bf16 v[64:67], a[220:223], v[156:159], v[64:67]
    v_add_f32 v22, v22, v178
    v_add_f32 v23, v23, v179
    v_mfma_f32_16x16x32_bf16 v[68:71], a[224:227], v[156:159], v[68:71]
    v_add_f32 v24, v24, v180
    v_add_f32 v25, v25, v181
    v_mfma_f32_16x16x32_bf16 v[72:75], a[228:231], v[156:159], v[72:75]
    s_waitcnt vmcnt(4)
    v_add_f32 v26, v26, v182
    v_add_f32 v27, v27, v183
    v_mfma_f32_16x16x32_bf16 v[56:59], a[232:235], v[160:163], v[56:59]
    s_waitcnt lgkmcnt(2)
    v_add_f32 v20, v20, v184
    v_add_f32 v21, v21, v185
    v_mfma_f32_16x16x32_bf16 v[60:63], a[236:239], v[160:163], v[60:63]
    v_add_f32 v22, v22, v186
    v_add_f32 v23, v23, v187
    v_mfma_f32_16x16x32_bf16 v[64:67], a[0:3], v[160:163], v[64:67]
    v_add_f32 v24, v24, v188
    v_add_f32 v25, v25, v189
    v_mfma_f32_16x16x32_bf16 v[68:71], a[4:7], v[160:163], v[68:71]
    v_add_f32 v26, v26, v190
    v_add_f32 v27, v27, v191
    v_mfma_f32_16x16x32_bf16 v[72:75], a[8:11], v[160:163], v[72:75]
    s_waitcnt vmcnt(3)
    v_mfma_f32_16x16x32_bf16 v[56:59], a[12:15], v[164:167], v[56:59]
    s_waitcnt lgkmcnt(0)
    v_add_f32 v20, v20, v124
    v_add_f32 v21, v21, v125
    v_mfma_f32_16x16x32_bf16 v[60:63], a[16:19], v[164:167], v[60:63]
    v_add_f32 v22, v22, v126
    v_add_f32 v23, v23, v127
    v_mfma_f32_16x16x32_bf16 v[64:67], a[20:23], v[164:167], v[64:67]
    v_add_f32 v24, v24, v76
    v_add_f32 v25, v25, v77
    v_mfma_f32_16x16x32_bf16 v[68:71], a[24:27], v[164:167], v[68:71]
    v_add_f32 v26, v26, v78
    v_add_f32 v27, v27, v79
    v_mfma_f32_16x16x32_bf16 v[72:75], a[28:31], v[164:167], v[72:75]
    s_waitcnt vmcnt(2)
    v_cvt_pk_bf16_f32 v28, v20, v21
    v_cvt_pk_bf16_f32 v29, v22, v23
    v_mfma_f32_16x16x32_bf16 v[56:59], a[32:35], v[168:171], v[56:59]
    v_cvt_pk_bf16_f32 v30, v24, v25
    v_cvt_pk_bf16_f32 v31, v26, v27
    v_mfma_f32_16x16x32_bf16 v[60:63], a[36:39], v[168:171], v[60:63]
    buffer_store_dwordx4 v[28:31], v15, s[20:23], s99 offen
    v_mfma_f32_16x16x32_bf16 v[64:67], a[40:43], v[168:171], v[64:67]
    s_add_u32 s99, s99, 40960
    v_mfma_f32_16x16x32_bf16 v[68:71], a[44:47], v[168:171], v[68:71]
    v_mfma_f32_16x16x32_bf16 v[72:75], a[48:51], v[168:171], v[72:75]
    s_waitcnt vmcnt(2)
    v_mfma_f32_16x16x32_bf16 v[56:59], a[52:55], v[172:175], v[56:59]
    v_mfma_f32_16x16x32_bf16 v[60:63], a[56:59], v[172:175], v[60:63]
    v_mfma_f32_16x16x32_bf16 v[64:67], a[60:63], v[172:175], v[64:67]
    v_mfma_f32_16x16x32_bf16 v[68:71], a[64:67], v[172:175], v[68:71]
    v_mfma_f32_16x16x32_bf16 v[72:75], a[68:71], v[172:175], v[72:75]
    s_nop 3
    ds_write_b128 v16, v[56:59] offset:20480
    ds_write_b128 v16, v[60:63] offset:21504
    ds_write_b128 v16, v[64:67] offset:22528
    ds_write_b128 v16, v[68:71] offset:23552
    ds_write_b128 v16, v[72:75] offset:24576
    s_waitcnt lgkmcnt(0)
    s_barrier
    ds_read_b128 v[20:23], v4 offset:30720
    ds_read_b128 v[24:27], v5 offset:30720
    ds_read_b128 v[56:59], v13 offset:20480
    ds_read_b128 v[60:63], v14 offset:20480
    ds_read_b128 v[176:179], v13 offset:25600
    ds_read_b128 v[180:183], v14 offset:25600
    ds_read_b128 v[184:187], v13 offset:30720
    ds_read_b128 v[188:191], v14 offset:30720
    ds_read_b128 v[124:127], v13 offset:35840
    ds_read_b128 v[76:79], v14 offset:35840
    s_waitcnt lgkmcnt(6)
    v_pk_add_f32 v[20:21], v[20:21], v[56:57]
    v_pk_add_f32 v[22:23], v[22:23], v[58:59]
    v_pk_add_f32 v[24:25], v[24:25], v[60:61]
    v_pk_add_f32 v[26:27], v[26:27], v[62:63]
    s_waitcnt lgkmcnt(4)
    v_pk_add_f32 v[20:21], v[20:21], v[176:177]
    v_pk_add_f32 v[22:23], v[22:23], v[178:179]
    v_pk_add_f32 v[24:25], v[24:25], v[180:181]
    v_pk_add_f32 v[26:27], v[26:27], v[182:183]
    s_waitcnt lgkmcnt(2)
    v_pk_add_f32 v[20:21], v[20:21], v[184:185]
    v_pk_add_f32 v[22:23], v[22:23], v[186:187]
    v_pk_add_f32 v[24:25], v[24:25], v[188:189]
    v_pk_add_f32 v[26:27], v[26:27], v[190:191]
    s_waitcnt lgkmcnt(0)
    v_pk_add_f32 v[20:21], v[20:21], v[124:125]
    v_pk_add_f32 v[22:23], v[22:23], v[126:127]
    v_pk_add_f32 v[24:25], v[24:25], v[76:77]
    v_pk_add_f32 v[26:27], v[26:27], v[78:79]
    v_cvt_pk_bf16_f32 v28, v20, v21
    v_cvt_pk_bf16_f32 v29, v22, v23
    v_cvt_pk_bf16_f32 v30, v24, v25
    v_cvt_pk_bf16_f32 v31, v26, v27
    buffer_store_dwordx4 v[28:31], v15, s[20:23], s99 offen
    s_add_u32 s99, s99, 40960
    s_endpgm
slow_6:
    s_mov_b32 s26, 0
    s_branch fast_7
hook_21:
    s_mov_b32 s40, s52
    s_lshr_b32 s57, s40, 3
    s_mul_i32 s58, s57, 52
    s_lshr_b32 s58, s58, 8
    s_mul_i32 s59, s58, 5
    s_sub_u32 s59, s57, s59
    s_mul_i32 s58, s58, 160
    s_lshl_b32 s61, s59, 5
    s_cmp_ge_u32 s59, 2
    s_cselect_b32 s62, 16, 0
    s_add_u32 s61, s61, s62
    s_cmp_eq_u32 s59, 4
    s_cselect_b32 s61, 64, s61
    s_cselect_b32 s62, 64, 0
    s_add_u32 s58, s58, s61
    s_add_u32 s62, s62, 16
    s_and_b32 s57, s42, 1
    s_mul_i32 s62, s62, s57
    s_add_u32 s58, s58, s62
    s_mul_i32 s58, s58, 3072
    s_and_b32 s59, s40, 7
    s_mul_i32 s59, s59, 384
    s_add_u32 s59, s59, s58
    s_cmp_lt_u32 s42, 2
    s_cselect_b32 s24, s34, s36
    s_cselect_b32 s25, s35, s37
    s_and_b32 s25, s25, 0xffff
    s_mov_b32 s26, 1966080
    s_mov_b32 s27, 0x00020000
    s_mul_i32 s61, s42, 6144
    v_add_u32 v2, 0, v1
    v_mul_u32_u24 v3, 0xAAAB, v2
    v_lshrrev_b32 v3, 20, v3
    v_mul_u32_u24 v8, 2688, v3
    v_lshl_add_u32 v3, v2, 4, v8
    s_add_u32 m0, s61, 86016
    s_nop 0
    buffer_load_dwordx4 v3, s[24:27], s59 offen lds
    v_add_u32 v2, 64, v1
    v_mul_u32_u24 v3, 0xAAAB, v2
    v_lshrrev_b32 v3, 20, v3
    v_mul_u32_u24 v8, 2688, v3
    v_lshl_add_u32 v3, v2, 4, v8
    s_add_u32 m0, s61, 87040
    s_nop 0
    buffer_load_dwordx4 v3, s[24:27], s59 offen lds
    v_add_u32 v2, 128, v1
    v_mul_u32_u24 v3, 0xAAAB, v2
    v_lshrrev_b32 v3, 20, v3
    v_mul_u32_u24 v8, 2688, v3
    v_lshl_add_u32 v3, v2, 4, v8
    s_add_u32 m0, s61, 88064
    s_nop 0
    buffer_load_dwordx4 v3, s[24:27], s59 offen lds
    v_add_u32 v2, 192, v1
    v_mul_u32_u24 v3, 0xAAAB, v2
    v_lshrrev_b32 v3, 20, v3
    v_mul_u32_u24 v8, 2688, v3
    v_lshl_add_u32 v3, v2, 4, v8
    s_add_u32 m0, s61, 89088
    s_nop 0
    buffer_load_dwordx4 v3, s[24:27], s59 offen lds
    v_add_u32 v2, 256, v1
    v_mul_u32_u24 v3, 0xAAAB, v2
    v_lshrrev_b32 v3, 20, v3
    v_mul_u32_u24 v8, 2688, v3
    v_lshl_add_u32 v3, v2, 4, v8
    s_add_u32 m0, s61, 90112
    s_nop 0
    buffer_load_dwordx4 v3, s[24:27], s59 offen lds
    v_add_u32 v2, 320, v1
    v_mul_u32_u24 v3, 0xAAAB, v2
    v_lshrrev_b32 v3, 20, v3
    v_mul_u32_u24 v8, 2688, v3
    v_lshl_add_u32 v3, v2, 4, v8
    s_add_u32 m0, s61, 91136
    s_nop 0
    buffer_load_dwordx4 v3, s[24:27], s59 offen lds
    s_add_u32 s101, s52, 128
    s_sub_u32 s41, s52, 0
    s_cmp_lt_u32 s52, 0
    s_cbranch_scc0 h1_58
    s_lshr_b32 s57, s101, 3
    s_mul_i32 s58, s57, 52
    s_lshr_b32 s58, s58, 8
    s_mul_i32 s59, s58, 5
    s_sub_u32 s59, s57, s59
    s_mul_i32 s58, s58, 160
    s_lshl_b32 s61, s59, 5
    s_cmp_ge_u32 s59, 2
    s_cselect_b32 s62, 16, 0
    s_add_u32 s61, s61, s62
    s_cmp_eq_u32 s59, 4
    s_cselect_b32 s61, 64, s61
    s_cselect_b32 s62, 64, 0
    s_add_u32 s58, s58, s61
    s_add_u32 s62, s62, 16
    s_and_b32 s57, s42, 1
    s_mul_i32 s62, s62, s57
    s_add_u32 s58, s58, s62
    s_mul_i32 s58, s58, 3072
    s_and_b32 s59, s101, 7
    s_mul_i32 s59, s59, 384
    s_add_u32 s59, s59, s58
    s_cmp_lt_u32 s42, 2
    s_cselect_b32 s24, s34, s36
    s_cselect_b32 s25, s35, s37
    s_and_b32 s25, s25, 0xffff
    s_mov_b32 s26, 1966080
    s_mov_b32 s27, 0x00020000
    s_mul_i32 s61, s42, 6144
    v_add_u32 v2, 0, v1
    v_mul_u32_u24 v3, 0xAAAB, v2
    v_lshrrev_b32 v3, 20, v3
    v_mul_u32_u24 v8, 2688, v3
    v_lshl_add_u32 v3, v2, 4, v8
    s_add_u32 m0, s61, 110592
    s_nop 0
    buffer_load_dwordx4 v3, s[24:27], s59 offen lds
    v_add_u32 v2, 64, v1
    v_mul_u32_u24 v3, 0xAAAB, v2
    v_lshrrev_b32 v3, 20, v3
    v_mul_u32_u24 v8, 2688, v3
    v_lshl_add_u32 v3, v2, 4, v8
    s_add_u32 m0, s61, 111616
    s_nop 0
    buffer_load_dwordx4 v3, s[24:27], s59 offen lds
    v_add_u32 v2, 128, v1
    v_mul_u32_u24 v3, 0xAAAB, v2
    v_lshrrev_b32 v3, 20, v3
    v_mul_u32_u24 v8, 2688, v3
    v_lshl_add_u32 v3, v2, 4, v8
    s_add_u32 m0, s61, 112640
    s_nop 0
    buffer_load_dwordx4 v3, s[24:27], s59 offen lds
    v_add_u32 v2, 192, v1
    v_mul_u32_u24 v3, 0xAAAB, v2
    v_lshrrev_b32 v3, 20, v3
    v_mul_u32_u24 v8, 2688, v3
    v_lshl_add_u32 v3, v2, 4, v8
    s_add_u32 m0, s61, 113664
    s_nop 0
    buffer_load_dwordx4 v3, s[24:27], s59 offen lds
    v_add_u32 v2, 256, v1
    v_mul_u32_u24 v3, 0xAAAB, v2
    v_lshrrev_b32 v3, 20, v3
    v_mul_u32_u24 v8, 2688, v3
    v_lshl_add_u32 v3, v2, 4, v8
    s_add_u32 m0, s61, 114688
    s_nop 0
    buffer_load_dwordx4 v3, s[24:27], s59 offen lds
    v_add_u32 v2, 320, v1
    v_mul_u32_u24 v3, 0xAAAB, v2
    v_lshrrev_b32 v3, 20, v3
    v_mul_u32_u24 v8, 2688, v3
    v_lshl_add_u32 v3, v2, 4, v8
    s_add_u32 m0, s61, 115712
    s_nop 0
    buffer_load_dwordx4 v3, s[24:27], s59 offen lds
    s_branch back_22
h1_58:
    s_cmp_lt_u32 s41, 80
    s_cbranch_scc0 back_22
    s_mov_b32 s28, s32
    s_and_b32 s29, s33, 0xffff
    s_mov_b32 s30, 819200
    s_mov_b32 s31, 0x00020000
    s_mul_i32 s58, s41, 0x3334
    s_lshr_b32 s58, s58, 16
    s_mul_i32 s59, s58, 5
    s_sub_u32 s59, s41, s59
    s_mul_i32 s58, s58, 40
    s_lshl_b32 s61, s59, 3
    s_add_u32 s58, s58, s61
    s_cmp_ge_u32 s59, 3
    s_cselect_b32 s61, 4, 0
    s_sub_u32 s58, s58, s61
    s_cmp_eq_u32 s59, 2
    s_cselect_b32 s61, 16, 0
    s_lshr_b32 s62, s42, 1
    s_mul_i32 s61, s61, s62
    s_lshl_b32 s62, s42, 1
    s_add_u32 s58, s58, s61
    s_add_u32 s58, s58, s62
    s_mul_i32 s58, s58, 1280
    s_mul_i32 s62, s42, 2560
    s_add_u32 m0, s62, 110592
    v_lshlrev_b32 v3, 4, v1
    buffer_load_dwordx4 v3, s[28:31], s58 offen lds
    buffer_load_dwordx4 v3, s[28:31], s58 offen offset:1024 lds
    s_mov_b32 exec_hi, 0
    buffer_load_dwordx4 v3, s[28:31], s58 offen offset:2048 lds
    s_mov_b64 exec, -1
    s_branch back_22
hook_23:
    v_mov_b32 v198, 0
    buffer_load_dword v196, v198, s[16:19], 0 offen sc1
    v_lshrrev_b32 v2, 4, v1
    v_bfe_u32 v3, v1, 2, 2
    v_and_b32 v4, 3, v1
    v_lshl_add_u32 v2, v2, 3, v3
    v_lshlrev_b32 v9, 4, v1
    v_mul_u32_u24 v5, 384, v2
    s_mul_i32 s57, s42, 96
    s_add_u32 s57, s57, 86016
    v_add_u32 v5, s57, v5
    v_lshl_add_u32 v6, v4, 3, v5
    v_and_b32 v7, 1, v4
    v_lshl_add_u32 v7, v7, 3, v5
    v_lshrrev_b32 v8, 1, v4
    v_mul_u32_u24 v8, 12288, v8
    v_add3_u32 v7, v7, v8, 32
    ds_read_b64_tr_b16 v[208:209], v6 offset:0
    ds_read_b64_tr_b16 v[210:211], v6 offset:1536
    ds_read_b64_tr_b16 v[212:213], v6 offset:12288
    ds_read_b64_tr_b16 v[214:215], v6 offset:13824
    ds_read_b64_tr_b16 v[216:217], v7 offset:0
    ds_read_b64_tr_b16 v[218:219], v7 offset:1536
    ds_read_b64_tr_b16 v[220:221], v6 offset:48
    ds_read_b64_tr_b16 v[222:223], v6 offset:1584
    ds_read_b64_tr_b16 v[224:225], v6 offset:12336
    ds_read_b64_tr_b16 v[226:227], v6 offset:13872
    ds_read_b64_tr_b16 v[228:229], v7 offset:48
    ds_read_b64_tr_b16 v[230:231], v7 offset:1584
    s_and_b32 s57, s40, 7
    s_lshl_b32 s57, s57, 2
    s_add_u32 s57, s57, s42
    s_mul_i32 s57, s57, 40
    s_lshr_b32 s58, s40, 3
    s_add_u32 s57, s57, s58
    s_mul_i32 s57, s57, 3072
    s_add_u32 s57, s57, 1048576
    s_add_u32 s58, s57, 61440
    s_waitcnt lgkmcnt(0)
    buffer_store_dwordx4 v[208:211], v9, s[12:15], s57 offen offset:0 sc1
    buffer_store_dwordx4 v[212:215], v9, s[12:15], s57 offen offset:1024 sc1
    buffer_store_dwordx4 v[216:219], v9, s[12:15], s57 offen offset:2048 sc1
    buffer_store_dwordx4 v[220:223], v9, s[12:15], s58 offen offset:0 sc1
    buffer_store_dwordx4 v[224:227], v9, s[12:15], s58 offen offset:1024 sc1
    buffer_store_dwordx4 v[228:231], v9, s[12:15], s58 offen offset:2048 sc1
    s_cmp_lt_u32 s52, 0
    s_cbranch_scc0 h1_60
    v_mul_u32_u24 v5, 384, v2
    s_mul_i32 s57, s42, 96
    s_add_u32 s57, s57, 110592
    v_add_u32 v5, s57, v5
    v_lshl_add_u32 v6, v4, 3, v5
    v_and_b32 v7, 1, v4
    v_lshl_add_u32 v7, v7, 3, v5
    v_lshrrev_b32 v8, 1, v4
    v_mul_u32_u24 v8, 12288, v8
    v_add3_u32 v7, v7, v8, 32
    ds_read_b64_tr_b16 v[232:233], v6 offset:0
    ds_read_b64_tr_b16 v[234:235], v6 offset:1536
    ds_read_b64_tr_b16 v[236:237], v6 offset:12288
    ds_read_b64_tr_b16 v[238:239], v6 offset:13824
    ds_read_b64_tr_b16 v[240:241], v7 offset:0
    ds_read_b64_tr_b16 v[242:243], v7 offset:1536
    ds_read_b64_tr_b16 v[244:245], v6 offset:48
    ds_read_b64_tr_b16 v[246:247], v6 offset:1584
    ds_read_b64_tr_b16 v[248:249], v6 offset:12336
    ds_read_b64_tr_b16 v[250:251], v6 offset:13872
    ds_read_b64_tr_b16 v[252:253], v7 offset:48
    ds_read_b64_tr_b16 v[254:255], v7 offset:1584
    s_and_b32 s57, s101, 7
    s_lshl_b32 s57, s57, 2
    s_add_u32 s57, s57, s42
    s_mul_i32 s57, s57, 40
    s_lshr_b32 s58, s101, 3
    s_add_u32 s57, s57, s58
    s_mul_i32 s57, s57, 3072
    s_add_u32 s57, s57, 1048576
    s_add_u32 s58, s57, 61440
    s_waitcnt lgkmcnt(0)
    buffer_store_dwordx4 v[232:235], v9, s[12:15], s57 offen offset:0 sc1
    buffer_store_dwordx4 v[236:239], v9, s[12:15], s57 offen offset:1024 sc1
    buffer_store_dwordx4 v[240:243], v9, s[12:15], s57 offen offset:2048 sc1
    buffer_store_dwordx4 v[244:247], v9, s[12:15], s58 offen offset:0 sc1
    buffer_store_dwordx4 v[248:251], v9, s[12:15], s58 offen offset:1024 sc1
    buffer_store_dwordx4 v[252:255], v9, s[12:15], s58 offen offset:2048 sc1
    s_branch back_24
h1_60:
    s_cmp_lt_u32 s41, 80
    s_cbranch_scc0 back_24
    s_lshr_b32 s57, s41, 2
    s_mul_i32 s57, s57, 5120
    s_and_b32 s58, s41, 3
    s_lshl_b32 s58, s58, 8
    s_add_u32 s57, s57, s58
    s_mul_i32 s58, s42, 204800
    s_add_u32 s57, s57, s58
    s_add_u32 s57, s57, 65536
    s_mul_i32 s58, s42, 320
    s_add_u32 s58, s58, 110592
    v_lshrrev_b32 v5, 4, v1
    v_add_u32 v5, 0, v5
    v_cmp_le_u32 vcc, 5, v5
    s_nop 1
    v_cndmask_b32 v6, 0, 1, vcc
    v_mul_u32_u24 v7, 5, v6
    v_sub_u32 v5, v5, v7
    v_mul_u32_u24 v7, 102400, v6
    v_lshl_add_u32 v7, v5, 10, v7
    v_and_b32 v8, 15, v1
    v_lshl_add_u32 v244, v8, 4, v7
    v_mul_u32_u24 v6, 160, v6
    v_lshrrev_b32 v7, 1, v5
    v_lshl_add_u32 v6, v7, 6, v6
    v_and_b32 v7, 1, v5
    v_lshl_add_u32 v6, v7, 3, v6
    v_cmp_eq_u32 vcc, 4, v5
    v_lshlrev_b32 v7, 4, v4
    v_lshlrev_b32 v8, 3, v4
    v_cndmask_b32 v7, v7, v8, vcc
    v_mul_u32_u24 v8, 1280, v3
    v_add3_u32 v6, v6, v7, v8
    v_add_u32 v6, s58, v6
    ds_read_b64_tr_b16 v[232:233], v6 offset:0
    ds_read_b64_tr_b16 v[234:235], v6 offset:5120
    v_lshrrev_b32 v5, 4, v1
    v_add_u32 v5, 4, v5
    v_cmp_le_u32 vcc, 5, v5
    s_nop 1
    v_cndmask_b32 v6, 0, 1, vcc
    v_mul_u32_u24 v7, 5, v6
    v_sub_u32 v5, v5, v7
    v_mul_u32_u24 v7, 102400, v6
    v_lshl_add_u32 v7, v5, 10, v7
    v_and_b32 v8, 15, v1
    v_lshl_add_u32 v245, v8, 4, v7
    v_mul_u32_u24 v6, 160, v6
    v_lshrrev_b32 v7, 1, v5
    v_lshl_add_u32 v6, v7, 6, v6
    v_and_b32 v7, 1, v5
    v_lshl_add_u32 v6, v7, 3, v6
    v_cmp_eq_u32 vcc, 4, v5
    v_lshlrev_b32 v7, 4, v4
    v_lshlrev_b32 v8, 3, v4
    v_cndmask_b32 v7, v7, v8, vcc
    v_mul_u32_u24 v8, 1280, v3
    v_add3_u32 v6, v6, v7, v8
    v_add_u32 v6, s58, v6
    ds_read_b64_tr_b16 v[236:237], v6 offset:0
    ds_read_b64_tr_b16 v[238:239], v6 offset:5120
    v_lshrrev_b32 v5, 4, v1
    v_add_u32 v5, 8, v5
    v_min_u32 v5, 9, v5
    v_cmp_le_u32 vcc, 5, v5
    s_nop 1
    v_cndmask_b32 v6, 0, 1, vcc
    v_mul_u32_u24 v7, 5, v6
    v_sub_u32 v5, v5, v7
    v_mul_u32_u24 v7, 102400, v6
    v_lshl_add_u32 v7, v5, 10, v7
    v_and_b32 v8, 15, v1
    v_lshl_add_u32 v246, v8, 4, v7
    v_mul_u32_u24 v6, 160, v6
    v_lshrrev_b32 v7, 1, v5
    v_lshl_add_u32 v6, v7, 6, v6
    v_and_b32 v7, 1, v5
    v_lshl_add_u32 v6, v7, 3, v6
    v_cmp_eq_u32 vcc, 4, v5
    v_lshlrev_b32 v7, 4, v4
    v_lshlrev_b32 v8, 3, v4
    v_cndmask_b32 v7, v7, v8, vcc
    v_mul_u32_u24 v8, 1280, v3
    v_add3_u32 v6, v6, v7, v8
    v_add_u32 v6, s58, v6
    ds_read_b64_tr_b16 v[240:241], v6 offset:0
    ds_read_b64_tr_b16 v[242:243], v6 offset:5120
    v_mov_b32 v8, 2147483648
    v_cmp_gt_u32 vcc, 32, v1
    s_nop 1
    v_cndmask_b32 v246, v8, v246, vcc
    s_waitcnt lgkmcnt(0)
    buffer_store_dwordx4 v[232:235], v244, s[12:15], s57 offen sc1
    buffer_store_dwordx4 v[236:239], v245, s[12:15], s57 offen sc1
    buffer_store_dwordx4 v[240:243], v246, s[12:15], s57 offen sc1
    s_branch back_24
hook_25:
    v_readfirstlane_b32 s57, v196
    s_nop 1
    s_cmp_eq_u32 s57, 1
    s_cbranch_scc1 h1_62
    v_mov_b32 v2, 0
    s_mov_b32 s62, 0
inip_65:
    buffer_load_dword v3, v2, s[16:19], 0 offen sc1
    s_waitcnt vmcnt(0)
    v_readfirstlane_b32 s61, v3
    s_add_u32 s62, s62, 1
    s_cmp_ge_u32 s62, 0x40000
    s_cbranch_scc1 ini_64
    s_cmp_eq_u32 s61, 1
    s_cbranch_scc0 inip_65
ini_64:
h1_62:
    s_cmp_eq_u32 s42, 0
    s_cbranch_scc0 sig_66
    s_and_b32 s57, s52, 7
    s_lshl_b32 s57, s57, 8
    v_mov_b32 v2, s57
    v_mov_b32 v3, 1
    s_mov_b64 exec, 1
    buffer_atomic_add v3, v2, s[12:15], 0 offen sc1
    s_mov_b64 exec, -1
sig_66:
    s_branch back_26
slow_27:
    s_cmp_eq_u32 s42, 0
    s_cbranch_scc0 pw_69
    v_mov_b32 v2, 0
    s_mov_b32 s62, 0
inip_73:
    buffer_load_dword v3, v2, s[16:19], 0 offen sc1
    s_waitcnt vmcnt(0)
    v_readfirstlane_b32 s61, v3
    s_add_u32 s62, s62, 1
    s_cmp_ge_u32 s62, 0x40000
    s_cbranch_scc1 ini_72
    s_cmp_eq_u32 s61, 1
    s_cbranch_scc0 inip_73
ini_72:
    s_mov_b32 s57, 0
    v_add_u32 v2, s57, v1
    v_lshlrev_b32 v2, 8, v2
    s_mov_b64 exec, 255
    s_mov_b32 s62, 0
pp_70:
    s_sleep 2
    buffer_load_dword v3, v2, s[12:15], 0 offen sc1
    s_waitcnt vmcnt(0)
    v_cmp_gt_u32 vcc, 16, v3
    s_add_u32 s62, s62, 1
    s_cmp_ge_u32 s62, 0x40000
    s_cbranch_scc1 pd_71
    s_nop 1
    s_cbranch_vccnz pp_70
pd_71:
    s_mov_b64 exec, -1
pw_69:
    s_branch fast_28
fs_46:
    s_mov_b32 s62, 0
fl_74:
    s_sleep 1
    buffer_load_dword v2, v17, s[12:15], s41 offen offset:0 sc1
    s_waitcnt vmcnt(0)
    v_readfirstlane_b32 s57, v2
    s_add_u32 s62, s62, 1
    s_cmp_ge_u32 s62, 0x40000
    s_cbranch_scc1 fb_47
    s_cmp_ge_u32 s57, 64
    s_cbranch_scc0 fl_74
    s_branch fb_47
fs_49:
    s_mov_b32 s62, 0
fl_75:
    s_sleep 1
    buffer_load_dword v3, v17, s[12:15], s41 offen offset:256 sc1
    s_waitcnt vmcnt(0)
    v_readfirstlane_b32 s57, v3
    s_add_u32 s62, s62, 1
    s_cmp_ge_u32 s62, 0x40000
    s_cbranch_scc1 fb_50
    s_cmp_ge_u32 s57, 64
    s_cbranch_scc0 fl_75
    s_branch fb_50
fs_52:
    s_mov_b32 s62, 0
fl_76:
    s_sleep 1
    buffer_load_dword v2, v17, s[12:15], s41 offen offset:512 sc1
    s_waitcnt vmcnt(0)
    v_readfirstlane_b32 s57, v2
    s_add_u32 s62, s62, 1
    s_cmp_ge_u32 s62, 0x40000
    s_cbranch_scc1 fb_53
    s_cmp_ge_u32 s57, 64
    s_cbranch_scc0 fl_76
    s_branch fb_53
fs_54:
    s_mov_b32 s62, 0
fl_77:
    s_sleep 1
    buffer_load_dword v3, v17, s[12:15], s41 offen offset:768 sc1
    s_waitcnt vmcnt(0)
    v_readfirstlane_b32 s57, v3
    s_add_u32 s62, s62, 1
    s_cmp_ge_u32 s62, 0x40000
    s_cbranch_scc1 fb_55
    s_cmp_ge_u32 s57, 64
    s_cbranch_scc0 fl_77
    s_branch fb_55
L_end:
.section .rodata,"a"
.p2align 6
.amdhsa_kernel sequential_preLN__linear_kernel_hedgehog__geglu_ffn__prompt_kernel
  .amdhsa_next_free_vgpr 512
  .amdhsa_next_free_sgpr 102
  .amdhsa_accum_offset 256
  .amdhsa_group_segment_fixed_size 0
  .amdhsa_kernarg_size 88
  .amdhsa_user_sgpr_count 2
  .amdhsa_user_sgpr_kernarg_segment_ptr 1
  .amdhsa_system_sgpr_workgroup_id_x 1
.end_amdhsa_kernel
```
